```python
import torch

def _softmax(x, axis=-1):
    return torch.softmax(x, dim=axis)
def _gelu(x):
    return torch.nn.functional.gelu(x, approximate="tanh")
def _silu(x):
    return torch.nn.functional.silu(x)
def _sigmoid(x):
    return torch.sigmoid(x)
def _layernorm(x, axis=-1, eps=1e-5):
    m = x.mean(dim=axis, keepdim=True)
    v = x.var(dim=axis, keepdim=True, unbiased=False)
    return (x - m) / torch.sqrt(v + eps)
def _scatter_add(tgt, idx, src, axis=0):
    return tgt.clone().index_add_(axis, idx, src)
def _segment_sum(src, seg, n):
    out = torch.zeros((n,) + src.shape[1:], dtype=src.dtype)
    return out.index_add_(0, seg, src)
def _pad(x, pw):
    flat = tuple(v for pair in reversed(pw) for v in pair)
    return torch.nn.functional.pad(x, flat)

kernel_name = 'standalone__gqa_softmax__near_ridge'

def setup_inputs():

    _w = (lambda a: (lambda t: t.to(torch.bfloat16) if t.is_floating_point() else t)(torch.as_tensor(a)))
    B, Hq, Hkv, Sq, Sk, D = 8, 32, 32, 384, 512, 192
    return {
        "q": _w((lambda *s: torch.randn(*s, dtype=torch.bfloat16) * 0.8)(B, Hq, Sq, D)),
        "k": _w((lambda *s: torch.randn(*s, dtype=torch.bfloat16) * 0.8)(B, Hkv, Sk, D)),
        "v": _w((lambda *s: torch.randn(*s, dtype=torch.bfloat16) * 0.05)(B, Hkv, Sk, D)),
    }

def reference(q, k, v):
    B, Hq, Sq, D = q.shape
    Hkv = k.shape[1]
    rep = Hq // Hkv
    k = (lambda x, n, axis: torch.repeat_interleave(x, n, dim=axis))(k, rep, axis=1)
    v = (lambda x, n, axis: torch.repeat_interleave(x, n, dim=axis))(v, rep, axis=1)
    scale = D ** -0.5
    scores = torch.einsum("bhqd,bhkd->bhqk", q, k) * scale
    p = _softmax(scores, axis=-1)
    return torch.einsum("bhqk,bhkd->bhqd", p, v)
```

```asm
; @launch grid=(256,1,1) block=(256,1,1) lds=154688
.amdgcn_target "amdgcn-amd-amdhsa--gfx950"
.text
.globl standalone__gqa_softmax__near_ridge_kernel
.p2align 8
.type standalone__gqa_softmax__near_ridge_kernel,@function
standalone__gqa_softmax__near_ridge_kernel:
L_start:
    s_cmp_ge_u32 s2, 256
    s_cbranch_scc1 L_end
    s_load_dwordx4 s[4:7], s[0:1], 0
    s_load_dwordx4 s[8:11], s[0:1], 16
    s_getpc_b64 s[18:19]
    v_lshrrev_b32 v240, 5, v0
L_pc:
    s_and_b32 s3, s2, 0xf8
    v_add_u32 v240, s3, v240
    v_lshlrev_b32 v240, 7, v240
    v_min_u32 v240, L_hotend-L_main, v240
    v_add_u32 v240, L_main-L_pc+4, v240
    global_load_dword v241, v240, s[18:19]
    v_lshrrev_b32 v243, 6, v0
    v_and_b32 v242, 63, v0
    s_mul_i32 s14, s2, 147456
    v_readfirstlane_b32 s47, v243
    s_mul_i32 s15, s2, 196608
    s_getreg_b32 s17, hwreg(HW_REG_XCC_ID, 0, 1)
    v_lshrrev_b32 v246, 3, v242
    v_mul_u32_u24 v247, 384, v246
    v_lshrrev_b32 v244, 4, v242
    v_lshlrev_b32 v245, 1, v244
    v_xor_b32 v245, v245, v242
    v_and_b32 v245, 7, v245
    v_lshl_add_u32 v7, v245, 4, v247
    s_mul_i32 s48, s47, 3072
    v_add_u32 v7, s48, v7
    v_and_b32 v245, 7, v242
    v_lshl_add_u32 v14, v245, 4, v247
    s_mul_i32 s49, s47, 36864
    v_add_u32 v14, s49, v14
    s_lshl_b32 s53, s47, 10
    s_add_u32 s52, s53, 49152
    s_mov_b32 s55, 6144
    s_mov_b32 s56, 12288
    s_mov_b32 s57, 18432
    s_mov_b32 s58, 24576
    s_mov_b32 s59, 30720
    s_mov_b32 s3, 0
    s_sub_u32 s48, s17, 0
    s_cmp_lt_u32 s48, 1
    s_cselect_b32 s3, 1, s3
    s_waitcnt lgkmcnt(0)
    s_add_u32 s24, s6, s15
    s_addc_u32 s25, s7, 0
    s_mov_b32 s26, 196608
    s_mov_b32 s27, 0x20000
    s_add_u32 m0, s52, 36864
    s_mov_b32 s48, 0
    buffer_load_dwordx4 v7, s[24:27], s48 offen offset:0 nt lds
    s_add_u32 m0, s52, 40832
    s_mov_b32 s48, 0
    buffer_load_dwordx4 v7, s[24:27], s48 offen offset:128 nt lds
    s_add_u32 m0, s52, 44800
    s_mov_b32 s48, 0
    buffer_load_dwordx4 v7, s[24:27], s48 offen offset:256 nt lds
    s_add_u32 s20, s4, s14
    s_addc_u32 s21, s5, 0
    s_mov_b32 s22, 147456
    s_mov_b32 s23, 0x20000
    buffer_load_dwordx4 v[96:99], v14, s[20:23], 0 offen offset:0 nt
    s_bitcmp1_b32 s3, 0
    s_cbranch_scc0 L_sg3_0
    s_waitcnt vmcnt(3)
L_sg3_0:
    buffer_load_dwordx4 v[100:103], v14, s[20:23], 0 offen offset:3072 nt
    s_bitcmp1_b32 s3, 0
    s_cbranch_scc0 L_sg4_0
    s_waitcnt vmcnt(3)
L_sg4_0:
    buffer_load_dwordx4 v[104:107], v14, s[20:23], 0 offen offset:128 nt
    s_bitcmp1_b32 s3, 0
    s_cbranch_scc0 L_sg5_0
    s_waitcnt vmcnt(3)
L_sg5_0:
    buffer_load_dwordx4 v[108:111], v14, s[20:23], 0 offen offset:3200 nt
    s_bitcmp1_b32 s3, 0
    s_cbranch_scc0 L_sg6_0
    s_waitcnt vmcnt(3)
L_sg6_0:
    buffer_load_dwordx4 v[112:115], v14, s[20:23], 0 offen offset:256 nt
    s_bitcmp1_b32 s3, 0
    s_cbranch_scc0 L_sg7_0
    s_waitcnt vmcnt(3)
L_sg7_0:
    buffer_load_dwordx4 v[116:119], v14, s[20:23], 0 offen offset:3328 nt
    s_bitcmp1_b32 s3, 0
    s_cbranch_scc0 L_sg8_0
    s_waitcnt vmcnt(3)
L_sg8_0:
    buffer_load_dwordx4 v[120:123], v14, s[20:23], s55 offen offset:0 nt
    s_bitcmp1_b32 s3, 0
    s_cbranch_scc0 L_sg9_0
    s_waitcnt vmcnt(3)
L_sg9_0:
    buffer_load_dwordx4 v[124:127], v14, s[20:23], s55 offen offset:3072 nt
    s_bitcmp1_b32 s3, 0
    s_cbranch_scc0 L_sg10_0
    s_waitcnt vmcnt(3)
L_sg10_0:
    buffer_load_dwordx4 v[128:131], v14, s[20:23], s55 offen offset:128 nt
    s_bitcmp1_b32 s3, 0
    s_cbranch_scc0 L_sg11_0
    s_waitcnt vmcnt(3)
L_sg11_0:
    buffer_load_dwordx4 v[132:135], v14, s[20:23], s55 offen offset:3200 nt
    s_bitcmp1_b32 s3, 0
    s_cbranch_scc0 L_sg12_0
    s_waitcnt vmcnt(3)
L_sg12_0:
    buffer_load_dwordx4 v[136:139], v14, s[20:23], s55 offen offset:256 nt
    s_bitcmp1_b32 s3, 0
    s_cbranch_scc0 L_sg13_0
    s_waitcnt vmcnt(3)
L_sg13_0:
    buffer_load_dwordx4 v[140:143], v14, s[20:23], s55 offen offset:3328 nt
    s_bitcmp1_b32 s3, 0
    s_cbranch_scc0 L_sg14_0
    s_waitcnt vmcnt(3)
L_sg14_0:
    buffer_load_dwordx4 v[144:147], v14, s[20:23], s56 offen offset:0 nt
    s_bitcmp1_b32 s3, 0
    s_cbranch_scc0 L_sg15_0
    s_waitcnt vmcnt(3)
L_sg15_0:
    buffer_load_dwordx4 v[148:151], v14, s[20:23], s56 offen offset:3072 nt
    s_bitcmp1_b32 s3, 0
    s_cbranch_scc0 L_sg16_0
    s_waitcnt vmcnt(3)
L_sg16_0:
    buffer_load_dwordx4 v[152:155], v14, s[20:23], s56 offen offset:128 nt
    s_bitcmp1_b32 s3, 0
    s_cbranch_scc0 L_sg17_0
    s_waitcnt vmcnt(3)
L_sg17_0:
    buffer_load_dwordx4 v[156:159], v14, s[20:23], s56 offen offset:3200 nt
    s_bitcmp1_b32 s3, 0
    s_cbranch_scc0 L_sg18_0
    s_waitcnt vmcnt(3)
L_sg18_0:
    buffer_load_dwordx4 v[160:163], v14, s[20:23], s56 offen offset:256 nt
    s_bitcmp1_b32 s3, 0
    s_cbranch_scc0 L_sg19_0
    s_waitcnt vmcnt(3)
L_sg19_0:
    buffer_load_dwordx4 v[164:167], v14, s[20:23], s56 offen offset:3328 nt
    s_bitcmp1_b32 s3, 0
    s_cbranch_scc0 L_sg20_0
    s_waitcnt vmcnt(3)
L_sg20_0:
    s_branch L_main
.p2align 12
L_main:
    s_add_u32 s28, s8, s15
    s_addc_u32 s29, s9, 0
    s_mov_b32 s30, 184320
    s_mov_b32 s31, 0x20000
    s_add_u32 s32, s10, s14
    s_addc_u32 s33, s11, 0
    s_mov_b32 s34, 147456
    s_mov_b32 s35, 0x20000
    s_add_u32 s84, s8, s15
    s_addc_u32 s85, s9, 0
    s_mov_b32 s86, 196608
    s_mov_b32 s87, 0x20000
    s_add_u32 s50, s52, 36864
    s_add_u32 s51, s53, 36864
    s_mul_i32 s16, s47, 14080
    s_add_u32 s16, s16, 98304
    v_xor_b32 v243, v246, v245
    v_lshlrev_b32 v243, 4, v243
    v_lshl_add_u32 v243, v246, 7, v243
    s_mul_i32 s48, s47, 6144
    s_cmp_lt_u32 s47, 2
    s_cselect_b32 s3, 0, 4
    s_mul_i32 s3, s3, 12288
    s_add_u32 s48, s48, s3
    v_add_u32 v249, s48, v243
    v_and_b32 v245, 3, v242
    v_xor_b32 v243, v246, v245
    v_lshlrev_b32 v243, 4, v243
    v_lshl_add_u32 v243, v245, 8, v243
    v_bfe_u32 v245, v242, 2, 1
    v_mul_u32_u24 v245, 1088, v245
    v_add3_u32 v15, v243, v245, s16
    v_and_b32 v243, 15, v242
    v_xor_b32 v245, v243, v244
    v_lshlrev_b32 v245, 4, v245
    v_lshl_add_u32 v245, v244, 8, v245
    v_add_u32 v6, s16, v245
    v_lshlrev_b32 v247, 7, v243
    v_lshrrev_b32 v245, 5, v242
    v_xor_b32 v245, v245, v242
    v_and_b32 v245, 7, v245
    v_lshl_add_u32 v247, v245, 4, v247
    v_xor_b32 v245, v244, v246
    v_and_b32 v245, 1, v245
    v_lshl_add_u32 v247, v245, 3, v247
    v_add_u32 v248, s48, v247
    ds_write_b64 v6, v[248:249] offset:13056
    v_and_b32 v245, 6, v242
    v_xor_b32 v245, v245, v244
    v_lshlrev_b32 v245, 4, v245
    v_lshl_add_u32 v0, v243, 7, v245
    v_add_u32 v0, 49152, v0
    v_xor_b32 v1, 64, v0
    v_lshrrev_b32 v245, 2, v242
    v_lshlrev_b32 v245, 7, v245
    v_and_b32 v243, 3, v242
    v_lshl_add_u32 v245, v243, 3, v245
    v_bfe_u32 v243, v242, 3, 2
    v_lshl_add_u32 v245, v243, 5, v245
    v_add_u32 v2, 24576, v245
    v_xor_b32 v3, 32, v2
    v_xor_b32 v4, 64, v2
    v_xor_b32 v5, 96, v2
    s_mov_b32 s40, 0x3dd53b95
    s_mov_b32 s41, 0x3dd53b95
    s_mov_b32 s54, 0xffff0000
    s_mov_b32 s42, 0
    s_mov_b32 s43, 49152
    s_mov_b32 s44, 24576
    s_add_u32 s45, s52, 12288
    s_mov_b32 s74, 159744
    s_add_u32 s75, s53, 36864
    s_mov_b32 s90, -24576
    s_mov_b32 s91, 12288
    s_mov_b32 s94, 24320
    s_movk_i32 s95, 128
    s_add_u32 s46, s53, 24576
    s_mov_b32 s76, 0x35800000
    s_mov_b32 s77, 0x4b800000
    s_mov_b64 s[78:79], 0
    v_mov_b32 v8, 0
    v_mov_b32 v9, 0
    v_mov_b32 v10, 0
    v_mov_b32 v11, 0
    v_mov_b32 v12, 0
    v_mov_b32 v13, 0
    v_accvgpr_write_b32 a124, 0
    v_accvgpr_write_b32 a125, 0
    v_accvgpr_write_b32 a126, 0
    v_accvgpr_write_b32 a127, 0
    v_mov_b32 v243, 154624
    ds_write_b32 v243, v8
    v_mfma_f32_32x32x16_bf16 a[128:143], a[124:127], a[124:127], 0
    v_mfma_f32_32x32x16_bf16 a[144:159], a[124:127], a[124:127], 0
    v_mfma_f32_32x32x16_bf16 a[160:175], a[124:127], a[124:127], 0
    v_mfma_f32_32x32x16_bf16 a[176:191], a[124:127], a[124:127], 0
    v_mfma_f32_32x32x16_bf16 a[192:207], a[124:127], a[124:127], 0
    v_mfma_f32_32x32x16_bf16 a[208:223], a[124:127], a[124:127], 0
    v_mfma_f32_32x32x16_bf16 a[224:239], a[124:127], a[124:127], 0
    v_mfma_f32_32x32x16_bf16 a[240:255], a[124:127], a[124:127], 0
    s_mov_b64 exec, 0
    s_cmp_eq_u32 s47, 0
    s_cbranch_scc1 L_hop1
    s_cmp_eq_u32 s47, 1
    s_cbranch_scc1 L_hop2
    s_cmp_eq_u32 s47, 2
    s_cbranch_scc1 L_hop3
    s_cmp_eq_u32 s17, 0
    s_cbranch_scc1 L_hop0
L_hopback0:
    s_mov_b64 exec, -1
    s_waitcnt vmcnt(18)
    s_waitcnt lgkmcnt(0)
    s_barrier
    ds_read_b128 v[52:55], v0 offset:36864
    ds_read_b128 v[64:67], v0 offset:38912
    ds_read_b128 v[76:79], v1 offset:36864
    ds_read_b128 v[88:91], v1 offset:38912
    ds_read_b128 v[20:23], v0 offset:40960
    ds_read_b128 v[36:39], v0 offset:43008
    ds_read_b128 v[28:31], v1 offset:40960
    ds_read_b128 v[44:47], v1 offset:43008
    ds_read_b128 a[96:99], v0 offset:45056
    ds_read_b128 a[100:103], v0 offset:47104
    ds_read_b128 a[104:107], v1 offset:45056
    ds_read_b128 a[108:111], v1 offset:47104
    s_waitcnt vmcnt(17)
    v_lshlrev_b32 v240, 16, v96
    v_and_b32 v241, s54, v96
    v_lshlrev_b32 v242, 16, v97
    v_and_b32 v243, s54, v97
    v_lshlrev_b32 v244, 16, v98
    v_and_b32 v245, s54, v98
    v_lshlrev_b32 v246, 16, v99
    v_and_b32 v247, s54, v99
    v_pk_mul_f32 v[240:241], v[240:241], s[40:41]
    v_pk_mul_f32 v[242:243], v[242:243], s[40:41]
    v_pk_mul_f32 v[244:245], v[244:245], s[40:41]
    v_pk_mul_f32 v[246:247], v[246:247], s[40:41]
    v_cvt_pk_bf16_f32 v96, v240, v241
    v_cvt_pk_bf16_f32 v97, v242, v243
    v_cvt_pk_bf16_f32 v98, v244, v245
    v_cvt_pk_bf16_f32 v99, v246, v247
    ds_write_b128 v15, v[96:99] offset:0
    buffer_load_dwordx4 v[168:171], v14, s[20:23], s57 offen offset:0 nt
    s_waitcnt vmcnt(17)
    v_lshlrev_b32 v248, 16, v100
    v_and_b32 v249, s54, v100
    v_lshlrev_b32 v250, 16, v101
    v_and_b32 v251, s54, v101
    v_lshlrev_b32 v252, 16, v102
    v_and_b32 v253, s54, v102
    v_lshlrev_b32 v254, 16, v103
    v_and_b32 v255, s54, v103
    v_pk_mul_f32 v[248:249], v[248:249], s[40:41]
    v_pk_mul_f32 v[250:251], v[250:251], s[40:41]
    v_pk_mul_f32 v[252:253], v[252:253], s[40:41]
    v_pk_mul_f32 v[254:255], v[254:255], s[40:41]
    v_cvt_pk_bf16_f32 v100, v248, v249
    v_cvt_pk_bf16_f32 v101, v250, v251
    v_cvt_pk_bf16_f32 v102, v252, v253
    v_cvt_pk_bf16_f32 v103, v254, v255
    ds_write_b128 v15, v[100:103] offset:128
    buffer_load_dwordx4 v[172:175], v14, s[20:23], s57 offen offset:3072 nt
    s_waitcnt vmcnt(17)
    v_lshlrev_b32 v240, 16, v104
    v_and_b32 v241, s54, v104
    v_lshlrev_b32 v242, 16, v105
    v_and_b32 v243, s54, v105
    v_lshlrev_b32 v244, 16, v106
    v_and_b32 v245, s54, v106
    v_lshlrev_b32 v246, 16, v107
    v_and_b32 v247, s54, v107
    v_pk_mul_f32 v[240:241], v[240:241], s[40:41]
    v_pk_mul_f32 v[242:243], v[242:243], s[40:41]
    v_pk_mul_f32 v[244:245], v[244:245], s[40:41]
    v_pk_mul_f32 v[246:247], v[246:247], s[40:41]
    v_cvt_pk_bf16_f32 v104, v240, v241
    v_cvt_pk_bf16_f32 v105, v242, v243
    v_cvt_pk_bf16_f32 v106, v244, v245
    v_cvt_pk_bf16_f32 v107, v246, v247
    ds_read_b128 a[0:3], v6 offset:0
    ds_read_b128 a[4:7], v6 offset:1088
    ds_write_b128 v15, v[104:107] offset:2176
    buffer_load_dwordx4 v[176:179], v14, s[20:23], s57 offen offset:128 nt
    s_waitcnt vmcnt(17)
    v_lshlrev_b32 v248, 16, v108
    v_and_b32 v249, s54, v108
    v_lshlrev_b32 v250, 16, v109
    v_and_b32 v251, s54, v109
    v_lshlrev_b32 v252, 16, v110
    v_and_b32 v253, s54, v110
    v_lshlrev_b32 v254, 16, v111
    v_and_b32 v255, s54, v111
    v_pk_mul_f32 v[248:249], v[248:249], s[40:41]
    v_pk_mul_f32 v[250:251], v[250:251], s[40:41]
    v_pk_mul_f32 v[252:253], v[252:253], s[40:41]
    v_pk_mul_f32 v[254:255], v[254:255], s[40:41]
    v_cvt_pk_bf16_f32 v108, v248, v249
    v_cvt_pk_bf16_f32 v109, v250, v251
    v_cvt_pk_bf16_f32 v110, v252, v253
    v_cvt_pk_bf16_f32 v111, v254, v255
    ds_write_b128 v15, v[108:111] offset:2304
    buffer_load_dwordx4 v[180:183], v14, s[20:23], s57 offen offset:3200 nt
    s_waitcnt lgkmcnt(2)
    v_mfma_f32_16x16x32_bf16 v[48:51], v[52:55], a[0:3], 0
    v_mfma_f32_16x16x32_bf16 v[48:51], v[76:79], a[4:7], v[48:51]
    v_mfma_f32_16x16x32_bf16 v[56:59], v[64:67], a[0:3], 0
    v_mfma_f32_16x16x32_bf16 v[56:59], v[88:91], a[4:7], v[56:59]
    s_waitcnt vmcnt(17)
    v_lshlrev_b32 v240, 16, v112
    v_and_b32 v241, s54, v112
    v_lshlrev_b32 v242, 16, v113
    v_and_b32 v243, s54, v113
    v_lshlrev_b32 v244, 16, v114
    v_and_b32 v245, s54, v114
    v_lshlrev_b32 v246, 16, v115
    v_and_b32 v247, s54, v115
    v_pk_mul_f32 v[240:241], v[240:241], s[40:41]
    v_pk_mul_f32 v[242:243], v[242:243], s[40:41]
    v_pk_mul_f32 v[244:245], v[244:245], s[40:41]
    v_pk_mul_f32 v[246:247], v[246:247], s[40:41]
    v_cvt_pk_bf16_f32 v112, v240, v241
    v_cvt_pk_bf16_f32 v113, v242, v243
    v_cvt_pk_bf16_f32 v114, v244, v245
    v_cvt_pk_bf16_f32 v115, v246, v247
    ds_read_b128 a[8:11], v6 offset:2176
    ds_read_b128 a[12:15], v6 offset:3264
    ds_write_b128 v15, v[112:115] offset:4352
    buffer_load_dwordx4 v[184:187], v14, s[20:23], s57 offen offset:256 nt
    s_waitcnt vmcnt(17)
    v_lshlrev_b32 v248, 16, v116
    v_and_b32 v249, s54, v116
    v_lshlrev_b32 v250, 16, v117
    v_and_b32 v251, s54, v117
    v_lshlrev_b32 v252, 16, v118
    v_and_b32 v253, s54, v118
    v_lshlrev_b32 v254, 16, v119
    v_and_b32 v255, s54, v119
    v_pk_mul_f32 v[248:249], v[248:249], s[40:41]
    v_pk_mul_f32 v[250:251], v[250:251], s[40:41]
    v_pk_mul_f32 v[252:253], v[252:253], s[40:41]
    v_pk_mul_f32 v[254:255], v[254:255], s[40:41]
    v_cvt_pk_bf16_f32 v116, v248, v249
    v_cvt_pk_bf16_f32 v117, v250, v251
    v_cvt_pk_bf16_f32 v118, v252, v253
    v_cvt_pk_bf16_f32 v119, v254, v255
    ds_write_b128 v15, v[116:119] offset:4480
    buffer_load_dwordx4 v[188:191], v14, s[20:23], s57 offen offset:3328 nt
    s_waitcnt lgkmcnt(2)
    v_mfma_f32_16x16x32_bf16 v[48:51], v[20:23], a[8:11], v[48:51]
    v_mfma_f32_16x16x32_bf16 v[48:51], v[28:31], a[12:15], v[48:51]
    v_mfma_f32_16x16x32_bf16 v[56:59], v[36:39], a[8:11], v[56:59]
    v_mfma_f32_16x16x32_bf16 v[56:59], v[44:47], a[12:15], v[56:59]
    s_waitcnt vmcnt(17)
    v_lshlrev_b32 v240, 16, v120
    v_and_b32 v241, s54, v120
    v_lshlrev_b32 v242, 16, v121
    v_and_b32 v243, s54, v121
    v_lshlrev_b32 v244, 16, v122
    v_and_b32 v245, s54, v122
    v_lshlrev_b32 v246, 16, v123
    v_and_b32 v247, s54, v123
    v_pk_mul_f32 v[240:241], v[240:241], s[40:41]
    v_pk_mul_f32 v[242:243], v[242:243], s[40:41]
    v_pk_mul_f32 v[244:245], v[244:245], s[40:41]
    v_pk_mul_f32 v[246:247], v[246:247], s[40:41]
    v_cvt_pk_bf16_f32 v120, v240, v241
    v_cvt_pk_bf16_f32 v121, v242, v243
    v_cvt_pk_bf16_f32 v122, v244, v245
    v_cvt_pk_bf16_f32 v123, v246, v247
    ds_read_b128 a[16:19], v6 offset:4352
    ds_read_b128 a[20:23], v6 offset:5440
    ds_write_b128 v15, v[120:123] offset:6528
    buffer_load_dwordx4 v[192:195], v14, s[20:23], s58 offen offset:0 nt
    s_waitcnt vmcnt(17)
    v_lshlrev_b32 v248, 16, v124
    v_and_b32 v249, s54, v124
    v_lshlrev_b32 v250, 16, v125
    v_and_b32 v251, s54, v125
    v_lshlrev_b32 v252, 16, v126
    v_and_b32 v253, s54, v126
    v_lshlrev_b32 v254, 16, v127
    v_and_b32 v255, s54, v127
    v_pk_mul_f32 v[248:249], v[248:249], s[40:41]
    v_pk_mul_f32 v[250:251], v[250:251], s[40:41]
    v_pk_mul_f32 v[252:253], v[252:253], s[40:41]
    v_pk_mul_f32 v[254:255], v[254:255], s[40:41]
    v_cvt_pk_bf16_f32 v124, v248, v249
    v_cvt_pk_bf16_f32 v125, v250, v251
    v_cvt_pk_bf16_f32 v126, v252, v253
    v_cvt_pk_bf16_f32 v127, v254, v255
    ds_write_b128 v15, v[124:127] offset:6656
    buffer_load_dwordx4 v[196:199], v14, s[20:23], s58 offen offset:3072 nt
    s_waitcnt lgkmcnt(2)
    v_mfma_f32_16x16x32_bf16 v[48:51], a[96:99], a[16:19], v[48:51]
    v_mfma_f32_16x16x32_bf16 v[48:51], a[104:107], a[20:23], v[48:51]
    v_mfma_f32_16x16x32_bf16 v[56:59], a[100:103], a[16:19], v[56:59]
    v_mfma_f32_16x16x32_bf16 v[56:59], a[108:111], a[20:23], v[56:59]
    s_waitcnt vmcnt(17)
    v_lshlrev_b32 v240, 16, v128
    v_and_b32 v241, s54, v128
    v_lshlrev_b32 v242, 16, v129
    v_and_b32 v243, s54, v129
    v_lshlrev_b32 v244, 16, v130
    v_and_b32 v245, s54, v130
    v_lshlrev_b32 v246, 16, v131
    v_and_b32 v247, s54, v131
    v_pk_mul_f32 v[240:241], v[240:241], s[40:41]
    v_pk_mul_f32 v[242:243], v[242:243], s[40:41]
    v_pk_mul_f32 v[244:245], v[244:245], s[40:41]
    v_pk_mul_f32 v[246:247], v[246:247], s[40:41]
    v_cvt_pk_bf16_f32 v128, v240, v241
    v_cvt_pk_bf16_f32 v129, v242, v243
    v_cvt_pk_bf16_f32 v130, v244, v245
    v_cvt_pk_bf16_f32 v131, v246, v247
    ds_read_b128 a[24:27], v6 offset:6528
    ds_read_b128 a[28:31], v6 offset:7616
    ds_write_b128 v15, v[128:131] offset:8704
    buffer_load_dwordx4 v[200:203], v14, s[20:23], s58 offen offset:128 nt
    s_waitcnt vmcnt(17)
    v_lshlrev_b32 v248, 16, v132
    v_and_b32 v249, s54, v132
    v_lshlrev_b32 v250, 16, v133
    v_and_b32 v251, s54, v133
    v_lshlrev_b32 v252, 16, v134
    v_and_b32 v253, s54, v134
    v_lshlrev_b32 v254, 16, v135
    v_and_b32 v255, s54, v135
    v_pk_mul_f32 v[248:249], v[248:249], s[40:41]
    v_pk_mul_f32 v[250:251], v[250:251], s[40:41]
    v_pk_mul_f32 v[252:253], v[252:253], s[40:41]
    v_pk_mul_f32 v[254:255], v[254:255], s[40:41]
    v_cvt_pk_bf16_f32 v132, v248, v249
    v_cvt_pk_bf16_f32 v133, v250, v251
    v_cvt_pk_bf16_f32 v134, v252, v253
    v_cvt_pk_bf16_f32 v135, v254, v255
    ds_write_b128 v15, v[132:135] offset:8832
    buffer_load_dwordx4 v[204:207], v14, s[20:23], s58 offen offset:3200 nt
    s_waitcnt lgkmcnt(2)
    v_mfma_f32_16x16x32_bf16 v[60:63], v[52:55], a[24:27], 0
    v_mfma_f32_16x16x32_bf16 v[60:63], v[76:79], a[28:31], v[60:63]
    v_mfma_f32_16x16x32_bf16 v[68:71], v[64:67], a[24:27], 0
    v_mfma_f32_16x16x32_bf16 v[68:71], v[88:91], a[28:31], v[68:71]
    v_exp_f32 v48, v48
    v_exp_f32 v49, v49
    v_exp_f32 v50, v50
    v_exp_f32 v51, v51
    v_exp_f32 v56, v56
    v_exp_f32 v57, v57
    v_exp_f32 v58, v58
    v_exp_f32 v59, v59
    s_nop 0
    v_add_f32 v8, v8, v48
    v_add_f32 v8, v8, v49
    v_cvt_pk_bf16_f32 v48, v48, v49
    v_add_f32 v8, v8, v50
    v_add_f32 v8, v8, v51
    v_cvt_pk_bf16_f32 v49, v50, v51
    v_add_f32 v8, v8, v56
    v_add_f32 v8, v8, v57
    v_cvt_pk_bf16_f32 v50, v56, v57
    v_add_f32 v8, v8, v58
    v_add_f32 v8, v8, v59
    v_cvt_pk_bf16_f32 v51, v58, v59
    s_waitcnt vmcnt(17)
    v_lshlrev_b32 v240, 16, v136
    v_and_b32 v241, s54, v136
    v_lshlrev_b32 v242, 16, v137
    v_and_b32 v243, s54, v137
    v_lshlrev_b32 v244, 16, v138
    v_and_b32 v245, s54, v138
    v_lshlrev_b32 v246, 16, v139
    v_and_b32 v247, s54, v139
    v_pk_mul_f32 v[240:241], v[240:241], s[40:41]
    v_pk_mul_f32 v[242:243], v[242:243], s[40:41]
    v_pk_mul_f32 v[244:245], v[244:245], s[40:41]
    v_pk_mul_f32 v[246:247], v[246:247], s[40:41]
    v_cvt_pk_bf16_f32 v136, v240, v241
    v_cvt_pk_bf16_f32 v137, v242, v243
    v_cvt_pk_bf16_f32 v138, v244, v245
    v_cvt_pk_bf16_f32 v139, v246, v247
    ds_read_b128 a[32:35], v6 offset:8704
    ds_read_b128 a[36:39], v6 offset:9792
    ds_write_b128 v15, v[136:139] offset:10880
    buffer_load_dwordx4 v[208:211], v14, s[20:23], s58 offen offset:256 nt
    s_waitcnt vmcnt(17)
    v_lshlrev_b32 v248, 16, v140
    v_and_b32 v249, s54, v140
    v_lshlrev_b32 v250, 16, v141
    v_and_b32 v251, s54, v141
    v_lshlrev_b32 v252, 16, v142
    v_and_b32 v253, s54, v142
    v_lshlrev_b32 v254, 16, v143
    v_and_b32 v255, s54, v143
    v_pk_mul_f32 v[248:249], v[248:249], s[40:41]
    v_pk_mul_f32 v[250:251], v[250:251], s[40:41]
    v_pk_mul_f32 v[252:253], v[252:253], s[40:41]
    v_pk_mul_f32 v[254:255], v[254:255], s[40:41]
    v_cvt_pk_bf16_f32 v140, v248, v249
    v_cvt_pk_bf16_f32 v141, v250, v251
    v_cvt_pk_bf16_f32 v142, v252, v253
    v_cvt_pk_bf16_f32 v143, v254, v255
    ds_write_b128 v15, v[140:143] offset:11008
    buffer_load_dwordx4 v[212:215], v14, s[20:23], s58 offen offset:3328 nt
    s_waitcnt lgkmcnt(2)
    v_mfma_f32_16x16x32_bf16 v[60:63], v[20:23], a[32:35], v[60:63]
    v_mfma_f32_16x16x32_bf16 v[60:63], v[28:31], a[36:39], v[60:63]
    v_mfma_f32_16x16x32_bf16 v[68:71], v[36:39], a[32:35], v[68:71]
    v_mfma_f32_16x16x32_bf16 v[68:71], v[44:47], a[36:39], v[68:71]
    s_waitcnt vmcnt(17)
    v_lshlrev_b32 v240, 16, v144
    v_and_b32 v241, s54, v144
    v_lshlrev_b32 v242, 16, v145
    v_and_b32 v243, s54, v145
    v_lshlrev_b32 v244, 16, v146
    v_and_b32 v245, s54, v146
    v_lshlrev_b32 v246, 16, v147
    v_and_b32 v247, s54, v147
    v_pk_mul_f32 v[240:241], v[240:241], s[40:41]
    v_pk_mul_f32 v[242:243], v[242:243], s[40:41]
    v_pk_mul_f32 v[244:245], v[244:245], s[40:41]
    v_pk_mul_f32 v[246:247], v[246:247], s[40:41]
    v_cvt_pk_bf16_f32 v144, v240, v241
    v_cvt_pk_bf16_f32 v145, v242, v243
    v_cvt_pk_bf16_f32 v146, v244, v245
    v_cvt_pk_bf16_f32 v147, v246, v247
    ds_read_b128 a[40:43], v6 offset:10880
    ds_read_b128 a[44:47], v6 offset:11968
    ds_write_b128 v15, v[144:147] offset:0
    buffer_load_dwordx4 v[216:219], v14, s[20:23], s59 offen offset:0 nt
    s_waitcnt vmcnt(17)
    v_lshlrev_b32 v248, 16, v148
    v_and_b32 v249, s54, v148
    v_lshlrev_b32 v250, 16, v149
    v_and_b32 v251, s54, v149
    v_lshlrev_b32 v252, 16, v150
    v_and_b32 v253, s54, v150
    v_lshlrev_b32 v254, 16, v151
    v_and_b32 v255, s54, v151
    v_pk_mul_f32 v[248:249], v[248:249], s[40:41]
    v_pk_mul_f32 v[250:251], v[250:251], s[40:41]
    v_pk_mul_f32 v[252:253], v[252:253], s[40:41]
    v_pk_mul_f32 v[254:255], v[254:255], s[40:41]
    v_cvt_pk_bf16_f32 v148, v248, v249
    v_cvt_pk_bf16_f32 v149, v250, v251
    v_cvt_pk_bf16_f32 v150, v252, v253
    v_cvt_pk_bf16_f32 v151, v254, v255
    ds_write_b128 v15, v[148:151] offset:128
    buffer_load_dwordx4 v[220:223], v14, s[20:23], s59 offen offset:3072 nt
    s_waitcnt lgkmcnt(2)
    v_mfma_f32_16x16x32_bf16 v[60:63], a[96:99], a[40:43], v[60:63]
    v_mfma_f32_16x16x32_bf16 v[60:63], a[104:107], a[44:47], v[60:63]
    v_mfma_f32_16x16x32_bf16 v[68:71], a[100:103], a[40:43], v[68:71]
    v_mfma_f32_16x16x32_bf16 v[68:71], a[108:111], a[44:47], v[68:71]
    s_waitcnt vmcnt(17)
    v_lshlrev_b32 v240, 16, v152
    v_and_b32 v241, s54, v152
    v_lshlrev_b32 v242, 16, v153
    v_and_b32 v243, s54, v153
    v_lshlrev_b32 v244, 16, v154
    v_and_b32 v245, s54, v154
    v_lshlrev_b32 v246, 16, v155
    v_and_b32 v247, s54, v155
    v_pk_mul_f32 v[240:241], v[240:241], s[40:41]
    v_pk_mul_f32 v[242:243], v[242:243], s[40:41]
    v_pk_mul_f32 v[244:245], v[244:245], s[40:41]
    v_pk_mul_f32 v[246:247], v[246:247], s[40:41]
    v_cvt_pk_bf16_f32 v152, v240, v241
    v_cvt_pk_bf16_f32 v153, v242, v243
    v_cvt_pk_bf16_f32 v154, v244, v245
    v_cvt_pk_bf16_f32 v155, v246, v247
    ds_read_b128 a[48:51], v6 offset:0
    ds_read_b128 a[52:55], v6 offset:1088
    ds_write_b128 v15, v[152:155] offset:2176
    buffer_load_dwordx4 v[224:227], v14, s[20:23], s59 offen offset:128 nt
    s_waitcnt vmcnt(17)
    v_lshlrev_b32 v248, 16, v156
    v_and_b32 v249, s54, v156
    v_lshlrev_b32 v250, 16, v157
    v_and_b32 v251, s54, v157
    v_lshlrev_b32 v252, 16, v158
    v_and_b32 v253, s54, v158
    v_lshlrev_b32 v254, 16, v159
    v_and_b32 v255, s54, v159
    v_pk_mul_f32 v[248:249], v[248:249], s[40:41]
    v_pk_mul_f32 v[250:251], v[250:251], s[40:41]
    v_pk_mul_f32 v[252:253], v[252:253], s[40:41]
    v_pk_mul_f32 v[254:255], v[254:255], s[40:41]
    v_cvt_pk_bf16_f32 v156, v248, v249
    v_cvt_pk_bf16_f32 v157, v250, v251
    v_cvt_pk_bf16_f32 v158, v252, v253
    v_cvt_pk_bf16_f32 v159, v254, v255
    ds_write_b128 v15, v[156:159] offset:2304
    buffer_load_dwordx4 v[228:231], v14, s[20:23], s59 offen offset:3200 nt
    s_waitcnt lgkmcnt(2)
    v_mfma_f32_16x16x32_bf16 v[72:75], v[52:55], a[48:51], 0
    v_mfma_f32_16x16x32_bf16 v[72:75], v[76:79], a[52:55], v[72:75]
    v_mfma_f32_16x16x32_bf16 v[80:83], v[64:67], a[48:51], 0
    v_mfma_f32_16x16x32_bf16 v[80:83], v[88:91], a[52:55], v[80:83]
    v_exp_f32 v60, v60
    v_exp_f32 v61, v61
    v_exp_f32 v62, v62
    v_exp_f32 v63, v63
    v_exp_f32 v68, v68
    v_exp_f32 v69, v69
    v_exp_f32 v70, v70
    v_exp_f32 v71, v71
    s_nop 0
    v_add_f32 v9, v9, v60
    v_add_f32 v9, v9, v61
    v_cvt_pk_bf16_f32 v60, v60, v61
    v_add_f32 v9, v9, v62
    v_add_f32 v9, v9, v63
    v_cvt_pk_bf16_f32 v61, v62, v63
    v_add_f32 v9, v9, v68
    v_add_f32 v9, v9, v69
    v_cvt_pk_bf16_f32 v62, v68, v69
    v_add_f32 v9, v9, v70
    v_add_f32 v9, v9, v71
    v_cvt_pk_bf16_f32 v63, v70, v71
    v_mfma_f32_32x32x16_bf16 v[96:111], a[124:127], a[124:127], 0
    v_mfma_f32_32x32x16_bf16 v[112:127], a[124:127], a[124:127], 0
    v_mfma_f32_32x32x16_bf16 v[128:143], a[124:127], a[124:127], 0
    s_waitcnt vmcnt(17)
    v_lshlrev_b32 v240, 16, v160
    v_and_b32 v241, s54, v160
    v_lshlrev_b32 v242, 16, v161
    v_and_b32 v243, s54, v161
    v_lshlrev_b32 v244, 16, v162
    v_and_b32 v245, s54, v162
    v_lshlrev_b32 v246, 16, v163
    v_and_b32 v247, s54, v163
    v_pk_mul_f32 v[240:241], v[240:241], s[40:41]
    v_pk_mul_f32 v[242:243], v[242:243], s[40:41]
    v_pk_mul_f32 v[244:245], v[244:245], s[40:41]
    v_pk_mul_f32 v[246:247], v[246:247], s[40:41]
    v_cvt_pk_bf16_f32 v160, v240, v241
    v_cvt_pk_bf16_f32 v161, v242, v243
    v_cvt_pk_bf16_f32 v162, v244, v245
    v_cvt_pk_bf16_f32 v163, v246, v247
    ds_read_b128 a[56:59], v6 offset:2176
    ds_read_b128 a[60:63], v6 offset:3264
    ds_write_b128 v15, v[160:163] offset:4352
    buffer_load_dwordx4 v[232:235], v14, s[20:23], s59 offen offset:256 nt
    s_waitcnt vmcnt(17)
    v_lshlrev_b32 v248, 16, v164
    v_and_b32 v249, s54, v164
    v_lshlrev_b32 v250, 16, v165
    v_and_b32 v251, s54, v165
    v_lshlrev_b32 v252, 16, v166
    v_and_b32 v253, s54, v166
    v_lshlrev_b32 v254, 16, v167
    v_and_b32 v255, s54, v167
    v_pk_mul_f32 v[248:249], v[248:249], s[40:41]
    v_pk_mul_f32 v[250:251], v[250:251], s[40:41]
    v_pk_mul_f32 v[252:253], v[252:253], s[40:41]
    v_pk_mul_f32 v[254:255], v[254:255], s[40:41]
    v_cvt_pk_bf16_f32 v164, v248, v249
    v_cvt_pk_bf16_f32 v165, v250, v251
    v_cvt_pk_bf16_f32 v166, v252, v253
    v_cvt_pk_bf16_f32 v167, v254, v255
    ds_write_b128 v15, v[164:167] offset:4480
    buffer_load_dwordx4 v[236:239], v14, s[20:23], s59 offen offset:3328 nt
    s_waitcnt lgkmcnt(2)
    v_mfma_f32_16x16x32_bf16 v[72:75], v[20:23], a[56:59], v[72:75]
    v_mfma_f32_16x16x32_bf16 v[72:75], v[28:31], a[60:63], v[72:75]
    v_mfma_f32_16x16x32_bf16 v[80:83], v[36:39], a[56:59], v[80:83]
    v_mfma_f32_16x16x32_bf16 v[80:83], v[44:47], a[60:63], v[80:83]
    s_waitcnt vmcnt(17)
    v_lshlrev_b32 v240, 16, v168
    v_and_b32 v241, s54, v168
    v_lshlrev_b32 v242, 16, v169
    v_and_b32 v243, s54, v169
    v_lshlrev_b32 v244, 16, v170
    v_and_b32 v245, s54, v170
    v_lshlrev_b32 v246, 16, v171
    v_and_b32 v247, s54, v171
    v_pk_mul_f32 v[240:241], v[240:241], s[40:41]
    v_pk_mul_f32 v[242:243], v[242:243], s[40:41]
    v_pk_mul_f32 v[244:245], v[244:245], s[40:41]
    v_pk_mul_f32 v[246:247], v[246:247], s[40:41]
    v_cvt_pk_bf16_f32 v168, v240, v241
    v_cvt_pk_bf16_f32 v169, v242, v243
    v_cvt_pk_bf16_f32 v170, v244, v245
    v_cvt_pk_bf16_f32 v171, v246, v247
    ds_read_b128 a[64:67], v6 offset:4352
    ds_read_b128 a[68:71], v6 offset:5440
    ds_write_b128 v15, v[168:171] offset:6528
    s_waitcnt vmcnt(16)
    v_lshlrev_b32 v248, 16, v172
    v_and_b32 v249, s54, v172
    v_lshlrev_b32 v250, 16, v173
    v_and_b32 v251, s54, v173
    v_lshlrev_b32 v252, 16, v174
    v_and_b32 v253, s54, v174
    v_lshlrev_b32 v254, 16, v175
    v_and_b32 v255, s54, v175
    v_pk_mul_f32 v[248:249], v[248:249], s[40:41]
    v_pk_mul_f32 v[250:251], v[250:251], s[40:41]
    v_pk_mul_f32 v[252:253], v[252:253], s[40:41]
    v_pk_mul_f32 v[254:255], v[254:255], s[40:41]
    v_cvt_pk_bf16_f32 v172, v248, v249
    v_cvt_pk_bf16_f32 v173, v250, v251
    v_cvt_pk_bf16_f32 v174, v252, v253
    v_cvt_pk_bf16_f32 v175, v254, v255
    ds_write_b128 v15, v[172:175] offset:6656
    s_waitcnt lgkmcnt(2)
    v_mfma_f32_16x16x32_bf16 v[72:75], a[96:99], a[64:67], v[72:75]
    v_mfma_f32_16x16x32_bf16 v[72:75], a[104:107], a[68:71], v[72:75]
    v_mfma_f32_16x16x32_bf16 v[80:83], a[100:103], a[64:67], v[80:83]
    v_mfma_f32_16x16x32_bf16 v[80:83], a[108:111], a[68:71], v[80:83]
    s_waitcnt vmcnt(15)
    v_lshlrev_b32 v240, 16, v176
    v_and_b32 v241, s54, v176
    v_lshlrev_b32 v242, 16, v177
    v_and_b32 v243, s54, v177
    v_lshlrev_b32 v244, 16, v178
    v_and_b32 v245, s54, v178
    v_lshlrev_b32 v246, 16, v179
    v_and_b32 v247, s54, v179
    v_pk_mul_f32 v[240:241], v[240:241], s[40:41]
    v_pk_mul_f32 v[242:243], v[242:243], s[40:41]
    v_pk_mul_f32 v[244:245], v[244:245], s[40:41]
    v_pk_mul_f32 v[246:247], v[246:247], s[40:41]
    v_cvt_pk_bf16_f32 v176, v240, v241
    v_cvt_pk_bf16_f32 v177, v242, v243
    v_cvt_pk_bf16_f32 v178, v244, v245
    v_cvt_pk_bf16_f32 v179, v246, v247
    ds_read_b128 a[72:75], v6 offset:6528
    ds_read_b128 a[76:79], v6 offset:7616
    ds_write_b128 v15, v[176:179] offset:8704
    s_waitcnt vmcnt(14)
    v_lshlrev_b32 v248, 16, v180
    v_and_b32 v249, s54, v180
    v_lshlrev_b32 v250, 16, v181
    v_and_b32 v251, s54, v181
    v_lshlrev_b32 v252, 16, v182
    v_and_b32 v253, s54, v182
    v_lshlrev_b32 v254, 16, v183
    v_and_b32 v255, s54, v183
    v_pk_mul_f32 v[248:249], v[248:249], s[40:41]
    v_pk_mul_f32 v[250:251], v[250:251], s[40:41]
    v_pk_mul_f32 v[252:253], v[252:253], s[40:41]
    v_pk_mul_f32 v[254:255], v[254:255], s[40:41]
    v_cvt_pk_bf16_f32 v180, v248, v249
    v_cvt_pk_bf16_f32 v181, v250, v251
    v_cvt_pk_bf16_f32 v182, v252, v253
    v_cvt_pk_bf16_f32 v183, v254, v255
    ds_write_b128 v15, v[180:183] offset:8832
    s_waitcnt lgkmcnt(2)
    v_mfma_f32_16x16x32_bf16 v[84:87], v[52:55], a[72:75], 0
    v_mfma_f32_16x16x32_bf16 v[84:87], v[76:79], a[76:79], v[84:87]
    v_mfma_f32_16x16x32_bf16 v[92:95], v[64:67], a[72:75], 0
    v_mfma_f32_16x16x32_bf16 v[92:95], v[88:91], a[76:79], v[92:95]
    v_exp_f32 v72, v72
    v_exp_f32 v73, v73
    v_exp_f32 v74, v74
    v_exp_f32 v75, v75
    v_exp_f32 v80, v80
    v_exp_f32 v81, v81
    v_exp_f32 v82, v82
    v_exp_f32 v83, v83
    s_nop 0
    v_add_f32 v10, v10, v72
    v_add_f32 v10, v10, v73
    v_cvt_pk_bf16_f32 v72, v72, v73
    v_add_f32 v10, v10, v74
    v_add_f32 v10, v10, v75
    v_cvt_pk_bf16_f32 v73, v74, v75
    v_add_f32 v10, v10, v80
    v_add_f32 v10, v10, v81
    v_cvt_pk_bf16_f32 v74, v80, v81
    v_add_f32 v10, v10, v82
    v_add_f32 v10, v10, v83
    v_cvt_pk_bf16_f32 v75, v82, v83
    s_waitcnt vmcnt(13)
    v_lshlrev_b32 v240, 16, v184
    v_and_b32 v241, s54, v184
    v_lshlrev_b32 v242, 16, v185
    v_and_b32 v243, s54, v185
    v_lshlrev_b32 v244, 16, v186
    v_and_b32 v245, s54, v186
    v_lshlrev_b32 v246, 16, v187
    v_and_b32 v247, s54, v187
    v_pk_mul_f32 v[240:241], v[240:241], s[40:41]
    v_pk_mul_f32 v[242:243], v[242:243], s[40:41]
    v_pk_mul_f32 v[244:245], v[244:245], s[40:41]
    v_pk_mul_f32 v[246:247], v[246:247], s[40:41]
    v_cvt_pk_bf16_f32 v184, v240, v241
    v_cvt_pk_bf16_f32 v185, v242, v243
    v_cvt_pk_bf16_f32 v186, v244, v245
    v_cvt_pk_bf16_f32 v187, v246, v247
    ds_read_b128 a[80:83], v6 offset:8704
    ds_read_b128 a[84:87], v6 offset:9792
    ds_write_b128 v15, v[184:187] offset:10880
    s_waitcnt vmcnt(12)
    v_lshlrev_b32 v248, 16, v188
    v_and_b32 v249, s54, v188
    v_lshlrev_b32 v250, 16, v189
    v_and_b32 v251, s54, v189
    v_lshlrev_b32 v252, 16, v190
    v_and_b32 v253, s54, v190
    v_lshlrev_b32 v254, 16, v191
    v_and_b32 v255, s54, v191
    v_pk_mul_f32 v[248:249], v[248:249], s[40:41]
    v_pk_mul_f32 v[250:251], v[250:251], s[40:41]
    v_pk_mul_f32 v[252:253], v[252:253], s[40:41]
    v_pk_mul_f32 v[254:255], v[254:255], s[40:41]
    v_cvt_pk_bf16_f32 v188, v248, v249
    v_cvt_pk_bf16_f32 v189, v250, v251
    v_cvt_pk_bf16_f32 v190, v252, v253
    v_cvt_pk_bf16_f32 v191, v254, v255
    ds_write_b128 v15, v[188:191] offset:11008
    s_waitcnt lgkmcnt(2)
    v_mfma_f32_16x16x32_bf16 v[84:87], v[20:23], a[80:83], v[84:87]
    v_mfma_f32_16x16x32_bf16 v[84:87], v[28:31], a[84:87], v[84:87]
    v_mfma_f32_16x16x32_bf16 v[92:95], v[36:39], a[80:83], v[92:95]
    v_mfma_f32_16x16x32_bf16 v[92:95], v[44:47], a[84:87], v[92:95]
    s_waitcnt vmcnt(11)
    v_lshlrev_b32 v240, 16, v192
    v_and_b32 v241, s54, v192
    v_lshlrev_b32 v242, 16, v193
    v_and_b32 v243, s54, v193
    v_lshlrev_b32 v244, 16, v194
    v_and_b32 v245, s54, v194
    v_lshlrev_b32 v246, 16, v195
    v_and_b32 v247, s54, v195
    v_pk_mul_f32 v[240:241], v[240:241], s[40:41]
    v_pk_mul_f32 v[242:243], v[242:243], s[40:41]
    v_pk_mul_f32 v[244:245], v[244:245], s[40:41]
    v_pk_mul_f32 v[246:247], v[246:247], s[40:41]
    v_cvt_pk_bf16_f32 v192, v240, v241
    v_cvt_pk_bf16_f32 v193, v242, v243
    v_cvt_pk_bf16_f32 v194, v244, v245
    v_cvt_pk_bf16_f32 v195, v246, v247
    ds_read_b128 a[88:91], v6 offset:10880
    ds_read_b128 a[92:95], v6 offset:11968
    ds_write_b128 v15, v[192:195] offset:0
    s_add_u32 m0, s52, 12288
    s_mov_b32 s48, 12288
    buffer_load_dwordx4 v7, s[24:27], s48 offen offset:0 nt lds
    s_waitcnt vmcnt(11)
    v_lshlrev_b32 v248, 16, v196
    v_and_b32 v249, s54, v196
    v_lshlrev_b32 v250, 16, v197
    v_and_b32 v251, s54, v197
    v_lshlrev_b32 v252, 16, v198
    v_and_b32 v253, s54, v198
    v_lshlrev_b32 v254, 16, v199
    v_and_b32 v255, s54, v199
    v_pk_mul_f32 v[248:249], v[248:249], s[40:41]
    v_pk_mul_f32 v[250:251], v[250:251], s[40:41]
    v_pk_mul_f32 v[252:253], v[252:253], s[40:41]
    v_pk_mul_f32 v[254:255], v[254:255], s[40:41]
    v_cvt_pk_bf16_f32 v196, v248, v249
    v_cvt_pk_bf16_f32 v197, v250, v251
    v_cvt_pk_bf16_f32 v198, v252, v253
    v_cvt_pk_bf16_f32 v199, v254, v255
    ds_write_b128 v15, v[196:199] offset:128
    s_add_u32 m0, s52, 16256
    s_mov_b32 s48, 12288
    buffer_load_dwordx4 v7, s[24:27], s48 offen offset:128 nt lds
    s_waitcnt lgkmcnt(2)
    v_mfma_f32_16x16x32_bf16 v[84:87], a[96:99], a[88:91], v[84:87]
    v_mfma_f32_16x16x32_bf16 v[84:87], a[104:107], a[92:95], v[84:87]
    v_mfma_f32_16x16x32_bf16 v[92:95], a[100:103], a[88:91], v[92:95]
    v_mfma_f32_16x16x32_bf16 v[92:95], a[108:111], a[92:95], v[92:95]
    s_waitcnt vmcnt(11)
    v_lshlrev_b32 v240, 16, v200
    v_and_b32 v241, s54, v200
    v_lshlrev_b32 v242, 16, v201
    v_and_b32 v243, s54, v201
    v_lshlrev_b32 v244, 16, v202
    v_and_b32 v245, s54, v202
    v_lshlrev_b32 v246, 16, v203
    v_and_b32 v247, s54, v203
    v_pk_mul_f32 v[240:241], v[240:241], s[40:41]
    v_pk_mul_f32 v[242:243], v[242:243], s[40:41]
    v_pk_mul_f32 v[244:245], v[244:245], s[40:41]
    v_pk_mul_f32 v[246:247], v[246:247], s[40:41]
    v_cvt_pk_bf16_f32 v200, v240, v241
    v_cvt_pk_bf16_f32 v201, v242, v243
    v_cvt_pk_bf16_f32 v202, v244, v245
    v_cvt_pk_bf16_f32 v203, v246, v247
    ds_read_b128 v[192:195], v6 offset:0
    ds_read_b128 v[196:199], v6 offset:1088
    ds_write_b128 v15, v[200:203] offset:2176
    s_add_u32 m0, s52, 20224
    s_mov_b32 s48, 12288
    buffer_load_dwordx4 v7, s[24:27], s48 offen offset:256 nt lds
    s_waitcnt vmcnt(11)
    v_lshlrev_b32 v248, 16, v204
    v_and_b32 v249, s54, v204
    v_lshlrev_b32 v250, 16, v205
    v_and_b32 v251, s54, v205
    v_lshlrev_b32 v252, 16, v206
    v_and_b32 v253, s54, v206
    v_lshlrev_b32 v254, 16, v207
    v_and_b32 v255, s54, v207
    v_pk_mul_f32 v[248:249], v[248:249], s[40:41]
    v_pk_mul_f32 v[250:251], v[250:251], s[40:41]
    v_pk_mul_f32 v[252:253], v[252:253], s[40:41]
    v_pk_mul_f32 v[254:255], v[254:255], s[40:41]
    v_cvt_pk_bf16_f32 v204, v248, v249
    v_cvt_pk_bf16_f32 v205, v250, v251
    v_cvt_pk_bf16_f32 v206, v252, v253
    v_cvt_pk_bf16_f32 v207, v254, v255
    ds_write_b128 v15, v[204:207] offset:2304
    s_add_u32 m0, s53, 0
    s_mov_b32 s48, 0
    buffer_load_dwordx4 v7, s[28:31], s48 offen offset:0 nt lds
    s_waitcnt lgkmcnt(2)
    v_mfma_f32_16x16x32_bf16 v[16:19], v[52:55], v[192:195], 0
    v_mfma_f32_16x16x32_bf16 v[16:19], v[76:79], v[196:199], v[16:19]
    v_mfma_f32_16x16x32_bf16 v[24:27], v[64:67], v[192:195], 0
    v_mfma_f32_16x16x32_bf16 v[24:27], v[88:91], v[196:199], v[24:27]
    v_exp_f32 v84, v84
    v_exp_f32 v85, v85
    v_exp_f32 v86, v86
    v_exp_f32 v87, v87
    v_exp_f32 v92, v92
    v_exp_f32 v93, v93
    v_exp_f32 v94, v94
    v_exp_f32 v95, v95
    s_nop 0
    v_add_f32 v11, v11, v84
    v_add_f32 v11, v11, v85
    v_cvt_pk_bf16_f32 v84, v84, v85
    v_add_f32 v11, v11, v86
    v_add_f32 v11, v11, v87
    v_cvt_pk_bf16_f32 v85, v86, v87
    v_add_f32 v11, v11, v92
    v_add_f32 v11, v11, v93
    v_cvt_pk_bf16_f32 v86, v92, v93
    v_add_f32 v11, v11, v94
    v_add_f32 v11, v11, v95
    v_cvt_pk_bf16_f32 v87, v94, v95
    v_mfma_f32_32x32x16_bf16 v[144:159], a[124:127], a[124:127], 0
    v_mfma_f32_32x32x16_bf16 v[160:175], a[124:127], a[124:127], 0
    v_mfma_f32_32x32x16_bf16 v[176:191], a[124:127], a[124:127], 0
    s_waitcnt vmcnt(11)
    v_lshlrev_b32 v240, 16, v208
    v_and_b32 v241, s54, v208
    v_lshlrev_b32 v242, 16, v209
    v_and_b32 v243, s54, v209
    v_lshlrev_b32 v244, 16, v210
    v_and_b32 v245, s54, v210
    v_lshlrev_b32 v246, 16, v211
    v_and_b32 v247, s54, v211
    v_pk_mul_f32 v[240:241], v[240:241], s[40:41]
    v_pk_mul_f32 v[242:243], v[242:243], s[40:41]
    v_pk_mul_f32 v[244:245], v[244:245], s[40:41]
    v_pk_mul_f32 v[246:247], v[246:247], s[40:41]
    v_cvt_pk_bf16_f32 v208, v240, v241
    v_cvt_pk_bf16_f32 v209, v242, v243
    v_cvt_pk_bf16_f32 v210, v244, v245
    v_cvt_pk_bf16_f32 v211, v246, v247
    ds_read_b128 v[200:203], v6 offset:2176
    ds_read_b128 v[204:207], v6 offset:3264
    ds_write_b128 v15, v[208:211] offset:4352
    s_add_u32 m0, s53, 3968
    s_mov_b32 s48, 0
    buffer_load_dwordx4 v7, s[28:31], s48 offen offset:128 nt lds
    s_waitcnt vmcnt(11)
    v_lshlrev_b32 v248, 16, v212
    v_and_b32 v249, s54, v212
    v_lshlrev_b32 v250, 16, v213
    v_and_b32 v251, s54, v213
    v_lshlrev_b32 v252, 16, v214
    v_and_b32 v253, s54, v214
    v_lshlrev_b32 v254, 16, v215
    v_and_b32 v255, s54, v215
    v_pk_mul_f32 v[248:249], v[248:249], s[40:41]
    v_pk_mul_f32 v[250:251], v[250:251], s[40:41]
    v_pk_mul_f32 v[252:253], v[252:253], s[40:41]
    v_pk_mul_f32 v[254:255], v[254:255], s[40:41]
    v_cvt_pk_bf16_f32 v212, v248, v249
    v_cvt_pk_bf16_f32 v213, v250, v251
    v_cvt_pk_bf16_f32 v214, v252, v253
    v_cvt_pk_bf16_f32 v215, v254, v255
    ds_write_b128 v15, v[212:215] offset:4480
    s_add_u32 m0, s53, 7936
    s_mov_b32 s48, 0
    buffer_load_dwordx4 v7, s[28:31], s48 offen offset:256 nt lds
    s_waitcnt lgkmcnt(2)
    v_mfma_f32_16x16x32_bf16 v[16:19], v[20:23], v[200:203], v[16:19]
    v_mfma_f32_16x16x32_bf16 v[16:19], v[28:31], v[204:207], v[16:19]
    v_mfma_f32_16x16x32_bf16 v[24:27], v[36:39], v[200:203], v[24:27]
    v_mfma_f32_16x16x32_bf16 v[24:27], v[44:47], v[204:207], v[24:27]
    s_waitcnt vmcnt(11)
    v_lshlrev_b32 v240, 16, v216
    v_and_b32 v241, s54, v216
    v_lshlrev_b32 v242, 16, v217
    v_and_b32 v243, s54, v217
    v_lshlrev_b32 v244, 16, v218
    v_and_b32 v245, s54, v218
    v_lshlrev_b32 v246, 16, v219
    v_and_b32 v247, s54, v219
    v_pk_mul_f32 v[240:241], v[240:241], s[40:41]
    v_pk_mul_f32 v[242:243], v[242:243], s[40:41]
    v_pk_mul_f32 v[244:245], v[244:245], s[40:41]
    v_pk_mul_f32 v[246:247], v[246:247], s[40:41]
    v_cvt_pk_bf16_f32 v216, v240, v241
    v_cvt_pk_bf16_f32 v217, v242, v243
    v_cvt_pk_bf16_f32 v218, v244, v245
    v_cvt_pk_bf16_f32 v219, v246, v247
    ds_read_b128 v[208:211], v6 offset:4352
    ds_read_b128 v[212:215], v6 offset:5440
    ds_write_b128 v15, v[216:219] offset:6528
    s_add_u32 m0, s52, 24576
    s_mov_b32 s48, 24576
    buffer_load_dwordx4 v7, s[24:27], s48 offen offset:0 nt lds
    s_waitcnt vmcnt(11)
    v_lshlrev_b32 v248, 16, v220
    v_and_b32 v249, s54, v220
    v_lshlrev_b32 v250, 16, v221
    v_and_b32 v251, s54, v221
    v_lshlrev_b32 v252, 16, v222
    v_and_b32 v253, s54, v222
    v_lshlrev_b32 v254, 16, v223
    v_and_b32 v255, s54, v223
    v_pk_mul_f32 v[248:249], v[248:249], s[40:41]
    v_pk_mul_f32 v[250:251], v[250:251], s[40:41]
    v_pk_mul_f32 v[252:253], v[252:253], s[40:41]
    v_pk_mul_f32 v[254:255], v[254:255], s[40:41]
    v_cvt_pk_bf16_f32 v220, v248, v249
    v_cvt_pk_bf16_f32 v221, v250, v251
    v_cvt_pk_bf16_f32 v222, v252, v253
    v_cvt_pk_bf16_f32 v223, v254, v255
    ds_write_b128 v15, v[220:223] offset:6656
    s_add_u32 m0, s52, 28544
    s_mov_b32 s48, 24576
    buffer_load_dwordx4 v7, s[24:27], s48 offen offset:128 nt lds
    s_waitcnt lgkmcnt(2)
    v_mfma_f32_16x16x32_bf16 v[16:19], a[96:99], v[208:211], v[16:19]
    v_mfma_f32_16x16x32_bf16 v[16:19], a[104:107], v[212:215], v[16:19]
    v_mfma_f32_16x16x32_bf16 v[24:27], a[100:103], v[208:211], v[24:27]
    v_mfma_f32_16x16x32_bf16 v[24:27], a[108:111], v[212:215], v[24:27]
    s_waitcnt vmcnt(11)
    v_lshlrev_b32 v240, 16, v224
    v_and_b32 v241, s54, v224
    v_lshlrev_b32 v242, 16, v225
    v_and_b32 v243, s54, v225
    v_lshlrev_b32 v244, 16, v226
    v_and_b32 v245, s54, v226
    v_lshlrev_b32 v246, 16, v227
    v_and_b32 v247, s54, v227
    v_pk_mul_f32 v[240:241], v[240:241], s[40:41]
    v_pk_mul_f32 v[242:243], v[242:243], s[40:41]
    v_pk_mul_f32 v[244:245], v[244:245], s[40:41]
    v_pk_mul_f32 v[246:247], v[246:247], s[40:41]
    v_cvt_pk_bf16_f32 v224, v240, v241
    v_cvt_pk_bf16_f32 v225, v242, v243
    v_cvt_pk_bf16_f32 v226, v244, v245
    v_cvt_pk_bf16_f32 v227, v246, v247
    ds_read_b128 v[216:219], v6 offset:6528
    ds_read_b128 v[220:223], v6 offset:7616
    ds_write_b128 v15, v[224:227] offset:8704
    s_add_u32 m0, s52, 32512
    s_mov_b32 s48, 24576
    buffer_load_dwordx4 v7, s[24:27], s48 offen offset:256 nt lds
    s_waitcnt vmcnt(11)
    v_lshlrev_b32 v248, 16, v228
    v_and_b32 v249, s54, v228
    v_lshlrev_b32 v250, 16, v229
    v_and_b32 v251, s54, v229
    v_lshlrev_b32 v252, 16, v230
    v_and_b32 v253, s54, v230
    v_lshlrev_b32 v254, 16, v231
    v_and_b32 v255, s54, v231
    v_pk_mul_f32 v[248:249], v[248:249], s[40:41]
    v_pk_mul_f32 v[250:251], v[250:251], s[40:41]
    v_pk_mul_f32 v[252:253], v[252:253], s[40:41]
    v_pk_mul_f32 v[254:255], v[254:255], s[40:41]
    v_cvt_pk_bf16_f32 v228, v248, v249
    v_cvt_pk_bf16_f32 v229, v250, v251
    v_cvt_pk_bf16_f32 v230, v252, v253
    v_cvt_pk_bf16_f32 v231, v254, v255
    ds_write_b128 v15, v[228:231] offset:8832
    s_waitcnt lgkmcnt(2)
    v_mfma_f32_16x16x32_bf16 v[32:35], v[52:55], v[216:219], 0
    v_mfma_f32_16x16x32_bf16 v[32:35], v[76:79], v[220:223], v[32:35]
    v_mfma_f32_16x16x32_bf16 v[40:43], v[64:67], v[216:219], 0
    v_mfma_f32_16x16x32_bf16 v[40:43], v[88:91], v[220:223], v[40:43]
    v_mfma_f32_32x32x16_bf16 v[192:207], a[124:127], a[124:127], 0
    v_mfma_f32_32x32x16_bf16 v[208:223], a[124:127], a[124:127], 0
    s_waitcnt vmcnt(10)
    v_lshlrev_b32 v240, 16, v232
    v_and_b32 v241, s54, v232
    v_lshlrev_b32 v242, 16, v233
    v_and_b32 v243, s54, v233
    v_lshlrev_b32 v244, 16, v234
    v_and_b32 v245, s54, v234
    v_lshlrev_b32 v246, 16, v235
    v_and_b32 v247, s54, v235
    v_pk_mul_f32 v[240:241], v[240:241], s[40:41]
    v_pk_mul_f32 v[242:243], v[242:243], s[40:41]
    v_pk_mul_f32 v[244:245], v[244:245], s[40:41]
    v_pk_mul_f32 v[246:247], v[246:247], s[40:41]
    v_cvt_pk_bf16_f32 v232, v240, v241
    v_cvt_pk_bf16_f32 v233, v242, v243
    v_cvt_pk_bf16_f32 v234, v244, v245
    v_cvt_pk_bf16_f32 v235, v246, v247
    ds_read_b128 v[224:227], v6 offset:8704
    ds_read_b128 v[228:231], v6 offset:9792
    ds_write_b128 v15, v[232:235] offset:10880
    s_waitcnt vmcnt(9)
    v_lshlrev_b32 v248, 16, v236
    v_and_b32 v249, s54, v236
    v_lshlrev_b32 v250, 16, v237
    v_and_b32 v251, s54, v237
    v_lshlrev_b32 v252, 16, v238
    v_and_b32 v253, s54, v238
    v_lshlrev_b32 v254, 16, v239
    v_and_b32 v255, s54, v239
    v_pk_mul_f32 v[248:249], v[248:249], s[40:41]
    v_pk_mul_f32 v[250:251], v[250:251], s[40:41]
    v_pk_mul_f32 v[252:253], v[252:253], s[40:41]
    v_pk_mul_f32 v[254:255], v[254:255], s[40:41]
    v_cvt_pk_bf16_f32 v236, v248, v249
    v_cvt_pk_bf16_f32 v237, v250, v251
    v_cvt_pk_bf16_f32 v238, v252, v253
    v_cvt_pk_bf16_f32 v239, v254, v255
    ds_write_b128 v15, v[236:239] offset:11008
    ds_read_b128 v[232:235], v6 offset:10880
    ds_read_b128 v[236:239], v6 offset:11968
    s_add_u32 m0, s53, 12288
    s_mov_b32 s48, 12288
    buffer_load_dwordx4 v7, s[28:31], s48 offen offset:0 nt lds
    s_add_u32 m0, s53, 16256
    s_mov_b32 s48, 12288
    buffer_load_dwordx4 v7, s[28:31], s48 offen offset:128 nt lds
    s_add_u32 m0, s53, 20224
    s_mov_b32 s48, 12288
    buffer_load_dwordx4 v7, s[28:31], s48 offen offset:256 nt lds
    s_waitcnt lgkmcnt(4)
    v_mfma_f32_16x16x32_bf16 v[32:35], v[20:23], v[224:227], v[32:35]
    v_mfma_f32_16x16x32_bf16 v[32:35], v[28:31], v[228:231], v[32:35]
    v_mfma_f32_16x16x32_bf16 v[40:43], v[36:39], v[224:227], v[40:43]
    v_mfma_f32_16x16x32_bf16 v[40:43], v[44:47], v[228:231], v[40:43]
    s_waitcnt lgkmcnt(0)
    v_mfma_f32_16x16x32_bf16 v[32:35], a[96:99], v[232:235], v[32:35]
    v_mfma_f32_16x16x32_bf16 v[32:35], a[104:107], v[236:239], v[32:35]
    v_mfma_f32_16x16x32_bf16 v[40:43], a[100:103], v[232:235], v[40:43]
    v_mfma_f32_16x16x32_bf16 v[40:43], a[108:111], v[236:239], v[40:43]
    v_mfma_f32_32x32x16_bf16 v[240:255], a[124:127], a[124:127], 0
    v_mfma_f32_32x32x16_bf16 v[224:239], a[124:127], a[124:127], 0
    s_add_u32 m0, s52, 0
    s_mov_b32 s48, 36864
    buffer_load_dwordx4 v7, s[24:27], s48 offen offset:0 nt lds
    s_add_u32 m0, s52, 3968
    s_mov_b32 s48, 36864
    buffer_load_dwordx4 v7, s[24:27], s48 offen offset:128 nt lds
    s_add_u32 m0, s52, 7936
    s_mov_b32 s48, 36864
    buffer_load_dwordx4 v7, s[24:27], s48 offen offset:256 nt lds
    s_waitcnt vmcnt(12)
    s_barrier
    v_add_u32 v0, 12288, v0
    v_add_u32 v1, 12288, v1
    ds_read_b128 a[96:99], v0 offset:0
    ds_read_b128 a[100:103], v1 offset:0
    ds_read_b128 a[112:115], v6 offset:0
    ds_read_b128 a[116:119], v6 offset:1088
    ds_read_b128 a[120:123], v6 offset:6528
    ds_read_b128 a[124:127], v6 offset:7616
    s_waitcnt lgkmcnt(0)
    v_mfma_f32_16x16x32_bf16 v[52:55], a[96:99], a[0:3], 0
    ds_read_b128 a[104:107], v0 offset:2048
    v_mfma_f32_16x16x32_bf16 v[52:55], a[100:103], a[4:7], v[52:55]
    s_mov_b32 s83, 0
    v_exp_f32 v16, v16
    v_mfma_f32_16x16x32_bf16 v[64:67], a[96:99], a[24:27], 0
    s_mov_b32 s93, s90
    ds_read_b128 a[108:111], v1 offset:2048
    v_mfma_f32_16x16x32_bf16 v[64:67], a[100:103], a[28:31], v[64:67]
    s_mov_b32 s82, 2
    v_exp_f32 v17, v17
    v_mfma_f32_16x16x32_bf16 v[76:79], a[96:99], a[48:51], 0
    s_mov_b32 s92, s91
    v_add_f32 v12, v12, v16
    v_add_f32 v12, v12, v17
    v_mfma_f32_16x16x32_bf16 v[76:79], a[100:103], a[52:55], v[76:79]
    v_cvt_pk_bf16_f32 v16, v16, v17
    v_mfma_f32_16x16x32_bf16 v[88:91], a[96:99], a[72:75], 0
    v_exp_f32 v18, v18
    v_mfma_f32_16x16x32_bf16 v[88:91], a[100:103], a[76:79], v[88:91]
    v_mfma_f32_16x16x32_bf16 v[20:23], a[96:99], a[112:115], 0
    v_exp_f32 v19, v19
    v_mfma_f32_16x16x32_bf16 v[20:23], a[100:103], a[116:119], v[20:23]
    v_add_f32 v12, v12, v18
    v_mfma_f32_16x16x32_bf16 v[36:39], a[96:99], a[120:123], 0
    v_add_f32 v12, v12, v19
    v_mfma_f32_16x16x32_bf16 v[36:39], a[100:103], a[124:127], v[36:39]
    s_waitcnt lgkmcnt(1)
    v_cvt_pk_bf16_f32 v17, v18, v19
    v_mfma_f32_16x16x32_bf16 v[44:47], a[104:107], a[120:123], 0
    s_waitcnt lgkmcnt(0)
    ds_read_b128 a[96:99], v0 offset:4096
    v_mfma_f32_16x16x32_bf16 v[44:47], a[108:111], a[124:127], v[44:47]
    ds_read_b128 a[120:123], v6 offset:8704
    v_mfma_f32_16x16x32_bf16 v[28:31], a[104:107], a[112:115], 0
    ds_read_b128 a[100:103], v1 offset:4096
    v_mfma_f32_16x16x32_bf16 v[28:31], a[108:111], a[116:119], v[28:31]
    ds_read_b128 a[124:127], v6 offset:9792
    v_mfma_f32_16x16x32_bf16 v[92:95], a[104:107], a[72:75], 0
    v_exp_f32 v24, v24
    v_mfma_f32_16x16x32_bf16 v[92:95], a[108:111], a[76:79], v[92:95]
    ds_read_b128 a[112:115], v6 offset:2176
    v_add_f32 v12, v12, v24
    v_mfma_f32_16x16x32_bf16 v[80:83], a[104:107], a[48:51], 0
    v_exp_f32 v25, v25
    v_mfma_f32_16x16x32_bf16 v[80:83], a[108:111], a[52:55], v[80:83]
    ds_read_b128 a[116:119], v6 offset:3264
    v_add_f32 v12, v12, v25
    v_mfma_f32_16x16x32_bf16 v[68:71], a[104:107], a[24:27], 0
    v_exp_f32 v26, v26
    v_mfma_f32_16x16x32_bf16 v[68:71], a[108:111], a[28:31], v[68:71]
    v_exp_f32 v27, v27
    v_mfma_f32_16x16x32_bf16 v[56:59], a[104:107], a[0:3], 0
    v_cvt_pk_bf16_f32 v18, v24, v25
    v_add_f32 v12, v12, v26
    v_mfma_f32_16x16x32_bf16 v[56:59], a[108:111], a[4:7], v[56:59]
    s_waitcnt lgkmcnt(5)
    v_add_f32 v12, v12, v27
    v_mfma_f32_16x16x32_bf16 v[52:55], a[96:99], a[8:11], v[52:55]
    s_waitcnt lgkmcnt(3)
    ds_read_b128 a[104:107], v0 offset:6144
    v_cvt_pk_bf16_f32 v19, v26, v27
    v_mfma_f32_16x16x32_bf16 v[52:55], a[100:103], a[12:15], v[52:55]
    v_exp_f32 v32, v32
    v_mfma_f32_16x16x32_bf16 v[64:67], a[96:99], a[32:35], v[64:67]
    ds_read_b128 a[108:111], v1 offset:6144
    v_mfma_f32_16x16x32_bf16 v[64:67], a[100:103], a[36:39], v[64:67]
    v_exp_f32 v33, v33
    v_mfma_f32_16x16x32_bf16 v[76:79], a[96:99], a[56:59], v[76:79]
    v_add_f32 v13, v13, v32
    v_mfma_f32_16x16x32_bf16 v[76:79], a[100:103], a[60:63], v[76:79]
    v_add_f32 v13, v13, v33
    v_mfma_f32_16x16x32_bf16 v[88:91], a[96:99], a[80:83], v[88:91]
    v_cvt_pk_bf16_f32 v32, v32, v33
    v_mfma_f32_16x16x32_bf16 v[88:91], a[100:103], a[84:87], v[88:91]
    s_waitcnt lgkmcnt(3)
    v_exp_f32 v34, v34
    v_mfma_f32_16x16x32_bf16 v[20:23], a[96:99], a[112:115], v[20:23]
    s_waitcnt lgkmcnt(2)
    v_mfma_f32_16x16x32_bf16 v[20:23], a[100:103], a[116:119], v[20:23]
    v_exp_f32 v35, v35
    v_mfma_f32_16x16x32_bf16 v[36:39], a[96:99], a[120:123], v[36:39]
    v_add_f32 v13, v13, v34
    v_mfma_f32_16x16x32_bf16 v[36:39], a[100:103], a[124:127], v[36:39]
    s_waitcnt lgkmcnt(1)
    v_add_f32 v13, v13, v35
    v_mfma_f32_16x16x32_bf16 v[44:47], a[104:107], a[120:123], v[44:47]
    s_waitcnt lgkmcnt(0)
    ds_read_b128 a[96:99], v0 offset:8192
    v_cvt_pk_bf16_f32 v33, v34, v35
    v_mfma_f32_16x16x32_bf16 v[44:47], a[108:111], a[124:127], v[44:47]
    ds_read_b128 a[120:123], v6 offset:10880
    v_mfma_f32_16x16x32_bf16 v[28:31], a[104:107], a[112:115], v[28:31]
    ds_read_b128 a[100:103], v1 offset:8192
    v_mfma_f32_16x16x32_bf16 v[28:31], a[108:111], a[116:119], v[28:31]
    ds_read_b128 a[124:127], v6 offset:11968
    v_mfma_f32_16x16x32_bf16 v[92:95], a[104:107], a[80:83], v[92:95]
    v_exp_f32 v40, v40
    v_mfma_f32_16x16x32_bf16 v[92:95], a[108:111], a[84:87], v[92:95]
    ds_read_b128 a[112:115], v6 offset:4352
    v_add_f32 v13, v13, v40
    v_mfma_f32_16x16x32_bf16 v[80:83], a[104:107], a[56:59], v[80:83]
    v_exp_f32 v41, v41
    v_mfma_f32_16x16x32_bf16 v[80:83], a[108:111], a[60:63], v[80:83]
    ds_read_b128 a[116:119], v6 offset:5440
    v_add_f32 v13, v13, v41
    v_mfma_f32_16x16x32_bf16 v[68:71], a[104:107], a[32:35], v[68:71]
    v_exp_f32 v42, v42
    v_mfma_f32_16x16x32_bf16 v[68:71], a[108:111], a[36:39], v[68:71]
    v_exp_f32 v43, v43
    v_mfma_f32_16x16x32_bf16 v[56:59], a[104:107], a[8:11], v[56:59]
    v_cvt_pk_bf16_f32 v34, v40, v41
    v_add_u32 v2, s93, v2
    v_mfma_f32_16x16x32_bf16 v[56:59], a[108:111], a[12:15], v[56:59]
    s_waitcnt lgkmcnt(5)
    v_add_f32 v13, v13, v42
    v_add_u32 v3, s93, v3
    v_mfma_f32_16x16x32_bf16 v[52:55], a[96:99], a[16:19], v[52:55]
    s_waitcnt lgkmcnt(3)
    ds_read_b128 a[104:107], v0 offset:10240
    v_add_f32 v13, v13, v43
    v_mfma_f32_16x16x32_bf16 v[52:55], a[100:103], a[20:23], v[52:55]
    v_cvt_pk_bf16_f32 v35, v42, v43
    v_add_u32 v4, s93, v4
    v_mfma_f32_16x16x32_bf16 v[64:67], a[96:99], a[40:43], v[64:67]
    ds_read_b128 a[108:111], v1 offset:10240
    v_add_u32 v5, s93, v5
    v_mfma_f32_16x16x32_bf16 v[64:67], a[100:103], a[44:47], v[64:67]
    v_mfma_f32_16x16x32_bf16 v[76:79], a[96:99], a[64:67], v[76:79]
    v_add_u32 v0, s92, v0
    v_add_u32 v1, s92, v1
    v_mfma_f32_16x16x32_bf16 v[76:79], a[100:103], a[68:71], v[76:79]
    v_mfma_f32_16x16x32_bf16 v[88:91], a[96:99], a[88:91], v[88:91]
    v_mfma_f32_16x16x32_bf16 v[88:91], a[100:103], a[92:95], v[88:91]
    s_waitcnt lgkmcnt(3)
    v_exp_f32 v52, v52
    v_mfma_f32_16x16x32_bf16 v[20:23], a[96:99], a[112:115], v[20:23]
    s_waitcnt lgkmcnt(2)
    v_exp_f32 v53, v53
    v_mfma_f32_16x16x32_bf16 v[20:23], a[100:103], a[116:119], v[20:23]
    s_waitcnt vmcnt(9) lgkmcnt(0)
    v_mfma_f32_16x16x32_bf16 v[36:39], a[96:99], a[120:123], v[36:39]
    s_barrier
    v_mfma_f32_16x16x32_bf16 v[36:39], a[100:103], a[124:127], v[36:39]
    s_waitcnt lgkmcnt(1)
    v_add_f32 v8, v8, v52
    v_add_f32 v8, v8, v53
    v_mfma_f32_16x16x32_bf16 v[44:47], a[104:107], a[120:123], v[44:47]
    s_waitcnt lgkmcnt(0)
    ds_read_b64_tr_b16 a[96:97], v2 offset:0
    ds_read_b64_tr_b16 a[98:99], v2 offset:2048
    v_mfma_f32_16x16x32_bf16 v[44:47], a[108:111], a[124:127], v[44:47]
    ds_read_b128 a[120:123], v6 offset:6528
    v_cvt_pk_bf16_f32 v52, v52, v53
    v_mfma_f32_16x16x32_bf16 v[28:31], a[104:107], a[112:115], v[28:31]
    v_exp_f32 v54, v54
    v_mfma_f32_16x16x32_bf16 v[28:31], a[108:111], a[116:119], v[28:31]
    ds_read_b64_tr_b16 a[100:101], v3 offset:0
    ds_read_b64_tr_b16 a[102:103], v3 offset:2048
    v_mfma_f32_16x16x32_bf16 v[92:95], a[104:107], a[88:91], v[92:95]
    ds_read_b128 a[124:127], v6 offset:7616
    v_add_f32 v8, v8, v54
    v_mfma_f32_16x16x32_bf16 v[92:95], a[108:111], a[92:95], v[92:95]
    v_exp_f32 v55, v55
    v_mfma_f32_16x16x32_bf16 v[80:83], a[104:107], a[64:67], v[80:83]
    ds_read_b128 a[112:115], v6 offset:0
    v_add_f32 v8, v8, v55
    v_mfma_f32_16x16x32_bf16 v[80:83], a[108:111], a[68:71], v[80:83]
    v_exp_f32 v64, v64
    v_mfma_f32_16x16x32_bf16 v[68:71], a[104:107], a[40:43], v[68:71]
    ds_read_b128 a[116:119], v6 offset:1088
    v_cvt_pk_bf16_f32 v53, v54, v55
    v_mfma_f32_16x16x32_bf16 v[68:71], a[108:111], a[44:47], v[68:71]
    v_exp_f32 v65, v65
    v_mfma_f32_16x16x32_bf16 v[56:59], a[104:107], a[16:19], v[56:59]
    s_add_u32 m0, s46, 0
    v_exp_f32 v66, v66
    v_mfma_f32_16x16x32_bf16 v[56:59], a[108:111], a[20:23], v[56:59]
    s_waitcnt lgkmcnt(6)
    buffer_load_dwordx4 v7, s[28:31], s44 offen offset:0 nt lds
    v_mfma_f32_16x16x32_bf16 v[96:99], a[96:99], v[48:51], v[96:99]
    ds_read_b64_tr_b16 a[104:105], v4 offset:0
    ds_read_b64_tr_b16 a[106:107], v4 offset:2048
    v_mfma_f32_16x16x32_bf16 v[144:147], a[96:99], v[60:63], v[144:147]
    v_exp_f32 v67, v67
    v_mfma_f32_16x16x32_bf16 v[192:195], a[96:99], v[72:75], v[192:195]
    v_add_f32 v9, v9, v64
    v_add_f32 v9, v9, v65
    v_mfma_f32_16x16x32_bf16 v[240:243], a[96:99], v[84:87], v[240:243]
    ds_read_b64_tr_b16 a[108:109], v5 offset:0
    ds_read_b64_tr_b16 a[110:111], v5 offset:2048
    v_mfma_f32_16x16x32_bf16 a[160:163], a[96:99], v[16:19], a[160:163]
    v_exp_f32 v76, v76
    v_mfma_f32_16x16x32_bf16 a[208:211], a[96:99], v[32:35], a[208:211]
    s_waitcnt lgkmcnt(7)
    v_exp_f32 v77, v77
    v_mfma_f32_16x16x32_bf16 v[100:103], a[100:103], v[48:51], v[100:103]
    ds_read_b64_tr_b16 a[96:97], v2 offset:4096
    ds_read_b64_tr_b16 a[98:99], v2 offset:6144
    v_mfma_f32_16x16x32_bf16 v[148:151], a[100:103], v[60:63], v[148:151]
    v_cvt_pk_bf16_f32 v64, v64, v65
    v_add_f32 v9, v9, v66
    v_mfma_f32_16x16x32_bf16 v[196:199], a[100:103], v[72:75], v[196:199]
    s_add_u32 m0, s46, 3968
    v_add_f32 v9, v9, v67
    v_cvt_pk_bf16_f32 v65, v66, v67
    v_mfma_f32_16x16x32_bf16 v[244:247], a[100:103], v[84:87], v[244:247]
    buffer_load_dwordx4 v7, s[28:31], s44 offen offset:128 nt lds
    v_mfma_f32_16x16x32_bf16 a[164:167], a[100:103], v[16:19], a[164:167]
    v_exp_f32 v78, v78
    v_mfma_f32_16x16x32_bf16 a[212:215], a[100:103], v[32:35], a[212:215]
    s_waitcnt lgkmcnt(4)
    v_exp_f32 v79, v79
    v_mfma_f32_16x16x32_bf16 v[104:107], a[104:107], v[48:51], v[104:107]
    ds_read_b64_tr_b16 a[100:101], v3 offset:4096
    ds_read_b64_tr_b16 a[102:103], v3 offset:6144
    v_mfma_f32_16x16x32_bf16 v[152:155], a[104:107], v[60:63], v[152:155]
    v_add_f32 v10, v10, v76
    v_add_f32 v10, v10, v77
    v_mfma_f32_16x16x32_bf16 v[200:203], a[104:107], v[72:75], v[200:203]
    v_exp_f32 v88, v88
    v_mfma_f32_16x16x32_bf16 v[248:251], a[104:107], v[84:87], v[248:251]
    v_cvt_pk_bf16_f32 v76, v76, v77
    v_add_f32 v10, v10, v78
    v_mfma_f32_16x16x32_bf16 a[168:171], a[104:107], v[16:19], a[168:171]
    v_exp_f32 v89, v89
    v_mfma_f32_16x16x32_bf16 a[216:219], a[104:107], v[32:35], a[216:219]
    s_waitcnt lgkmcnt(4)
    v_add_f32 v10, v10, v79
    v_cvt_pk_bf16_f32 v77, v78, v79
    v_mfma_f32_16x16x32_bf16 v[108:111], a[108:111], v[48:51], v[108:111]
    ds_read_b64_tr_b16 a[104:105], v4 offset:4096
    ds_read_b64_tr_b16 a[106:107], v4 offset:6144
    v_mfma_f32_16x16x32_bf16 v[156:159], a[108:111], v[60:63], v[156:159]
    v_add_f32 v11, v11, v88
    v_add_f32 v11, v11, v89
    v_mfma_f32_16x16x32_bf16 v[204:207], a[108:111], v[72:75], v[204:207]
    s_add_u32 m0, s46, 7936
    v_exp_f32 v90, v90
    v_mfma_f32_16x16x32_bf16 v[252:255], a[108:111], v[84:87], v[252:255]
    buffer_load_dwordx4 v7, s[28:31], s44 offen offset:256 nt lds
    v_mfma_f32_16x16x32_bf16 a[172:175], a[108:111], v[16:19], a[172:175]
    v_exp_f32 v91, v91
    v_mfma_f32_16x16x32_bf16 a[220:223], a[108:111], v[32:35], a[220:223]
    s_waitcnt lgkmcnt(4)
    v_cvt_pk_bf16_f32 v88, v88, v89
    v_add_f32 v11, v11, v90
    v_mfma_f32_16x16x32_bf16 v[112:115], a[96:99], v[48:51], v[112:115]
    ds_read_b64_tr_b16 a[108:109], v5 offset:4096
    ds_read_b64_tr_b16 a[110:111], v5 offset:6144
    v_mfma_f32_16x16x32_bf16 v[160:163], a[96:99], v[60:63], v[160:163]
    v_exp_f32 v92, v92
    v_mfma_f32_16x16x32_bf16 v[208:211], a[96:99], v[72:75], v[208:211]
    v_add_f32 v11, v11, v91
    v_cvt_pk_bf16_f32 v89, v90, v91
    v_mfma_f32_16x16x32_bf16 a[128:131], a[96:99], v[84:87], a[128:131]
    v_exp_f32 v93, v93
    v_mfma_f32_16x16x32_bf16 a[176:179], a[96:99], v[16:19], a[176:179]
    v_add_f32 v11, v11, v92
    v_mfma_f32_16x16x32_bf16 a[224:227], a[96:99], v[32:35], a[224:227]
    s_waitcnt lgkmcnt(4)
    v_add_f32 v11, v11, v93
    v_mfma_f32_16x16x32_bf16 v[116:119], a[100:103], v[48:51], v[116:119]
    ds_read_b64_tr_b16 a[96:97], v2 offset:8192
    ds_read_b64_tr_b16 a[98:99], v2 offset:10240
    v_mfma_f32_16x16x32_bf16 v[164:167], a[100:103], v[60:63], v[164:167]
    v_exp_f32 v94, v94
    v_mfma_f32_16x16x32_bf16 v[212:215], a[100:103], v[72:75], v[212:215]
    s_add_u32 m0, s45, 0
    v_exp_f32 v95, v95
    v_mfma_f32_16x16x32_bf16 a[132:135], a[100:103], v[84:87], a[132:135]
    buffer_load_dwordx4 v7, s[24:27], s43 offen offset:0 nt lds
    v_mfma_f32_16x16x32_bf16 a[180:183], a[100:103], v[16:19], a[180:183]
    v_cvt_pk_bf16_f32 v90, v92, v93
    v_add_f32 v11, v11, v94
    v_mfma_f32_16x16x32_bf16 a[228:231], a[100:103], v[32:35], a[228:231]
    s_waitcnt lgkmcnt(4)
    v_add_f32 v11, v11, v95
    v_cvt_pk_bf16_f32 v91, v94, v95
    v_mfma_f32_16x16x32_bf16 v[120:123], a[104:107], v[48:51], v[120:123]
    ds_read_b64_tr_b16 a[100:101], v3 offset:8192
    ds_read_b64_tr_b16 a[102:103], v3 offset:10240
    v_mfma_f32_16x16x32_bf16 v[168:171], a[104:107], v[60:63], v[168:171]
    v_exp_f32 v80, v80
    v_mfma_f32_16x16x32_bf16 v[216:219], a[104:107], v[72:75], v[216:219]
    v_exp_f32 v81, v81
    v_mfma_f32_16x16x32_bf16 a[136:139], a[104:107], v[84:87], a[136:139]
    v_add_f32 v10, v10, v80
    v_add_f32 v10, v10, v81
    v_mfma_f32_16x16x32_bf16 a[184:187], a[104:107], v[16:19], a[184:187]
    v_cvt_pk_bf16_f32 v78, v80, v81
    v_mfma_f32_16x16x32_bf16 a[232:235], a[104:107], v[32:35], a[232:235]
    s_waitcnt lgkmcnt(4)
    v_exp_f32 v82, v82
    v_mfma_f32_16x16x32_bf16 v[124:127], a[108:111], v[48:51], v[124:127]
    ds_read_b64_tr_b16 a[104:105], v4 offset:8192
    ds_read_b64_tr_b16 a[106:107], v4 offset:10240
    v_mfma_f32_16x16x32_bf16 v[172:175], a[108:111], v[60:63], v[172:175]
    v_exp_f32 v83, v83
    v_mfma_f32_16x16x32_bf16 v[220:223], a[108:111], v[72:75], v[220:223]
    s_add_u32 m0, s45, 3968
    v_add_f32 v10, v10, v82
    v_mfma_f32_16x16x32_bf16 a[140:143], a[108:111], v[84:87], a[140:143]
    buffer_load_dwordx4 v7, s[24:27], s43 offen offset:128 nt lds
    v_mfma_f32_16x16x32_bf16 a[188:191], a[108:111], v[16:19], a[188:191]
    v_exp_f32 v68, v68
    v_mfma_f32_16x16x32_bf16 a[236:239], a[108:111], v[32:35], a[236:239]
    s_waitcnt lgkmcnt(4)
    v_add_f32 v10, v10, v83
    v_cvt_pk_bf16_f32 v79, v82, v83
    v_mfma_f32_16x16x32_bf16 v[128:131], a[96:99], v[48:51], v[128:131]
    ds_read_b64_tr_b16 a[108:109], v5 offset:8192
    ds_read_b64_tr_b16 a[110:111], v5 offset:10240
    v_mfma_f32_16x16x32_bf16 v[176:179], a[96:99], v[60:63], v[176:179]
    s_waitcnt vmcnt(11)
    v_exp_f32 v69, v69
    v_mfma_f32_16x16x32_bf16 v[224:227], a[96:99], v[72:75], v[224:227]
    s_barrier
    v_mfma_f32_16x16x32_bf16 a[144:147], a[96:99], v[84:87], a[144:147]
    v_add_f32 v9, v9, v68
    v_add_f32 v9, v9, v69
    v_mfma_f32_16x16x32_bf16 a[192:195], a[96:99], v[16:19], a[192:195]
    v_exp_f32 v70, v70
    v_mfma_f32_16x16x32_bf16 a[240:243], a[96:99], v[32:35], a[240:243]
    s_waitcnt lgkmcnt(4)
    v_exp_f32 v71, v71
    v_mfma_f32_16x16x32_bf16 v[132:135], a[100:103], v[48:51], v[132:135]
    v_cvt_pk_bf16_f32 v66, v68, v69
    v_mfma_f32_16x16x32_bf16 v[180:183], a[100:103], v[60:63], v[180:183]
    ds_read_b128 a[96:99], v0 offset:0
    v_add_f32 v9, v9, v70
    v_mfma_f32_16x16x32_bf16 v[228:231], a[100:103], v[72:75], v[228:231]
    v_add_f32 v9, v9, v71
    v_cvt_pk_bf16_f32 v67, v70, v71
    v_mfma_f32_16x16x32_bf16 a[148:151], a[100:103], v[84:87], a[148:151]
    s_add_u32 m0, s45, 7936
    v_exp_f32 v56, v56
    v_mfma_f32_16x16x32_bf16 a[196:199], a[100:103], v[16:19], a[196:199]
    buffer_load_dwordx4 v7, s[24:27], s43 offen offset:256 nt lds
    v_mfma_f32_16x16x32_bf16 a[244:247], a[100:103], v[32:35], a[244:247]
    s_waitcnt lgkmcnt(3)
    v_exp_f32 v57, v57
    v_mfma_f32_16x16x32_bf16 v[136:139], a[104:107], v[48:51], v[136:139]
    v_add_f32 v8, v8, v56
    v_mfma_f32_16x16x32_bf16 v[184:187], a[104:107], v[60:63], v[184:187]
    ds_read_b128 a[100:103], v1 offset:0
    v_add_f32 v8, v8, v57
    v_mfma_f32_16x16x32_bf16 v[232:235], a[104:107], v[72:75], v[232:235]
    v_exp_f32 v58, v58
    v_mfma_f32_16x16x32_bf16 a[152:155], a[104:107], v[84:87], a[152:155]
    v_cvt_pk_bf16_f32 v54, v56, v57
    v_mfma_f32_16x16x32_bf16 a[200:203], a[104:107], v[16:19], a[200:203]
    v_exp_f32 v59, v59
    v_mfma_f32_16x16x32_bf16 a[248:251], a[104:107], v[32:35], a[248:251]
    s_waitcnt lgkmcnt(2)
    v_add_f32 v8, v8, v58
    v_mfma_f32_16x16x32_bf16 v[140:143], a[108:111], v[48:51], v[140:143]
    v_add_f32 v8, v8, v59
    v_mfma_f32_16x16x32_bf16 v[188:191], a[108:111], v[60:63], v[188:191]
    v_cvt_pk_bf16_f32 v55, v58, v59
    v_mfma_f32_16x16x32_bf16 v[236:239], a[108:111], v[72:75], v[236:239]
    v_mfma_f32_16x16x32_bf16 a[156:159], a[108:111], v[84:87], a[156:159]
    v_mfma_f32_16x16x32_bf16 a[204:207], a[108:111], v[16:19], a[204:207]
    v_mfma_f32_16x16x32_bf16 a[252:255], a[108:111], v[32:35], a[252:255]
    s_waitcnt lgkmcnt(1)
    s_add_u32 s43, s43, 12288
    s_add_u32 s45, s45, 12288
    s_add_u32 s44, s44, 12288
    s_mov_b32 s46, s53
    s_mov_b32 s42, 1
.p2align 3
L_loop:
    v_mfma_f32_16x16x32_bf16 v[48:51], a[96:99], a[0:3], 0
    s_waitcnt lgkmcnt(0)
    ds_read_b128 a[104:107], v0 offset:2048
    v_mfma_f32_16x16x32_bf16 v[48:51], a[100:103], a[4:7], v[48:51]
    s_add_u32 s83, s83, 1
    v_exp_f32 v20, v20
    v_mfma_f32_16x16x32_bf16 v[60:63], a[96:99], a[24:27], 0
    s_cmp_eq_u32 s83, 3
    ds_read_b128 a[108:111], v1 offset:2048
    v_mfma_f32_16x16x32_bf16 v[60:63], a[100:103], a[28:31], v[60:63]
    s_cselect_b32 s83, 0, s83
    v_exp_f32 v21, v21
    v_mfma_f32_16x16x32_bf16 v[72:75], a[96:99], a[48:51], 0
    s_cselect_b32 s93, s90, s91
    v_add_f32 v12, v12, v20
    v_add_f32 v12, v12, v21
    v_mfma_f32_16x16x32_bf16 v[72:75], a[100:103], a[52:55], v[72:75]
    s_add_u32 s82, s82, 1
    v_cvt_pk_bf16_f32 v20, v20, v21
    v_mfma_f32_16x16x32_bf16 v[84:87], a[96:99], a[72:75], 0
    s_cmp_eq_u32 s82, 3
    v_exp_f32 v22, v22
    v_mfma_f32_16x16x32_bf16 v[84:87], a[100:103], a[76:79], v[84:87]
    s_cselect_b32 s82, 0, s82
    v_mfma_f32_16x16x32_bf16 v[16:19], a[96:99], a[112:115], 0
    s_cselect_b32 s92, s90, s91
    v_exp_f32 v23, v23
    v_mfma_f32_16x16x32_bf16 v[16:19], a[100:103], a[116:119], v[16:19]
    v_add_f32 v12, v12, v22
    v_mfma_f32_16x16x32_bf16 v[32:35], a[96:99], a[120:123], 0
    v_add_f32 v12, v12, v23
    v_mfma_f32_16x16x32_bf16 v[32:35], a[100:103], a[124:127], v[32:35]
    s_waitcnt lgkmcnt(1)
    v_cvt_pk_bf16_f32 v21, v22, v23
    v_mfma_f32_16x16x32_bf16 v[40:43], a[104:107], a[120:123], 0
    s_waitcnt lgkmcnt(0)
    ds_read_b128 a[96:99], v0 offset:4096
    v_mfma_f32_16x16x32_bf16 v[40:43], a[108:111], a[124:127], v[40:43]
    ds_read_b128 a[120:123], v6 offset:8704
    v_mfma_f32_16x16x32_bf16 v[24:27], a[104:107], a[112:115], 0
    s_cmp_eq_u32 s42, 6
    ds_read_b128 a[100:103], v1 offset:4096
    v_mfma_f32_16x16x32_bf16 v[24:27], a[108:111], a[116:119], v[24:27]
    s_cselect_b32 s24, s28, s24
    ds_read_b128 a[124:127], v6 offset:9792
    v_mfma_f32_16x16x32_bf16 v[92:95], a[104:107], a[72:75], 0
    s_cselect_b32 s25, s29, s25
    v_exp_f32 v28, v28
    v_mfma_f32_16x16x32_bf16 v[92:95], a[108:111], a[76:79], v[92:95]
    s_cselect_b32 s44, 172032, s44
    ds_read_b128 a[112:115], v6 offset:2176
    v_add_f32 v12, v12, v28
    v_mfma_f32_16x16x32_bf16 v[80:83], a[104:107], a[48:51], 0
    v_exp_f32 v29, v29
    v_mfma_f32_16x16x32_bf16 v[80:83], a[108:111], a[52:55], v[80:83]
    ds_read_b128 a[116:119], v6 offset:3264
    v_add_f32 v12, v12, v29
    v_mfma_f32_16x16x32_bf16 v[68:71], a[104:107], a[24:27], 0
    v_exp_f32 v30, v30
    v_mfma_f32_16x16x32_bf16 v[68:71], a[108:111], a[28:31], v[68:71]
    v_exp_f32 v31, v31
    v_mfma_f32_16x16x32_bf16 v[56:59], a[104:107], a[0:3], 0
    v_cvt_pk_bf16_f32 v22, v28, v29
    v_add_f32 v12, v12, v30
    v_mfma_f32_16x16x32_bf16 v[56:59], a[108:111], a[4:7], v[56:59]
    s_waitcnt lgkmcnt(5)
    v_add_f32 v12, v12, v31
    v_mfma_f32_16x16x32_bf16 v[48:51], a[96:99], a[8:11], v[48:51]
    s_waitcnt lgkmcnt(3)
    ds_read_b128 a[104:107], v0 offset:6144
    v_cvt_pk_bf16_f32 v23, v30, v31
    v_mfma_f32_16x16x32_bf16 v[48:51], a[100:103], a[12:15], v[48:51]
    v_exp_f32 v36, v36
    v_mfma_f32_16x16x32_bf16 v[60:63], a[96:99], a[32:35], v[60:63]
    ds_read_b128 a[108:111], v1 offset:6144
    v_mfma_f32_16x16x32_bf16 v[60:63], a[100:103], a[36:39], v[60:63]
    v_exp_f32 v37, v37
    v_mfma_f32_16x16x32_bf16 v[72:75], a[96:99], a[56:59], v[72:75]
    v_add_f32 v13, v13, v36
    v_mfma_f32_16x16x32_bf16 v[72:75], a[100:103], a[60:63], v[72:75]
    v_add_f32 v13, v13, v37
    v_mfma_f32_16x16x32_bf16 v[84:87], a[96:99], a[80:83], v[84:87]
    v_cvt_pk_bf16_f32 v36, v36, v37
    v_mfma_f32_16x16x32_bf16 v[84:87], a[100:103], a[84:87], v[84:87]
    s_waitcnt lgkmcnt(3)
    v_exp_f32 v38, v38
    v_mfma_f32_16x16x32_bf16 v[16:19], a[96:99], a[112:115], v[16:19]
    s_waitcnt lgkmcnt(2)
    v_mfma_f32_16x16x32_bf16 v[16:19], a[100:103], a[116:119], v[16:19]
    v_exp_f32 v39, v39
    v_mfma_f32_16x16x32_bf16 v[32:35], a[96:99], a[120:123], v[32:35]
    v_add_f32 v13, v13, v38
    v_mfma_f32_16x16x32_bf16 v[32:35], a[100:103], a[124:127], v[32:35]
    s_waitcnt lgkmcnt(1)
    v_add_f32 v13, v13, v39
    v_mfma_f32_16x16x32_bf16 v[40:43], a[104:107], a[120:123], v[40:43]
    s_waitcnt lgkmcnt(0)
    ds_read_b128 a[96:99], v0 offset:8192
    v_cvt_pk_bf16_f32 v37, v38, v39
    v_mfma_f32_16x16x32_bf16 v[40:43], a[108:111], a[124:127], v[40:43]
    ds_read_b128 a[120:123], v6 offset:10880
    v_mfma_f32_16x16x32_bf16 v[24:27], a[104:107], a[112:115], v[24:27]
    ds_read_b128 a[100:103], v1 offset:8192
    v_mfma_f32_16x16x32_bf16 v[24:27], a[108:111], a[116:119], v[24:27]
    ds_read_b128 a[124:127], v6 offset:11968
    v_mfma_f32_16x16x32_bf16 v[92:95], a[104:107], a[80:83], v[92:95]
    v_exp_f32 v44, v44
    v_mfma_f32_16x16x32_bf16 v[92:95], a[108:111], a[84:87], v[92:95]
    ds_read_b128 a[112:115], v6 offset:4352
    v_add_f32 v13, v13, v44
    v_mfma_f32_16x16x32_bf16 v[80:83], a[104:107], a[56:59], v[80:83]
    v_exp_f32 v45, v45
    v_mfma_f32_16x16x32_bf16 v[80:83], a[108:111], a[60:63], v[80:83]
    ds_read_b128 a[116:119], v6 offset:5440
    v_add_f32 v13, v13, v45
    v_mfma_f32_16x16x32_bf16 v[68:71], a[104:107], a[32:35], v[68:71]
    v_exp_f32 v46, v46
    v_mfma_f32_16x16x32_bf16 v[68:71], a[108:111], a[36:39], v[68:71]
    v_exp_f32 v47, v47
    v_mfma_f32_16x16x32_bf16 v[56:59], a[104:107], a[8:11], v[56:59]
    v_cvt_pk_bf16_f32 v38, v44, v45
    v_add_u32 v2, s93, v2
    v_mfma_f32_16x16x32_bf16 v[56:59], a[108:111], a[12:15], v[56:59]
    s_waitcnt lgkmcnt(5)
    v_add_f32 v13, v13, v46
    v_add_u32 v3, s93, v3
    v_mfma_f32_16x16x32_bf16 v[48:51], a[96:99], a[16:19], v[48:51]
    s_waitcnt lgkmcnt(3)
    ds_read_b128 a[104:107], v0 offset:10240
    v_add_f32 v13, v13, v47
    v_mfma_f32_16x16x32_bf16 v[48:51], a[100:103], a[20:23], v[48:51]
    v_cvt_pk_bf16_f32 v39, v46, v47
    v_add_u32 v4, s93, v4
    v_mfma_f32_16x16x32_bf16 v[60:63], a[96:99], a[40:43], v[60:63]
    ds_read_b128 a[108:111], v1 offset:10240
    v_add_u32 v5, s93, v5
    v_mfma_f32_16x16x32_bf16 v[60:63], a[100:103], a[44:47], v[60:63]
    v_mfma_f32_16x16x32_bf16 v[72:75], a[96:99], a[64:67], v[72:75]
    v_add_u32 v0, s92, v0
    v_add_u32 v1, s92, v1
    v_mfma_f32_16x16x32_bf16 v[72:75], a[100:103], a[68:71], v[72:75]
    v_mfma_f32_16x16x32_bf16 v[84:87], a[96:99], a[88:91], v[84:87]
    v_mfma_f32_16x16x32_bf16 v[84:87], a[100:103], a[92:95], v[84:87]
    s_waitcnt lgkmcnt(3)
    v_exp_f32 v48, v48
    v_mfma_f32_16x16x32_bf16 v[16:19], a[96:99], a[112:115], v[16:19]
    s_waitcnt lgkmcnt(2)
    v_exp_f32 v49, v49
    v_mfma_f32_16x16x32_bf16 v[16:19], a[100:103], a[116:119], v[16:19]
    s_waitcnt vmcnt(6) lgkmcnt(0)
    v_mfma_f32_16x16x32_bf16 v[32:35], a[96:99], a[120:123], v[32:35]
    s_barrier
    v_mfma_f32_16x16x32_bf16 v[32:35], a[100:103], a[124:127], v[32:35]
    s_waitcnt lgkmcnt(1)
    v_add_f32 v8, v8, v48
    v_add_f32 v8, v8, v49
    v_mfma_f32_16x16x32_bf16 v[40:43], a[104:107], a[120:123], v[40:43]
    s_waitcnt lgkmcnt(0)
    ds_read_b64_tr_b16 a[96:97], v2 offset:0
    ds_read_b64_tr_b16 a[98:99], v2 offset:2048
    v_mfma_f32_16x16x32_bf16 v[40:43], a[108:111], a[124:127], v[40:43]
    s_mov_b32 m0, s75
    ds_read_b128 a[120:123], v6 offset:6528
    v_cvt_pk_bf16_f32 v48, v48, v49
    v_mfma_f32_16x16x32_bf16 v[24:27], a[104:107], a[112:115], v[24:27]
    buffer_load_dwordx4 v7, s[84:87], s74 offen nt lds
    v_mfma_f32_16x16x32_bf16 v[24:27], a[108:111], a[116:119], v[24:27]
    ds_read_b64_tr_b16 a[100:101], v3 offset:0
    ds_read_b64_tr_b16 a[102:103], v3 offset:2048
    v_mfma_f32_16x16x32_bf16 v[92:95], a[104:107], a[88:91], v[92:95]
    ds_read_b128 a[124:127], v6 offset:7616
    v_mfma_f32_16x16x32_bf16 v[92:95], a[108:111], a[92:95], v[92:95]
    v_exp_f32 v50, v50
    v_mfma_f32_16x16x32_bf16 v[80:83], a[104:107], a[64:67], v[80:83]
    ds_read_b128 a[112:115], v6 offset:0
    v_add_f32 v8, v8, v50
    v_mfma_f32_16x16x32_bf16 v[80:83], a[108:111], a[68:71], v[80:83]
    v_exp_f32 v51, v51
    v_mfma_f32_16x16x32_bf16 v[68:71], a[104:107], a[40:43], v[68:71]
    ds_read_b128 a[116:119], v6 offset:1088
    v_add_f32 v8, v8, v51
    v_mfma_f32_16x16x32_bf16 v[68:71], a[108:111], a[44:47], v[68:71]
    v_exp_f32 v60, v60
    v_mfma_f32_16x16x32_bf16 v[56:59], a[104:107], a[16:19], v[56:59]
    s_add_u32 m0, s46, 0
    v_exp_f32 v61, v61
    v_mfma_f32_16x16x32_bf16 v[56:59], a[108:111], a[20:23], v[56:59]
    s_waitcnt lgkmcnt(6)
    buffer_load_dwordx4 v7, s[28:31], s44 offen offset:0 nt lds
    v_mfma_f32_16x16x32_bf16 v[96:99], a[96:99], v[52:55], v[96:99]
    ds_read_b64_tr_b16 a[104:105], v4 offset:0
    ds_read_b64_tr_b16 a[106:107], v4 offset:2048
    v_mfma_f32_16x16x32_bf16 v[144:147], a[96:99], v[64:67], v[144:147]
    v_exp_f32 v62, v62
    v_mfma_f32_16x16x32_bf16 v[192:195], a[96:99], v[76:79], v[192:195]
    v_exp_f32 v63, v63
    v_mfma_f32_16x16x32_bf16 v[240:243], a[96:99], v[88:91], v[240:243]
    ds_read_b64_tr_b16 a[108:109], v5 offset:0
    ds_read_b64_tr_b16 a[110:111], v5 offset:2048
    v_mfma_f32_16x16x32_bf16 a[160:163], a[96:99], v[20:23], a[160:163]
    v_exp_f32 v72, v72
    v_mfma_f32_16x16x32_bf16 a[208:211], a[96:99], v[36:39], a[208:211]
    s_waitcnt lgkmcnt(7)
    v_exp_f32 v73, v73
    v_mfma_f32_16x16x32_bf16 v[100:103], a[100:103], v[52:55], v[100:103]
    ds_read_b64_tr_b16 a[96:97], v2 offset:4096
    ds_read_b64_tr_b16 a[98:99], v2 offset:6144
    v_mfma_f32_16x16x32_bf16 v[148:151], a[100:103], v[64:67], v[148:151]
    v_cvt_pk_bf16_f32 v49, v50, v51
    v_add_f32 v9, v9, v60
    v_mfma_f32_16x16x32_bf16 v[196:199], a[100:103], v[76:79], v[196:199]
    s_add_u32 m0, s46, 3968
    v_add_f32 v9, v9, v61
    v_cvt_pk_bf16_f32 v60, v60, v61
    v_mfma_f32_16x16x32_bf16 v[244:247], a[100:103], v[88:91], v[244:247]
    buffer_load_dwordx4 v7, s[28:31], s44 offen offset:128 nt lds
    v_mfma_f32_16x16x32_bf16 a[164:167], a[100:103], v[20:23], a[164:167]
    s_cmp_eq_u32 s42, 3
    v_exp_f32 v74, v74
    v_mfma_f32_16x16x32_bf16 a[212:215], a[100:103], v[36:39], a[212:215]
    s_waitcnt lgkmcnt(4)
    v_exp_f32 v75, v75
    v_mfma_f32_16x16x32_bf16 v[104:107], a[104:107], v[52:55], v[104:107]
    s_cselect_b32 s48, s94, s95
    ds_read_b64_tr_b16 a[100:101], v3 offset:4096
    ds_read_b64_tr_b16 a[102:103], v3 offset:6144
    v_mfma_f32_16x16x32_bf16 v[152:155], a[104:107], v[64:67], v[152:155]
    s_cselect_b32 s84, s24, s84
    v_add_f32 v9, v9, v62
    v_add_f32 v9, v9, v63
    v_mfma_f32_16x16x32_bf16 v[200:203], a[104:107], v[76:79], v[200:203]
    s_cselect_b32 s85, s25, s85
    v_exp_f32 v84, v84
    v_mfma_f32_16x16x32_bf16 v[248:251], a[104:107], v[88:91], v[248:251]
    s_cselect_b32 s3, 36864, 0
    v_cvt_pk_bf16_f32 v61, v62, v63
    v_add_f32 v10, v10, v72
    v_mfma_f32_16x16x32_bf16 a[168:171], a[104:107], v[20:23], a[168:171]
    v_exp_f32 v85, v85
    v_mfma_f32_16x16x32_bf16 a[216:219], a[104:107], v[36:39], a[216:219]
    s_waitcnt lgkmcnt(4)
    v_add_f32 v10, v10, v73
    v_cvt_pk_bf16_f32 v72, v72, v73
    v_mfma_f32_16x16x32_bf16 v[108:111], a[108:111], v[52:55], v[108:111]
    ds_read_b64_tr_b16 a[104:105], v4 offset:4096
    ds_read_b64_tr_b16 a[106:107], v4 offset:6144
    v_mfma_f32_16x16x32_bf16 v[156:159], a[108:111], v[64:67], v[156:159]
    v_add_f32 v10, v10, v74
    v_add_f32 v10, v10, v75
    v_mfma_f32_16x16x32_bf16 v[204:207], a[108:111], v[76:79], v[204:207]
    s_add_u32 m0, s46, 7936
    v_exp_f32 v86, v86
    v_mfma_f32_16x16x32_bf16 v[252:255], a[108:111], v[88:91], v[252:255]
    buffer_load_dwordx4 v7, s[28:31], s44 offen offset:256 nt lds
    v_mfma_f32_16x16x32_bf16 a[172:175], a[108:111], v[20:23], a[172:175]
    s_add_u32 s44, s44, 12288
    v_exp_f32 v87, v87
    v_mfma_f32_16x16x32_bf16 a[220:223], a[108:111], v[36:39], a[220:223]
    s_waitcnt lgkmcnt(4)
    v_cvt_pk_bf16_f32 v73, v74, v75
    v_add_f32 v11, v11, v84
    v_mfma_f32_16x16x32_bf16 v[112:115], a[96:99], v[52:55], v[112:115]
    s_add_u32 s46, s46, 12288
    ds_read_b64_tr_b16 a[108:109], v5 offset:4096
    ds_read_b64_tr_b16 a[110:111], v5 offset:6144
    v_mfma_f32_16x16x32_bf16 v[160:163], a[96:99], v[64:67], v[160:163]
    s_cmp_eq_u32 s46, s51
    v_exp_f32 v92, v92
    v_mfma_f32_16x16x32_bf16 v[208:211], a[96:99], v[76:79], v[208:211]
    s_cselect_b32 s46, s53, s46
    v_add_f32 v11, v11, v85
    v_cvt_pk_bf16_f32 v84, v84, v85
    v_mfma_f32_16x16x32_bf16 a[128:131], a[96:99], v[88:91], a[128:131]
    v_exp_f32 v93, v93
    v_mfma_f32_16x16x32_bf16 a[176:179], a[96:99], v[20:23], a[176:179]
    v_add_f32 v11, v11, v86
    v_add_f32 v11, v11, v87
    v_mfma_f32_16x16x32_bf16 a[224:227], a[96:99], v[36:39], a[224:227]
    s_waitcnt lgkmcnt(4)
    v_cvt_pk_bf16_f32 v85, v86, v87
    v_add_f32 v11, v11, v92
    v_mfma_f32_16x16x32_bf16 v[116:119], a[100:103], v[52:55], v[116:119]
    ds_read_b64_tr_b16 a[96:97], v2 offset:8192
    ds_read_b64_tr_b16 a[98:99], v2 offset:10240
    v_mfma_f32_16x16x32_bf16 v[164:167], a[100:103], v[64:67], v[164:167]
    v_exp_f32 v94, v94
    v_mfma_f32_16x16x32_bf16 v[212:215], a[100:103], v[76:79], v[212:215]
    s_add_u32 m0, s45, 0
    v_exp_f32 v95, v95
    v_mfma_f32_16x16x32_bf16 a[132:135], a[100:103], v[88:91], a[132:135]
    buffer_load_dwordx4 v7, s[24:27], s43 offen offset:0 nt lds
    v_mfma_f32_16x16x32_bf16 a[180:183], a[100:103], v[20:23], a[180:183]
    s_add_u32 s74, s74, s48
    v_add_f32 v11, v11, v93
    v_cvt_pk_bf16_f32 v86, v92, v93
    v_mfma_f32_16x16x32_bf16 a[228:231], a[100:103], v[36:39], a[228:231]
    s_waitcnt lgkmcnt(4)
    v_add_f32 v11, v11, v94
    v_add_f32 v11, v11, v95
    v_mfma_f32_16x16x32_bf16 v[120:123], a[104:107], v[52:55], v[120:123]
    s_add_u32 s75, s75, 4096
    ds_read_b64_tr_b16 a[100:101], v3 offset:8192
    ds_read_b64_tr_b16 a[102:103], v3 offset:10240
    v_mfma_f32_16x16x32_bf16 v[168:171], a[104:107], v[64:67], v[168:171]
    s_add_u32 s75, s75, s3
    v_exp_f32 v80, v80
    v_mfma_f32_16x16x32_bf16 v[216:219], a[104:107], v[76:79], v[216:219]
    v_exp_f32 v81, v81
    v_mfma_f32_16x16x32_bf16 a[136:139], a[104:107], v[88:91], a[136:139]
    v_cvt_pk_bf16_f32 v87, v94, v95
    v_add_f32 v10, v10, v80
    v_mfma_f32_16x16x32_bf16 a[184:187], a[104:107], v[20:23], a[184:187]
    v_add_f32 v10, v10, v81
    v_cvt_pk_bf16_f32 v74, v80, v81
    v_mfma_f32_16x16x32_bf16 a[232:235], a[104:107], v[36:39], a[232:235]
    s_waitcnt lgkmcnt(4)
    v_exp_f32 v82, v82
    v_mfma_f32_16x16x32_bf16 v[124:127], a[108:111], v[52:55], v[124:127]
    ds_read_b64_tr_b16 a[104:105], v4 offset:8192
    ds_read_b64_tr_b16 a[106:107], v4 offset:10240
    v_mfma_f32_16x16x32_bf16 v[172:175], a[108:111], v[64:67], v[172:175]
    v_exp_f32 v83, v83
    v_mfma_f32_16x16x32_bf16 v[220:223], a[108:111], v[76:79], v[220:223]
    s_add_u32 m0, s45, 3968
    v_add_f32 v10, v10, v82
    v_mfma_f32_16x16x32_bf16 a[140:143], a[108:111], v[88:91], a[140:143]
    buffer_load_dwordx4 v7, s[24:27], s43 offen offset:128 nt lds
    v_mfma_f32_16x16x32_bf16 a[188:191], a[108:111], v[20:23], a[188:191]
    v_exp_f32 v68, v68
    v_mfma_f32_16x16x32_bf16 a[236:239], a[108:111], v[36:39], a[236:239]
    s_waitcnt lgkmcnt(4)
    v_add_f32 v10, v10, v83
    v_cvt_pk_bf16_f32 v75, v82, v83
    v_mfma_f32_16x16x32_bf16 v[128:131], a[96:99], v[52:55], v[128:131]
    ds_read_b64_tr_b16 a[108:109], v5 offset:8192
    ds_read_b64_tr_b16 a[110:111], v5 offset:10240
    v_mfma_f32_16x16x32_bf16 v[176:179], a[96:99], v[64:67], v[176:179]
    v_exp_f32 v69, v69
    v_mfma_f32_16x16x32_bf16 v[224:227], a[96:99], v[76:79], v[224:227]
    v_add_f32 v9, v9, v68
    v_add_f32 v9, v9, v69
    v_mfma_f32_16x16x32_bf16 a[144:147], a[96:99], v[88:91], a[144:147]
    v_cvt_pk_bf16_f32 v62, v68, v69
    v_mfma_f32_16x16x32_bf16 a[192:195], a[96:99], v[20:23], a[192:195]
    v_exp_f32 v70, v70
    v_mfma_f32_16x16x32_bf16 a[240:243], a[96:99], v[36:39], a[240:243]
    s_waitcnt lgkmcnt(4)
    v_exp_f32 v71, v71
    v_mfma_f32_16x16x32_bf16 v[132:135], a[100:103], v[52:55], v[132:135]
    v_mfma_f32_16x16x32_bf16 v[180:183], a[100:103], v[64:67], v[180:183]
    ds_read_b128 a[96:99], v0 offset:0
    v_add_f32 v9, v9, v70
    v_mfma_f32_16x16x32_bf16 v[228:231], a[100:103], v[76:79], v[228:231]
    v_add_f32 v9, v9, v71
    v_cvt_pk_bf16_f32 v63, v70, v71
    v_mfma_f32_16x16x32_bf16 a[148:151], a[100:103], v[88:91], a[148:151]
    s_add_u32 m0, s45, 7936
    v_exp_f32 v56, v56
    v_mfma_f32_16x16x32_bf16 a[196:199], a[100:103], v[20:23], a[196:199]
    buffer_load_dwordx4 v7, s[24:27], s43 offen offset:256 nt lds
    v_mfma_f32_16x16x32_bf16 a[244:247], a[100:103], v[36:39], a[244:247]
    s_waitcnt lgkmcnt(3)
    v_exp_f32 v57, v57
    v_mfma_f32_16x16x32_bf16 v[136:139], a[104:107], v[52:55], v[136:139]
    s_add_u32 s43, s43, 12288
    v_add_f32 v8, v8, v56
    v_mfma_f32_16x16x32_bf16 v[184:187], a[104:107], v[64:67], v[184:187]
    s_add_u32 s45, s45, 12288
    ds_read_b128 a[100:103], v1 offset:0
    v_add_f32 v8, v8, v57
    v_mfma_f32_16x16x32_bf16 v[232:235], a[104:107], v[76:79], v[232:235]
    s_cmp_eq_u32 s45, s50
    v_exp_f32 v58, v58
    v_mfma_f32_16x16x32_bf16 a[152:155], a[104:107], v[88:91], a[152:155]
    s_cselect_b32 s45, s52, s45
    v_cvt_pk_bf16_f32 v50, v56, v57
    v_mfma_f32_16x16x32_bf16 a[200:203], a[104:107], v[20:23], a[200:203]
    v_exp_f32 v59, v59
    v_mfma_f32_16x16x32_bf16 a[248:251], a[104:107], v[36:39], a[248:251]
    s_waitcnt lgkmcnt(2)
    v_add_f32 v8, v8, v58
    v_mfma_f32_16x16x32_bf16 v[140:143], a[108:111], v[52:55], v[140:143]
    v_add_f32 v8, v8, v59
    v_mfma_f32_16x16x32_bf16 v[188:191], a[108:111], v[64:67], v[188:191]
    v_cvt_pk_bf16_f32 v51, v58, v59
    v_mfma_f32_16x16x32_bf16 v[236:239], a[108:111], v[76:79], v[236:239]
    v_mfma_f32_16x16x32_bf16 a[156:159], a[108:111], v[88:91], a[156:159]
    v_mfma_f32_16x16x32_bf16 a[204:207], a[108:111], v[20:23], a[204:207]
    v_mfma_f32_16x16x32_bf16 a[252:255], a[108:111], v[36:39], a[252:255]
    s_waitcnt lgkmcnt(1)
    v_mfma_f32_16x16x32_bf16 v[52:55], a[96:99], a[0:3], 0
    s_waitcnt lgkmcnt(0)
    ds_read_b128 a[104:107], v0 offset:2048
    v_mfma_f32_16x16x32_bf16 v[52:55], a[100:103], a[4:7], v[52:55]
    s_add_u32 s83, s83, 1
    v_exp_f32 v16, v16
    v_mfma_f32_16x16x32_bf16 v[64:67], a[96:99], a[24:27], 0
    s_cmp_eq_u32 s83, 3
    ds_read_b128 a[108:111], v1 offset:2048
    v_mfma_f32_16x16x32_bf16 v[64:67], a[100:103], a[28:31], v[64:67]
    s_cselect_b32 s83, 0, s83
    v_exp_f32 v17, v17
    v_mfma_f32_16x16x32_bf16 v[76:79], a[96:99], a[48:51], 0
    s_cselect_b32 s93, s90, s91
    v_add_f32 v12, v12, v16
    v_add_f32 v12, v12, v17
    v_mfma_f32_16x16x32_bf16 v[76:79], a[100:103], a[52:55], v[76:79]
    s_add_u32 s82, s82, 1
    v_cvt_pk_bf16_f32 v16, v16, v17
    v_mfma_f32_16x16x32_bf16 v[88:91], a[96:99], a[72:75], 0
    s_cmp_eq_u32 s82, 3
    v_exp_f32 v18, v18
    v_mfma_f32_16x16x32_bf16 v[88:91], a[100:103], a[76:79], v[88:91]
    s_cselect_b32 s82, 0, s82
    v_mfma_f32_16x16x32_bf16 v[20:23], a[96:99], a[112:115], 0
    s_cselect_b32 s92, s90, s91
    v_exp_f32 v19, v19
    v_mfma_f32_16x16x32_bf16 v[20:23], a[100:103], a[116:119], v[20:23]
    v_add_f32 v12, v12, v18
    v_mfma_f32_16x16x32_bf16 v[36:39], a[96:99], a[120:123], 0
    v_add_f32 v12, v12, v19
    v_mfma_f32_16x16x32_bf16 v[36:39], a[100:103], a[124:127], v[36:39]
    s_waitcnt lgkmcnt(1)
    v_cvt_pk_bf16_f32 v17, v18, v19
    v_mfma_f32_16x16x32_bf16 v[44:47], a[104:107], a[120:123], 0
    s_waitcnt lgkmcnt(0)
    ds_read_b128 a[96:99], v0 offset:4096
    v_mfma_f32_16x16x32_bf16 v[44:47], a[108:111], a[124:127], v[44:47]
    ds_read_b128 a[120:123], v6 offset:8704
    v_mfma_f32_16x16x32_bf16 v[28:31], a[104:107], a[112:115], 0
    ds_read_b128 a[100:103], v1 offset:4096
    v_mfma_f32_16x16x32_bf16 v[28:31], a[108:111], a[116:119], v[28:31]
    ds_read_b128 a[124:127], v6 offset:9792
    v_mfma_f32_16x16x32_bf16 v[92:95], a[104:107], a[72:75], 0
    v_exp_f32 v24, v24
    v_mfma_f32_16x16x32_bf16 v[92:95], a[108:111], a[76:79], v[92:95]
    ds_read_b128 a[112:115], v6 offset:2176
    v_add_f32 v12, v12, v24
    v_mfma_f32_16x16x32_bf16 v[80:83], a[104:107], a[48:51], 0
    v_exp_f32 v25, v25
    v_mfma_f32_16x16x32_bf16 v[80:83], a[108:111], a[52:55], v[80:83]
    ds_read_b128 a[116:119], v6 offset:3264
    v_add_f32 v12, v12, v25
    v_mfma_f32_16x16x32_bf16 v[68:71], a[104:107], a[24:27], 0
    v_exp_f32 v26, v26
    v_mfma_f32_16x16x32_bf16 v[68:71], a[108:111], a[28:31], v[68:71]
    v_exp_f32 v27, v27
    v_mfma_f32_16x16x32_bf16 v[56:59], a[104:107], a[0:3], 0
    v_cvt_pk_bf16_f32 v18, v24, v25
    v_add_f32 v12, v12, v26
    v_mfma_f32_16x16x32_bf16 v[56:59], a[108:111], a[4:7], v[56:59]
    s_waitcnt lgkmcnt(5)
    v_add_f32 v12, v12, v27
    v_mfma_f32_16x16x32_bf16 v[52:55], a[96:99], a[8:11], v[52:55]
    s_waitcnt lgkmcnt(3)
    ds_read_b128 a[104:107], v0 offset:6144
    v_cvt_pk_bf16_f32 v19, v26, v27
    v_mfma_f32_16x16x32_bf16 v[52:55], a[100:103], a[12:15], v[52:55]
    v_exp_f32 v32, v32
    v_mfma_f32_16x16x32_bf16 v[64:67], a[96:99], a[32:35], v[64:67]
    ds_read_b128 a[108:111], v1 offset:6144
    v_mfma_f32_16x16x32_bf16 v[64:67], a[100:103], a[36:39], v[64:67]
    v_exp_f32 v33, v33
    v_mfma_f32_16x16x32_bf16 v[76:79], a[96:99], a[56:59], v[76:79]
    v_add_f32 v13, v13, v32
    v_mfma_f32_16x16x32_bf16 v[76:79], a[100:103], a[60:63], v[76:79]
    v_add_f32 v13, v13, v33
    v_mfma_f32_16x16x32_bf16 v[88:91], a[96:99], a[80:83], v[88:91]
    v_cvt_pk_bf16_f32 v32, v32, v33
    v_mfma_f32_16x16x32_bf16 v[88:91], a[100:103], a[84:87], v[88:91]
    s_waitcnt lgkmcnt(3)
    v_exp_f32 v34, v34
    v_mfma_f32_16x16x32_bf16 v[20:23], a[96:99], a[112:115], v[20:23]
    s_waitcnt lgkmcnt(2)
    v_mfma_f32_16x16x32_bf16 v[20:23], a[100:103], a[116:119], v[20:23]
    v_exp_f32 v35, v35
    v_mfma_f32_16x16x32_bf16 v[36:39], a[96:99], a[120:123], v[36:39]
    v_add_f32 v13, v13, v34
    v_mfma_f32_16x16x32_bf16 v[36:39], a[100:103], a[124:127], v[36:39]
    s_waitcnt lgkmcnt(1)
    v_add_f32 v13, v13, v35
    v_mfma_f32_16x16x32_bf16 v[44:47], a[104:107], a[120:123], v[44:47]
    s_waitcnt lgkmcnt(0)
    ds_read_b128 a[96:99], v0 offset:8192
    v_cvt_pk_bf16_f32 v33, v34, v35
    v_mfma_f32_16x16x32_bf16 v[44:47], a[108:111], a[124:127], v[44:47]
    ds_read_b128 a[120:123], v6 offset:10880
    v_mfma_f32_16x16x32_bf16 v[28:31], a[104:107], a[112:115], v[28:31]
    ds_read_b128 a[100:103], v1 offset:8192
    v_mfma_f32_16x16x32_bf16 v[28:31], a[108:111], a[116:119], v[28:31]
    ds_read_b128 a[124:127], v6 offset:11968
    v_mfma_f32_16x16x32_bf16 v[92:95], a[104:107], a[80:83], v[92:95]
    v_exp_f32 v40, v40
    v_mfma_f32_16x16x32_bf16 v[92:95], a[108:111], a[84:87], v[92:95]
    ds_read_b128 a[112:115], v6 offset:4352
    v_add_f32 v13, v13, v40
    v_mfma_f32_16x16x32_bf16 v[80:83], a[104:107], a[56:59], v[80:83]
    v_exp_f32 v41, v41
    v_mfma_f32_16x16x32_bf16 v[80:83], a[108:111], a[60:63], v[80:83]
    ds_read_b128 a[116:119], v6 offset:5440
    v_add_f32 v13, v13, v41
    v_mfma_f32_16x16x32_bf16 v[68:71], a[104:107], a[32:35], v[68:71]
    v_exp_f32 v42, v42
    v_mfma_f32_16x16x32_bf16 v[68:71], a[108:111], a[36:39], v[68:71]
    v_exp_f32 v43, v43
    v_mfma_f32_16x16x32_bf16 v[56:59], a[104:107], a[8:11], v[56:59]
    v_cvt_pk_bf16_f32 v34, v40, v41
    v_add_u32 v2, s93, v2
    v_mfma_f32_16x16x32_bf16 v[56:59], a[108:111], a[12:15], v[56:59]
    s_waitcnt lgkmcnt(5)
    v_add_f32 v13, v13, v42
    v_add_u32 v3, s93, v3
    v_mfma_f32_16x16x32_bf16 v[52:55], a[96:99], a[16:19], v[52:55]
    s_waitcnt lgkmcnt(3)
    ds_read_b128 a[104:107], v0 offset:10240
    v_add_f32 v13, v13, v43
    v_mfma_f32_16x16x32_bf16 v[52:55], a[100:103], a[20:23], v[52:55]
L_hop0:
    s_cbranch_execz L_hopback0
    v_cvt_pk_bf16_f32 v35, v42, v43
    v_add_u32 v4, s93, v4
    v_mfma_f32_16x16x32_bf16 v[64:67], a[96:99], a[40:43], v[64:67]
    ds_read_b128 a[108:111], v1 offset:10240
    v_add_u32 v5, s93, v5
    v_mfma_f32_16x16x32_bf16 v[64:67], a[100:103], a[44:47], v[64:67]
    v_mfma_f32_16x16x32_bf16 v[76:79], a[96:99], a[64:67], v[76:79]
    v_add_u32 v0, s92, v0
    v_add_u32 v1, s92, v1
    v_mfma_f32_16x16x32_bf16 v[76:79], a[100:103], a[68:71], v[76:79]
    v_mfma_f32_16x16x32_bf16 v[88:91], a[96:99], a[88:91], v[88:91]
    v_mfma_f32_16x16x32_bf16 v[88:91], a[100:103], a[92:95], v[88:91]
    s_waitcnt lgkmcnt(3)
    v_exp_f32 v52, v52
    v_mfma_f32_16x16x32_bf16 v[20:23], a[96:99], a[112:115], v[20:23]
    s_waitcnt lgkmcnt(2)
    v_exp_f32 v53, v53
    v_mfma_f32_16x16x32_bf16 v[20:23], a[100:103], a[116:119], v[20:23]
    s_waitcnt vmcnt(7) lgkmcnt(0)
    v_mfma_f32_16x16x32_bf16 v[36:39], a[96:99], a[120:123], v[36:39]
    s_barrier
    v_mfma_f32_16x16x32_bf16 v[36:39], a[100:103], a[124:127], v[36:39]
    s_waitcnt lgkmcnt(1)
    v_add_f32 v8, v8, v52
    v_add_f32 v8, v8, v53
    v_mfma_f32_16x16x32_bf16 v[44:47], a[104:107], a[120:123], v[44:47]
    s_waitcnt lgkmcnt(0)
    ds_read_b64_tr_b16 a[96:97], v2 offset:0
    ds_read_b64_tr_b16 a[98:99], v2 offset:2048
    v_mfma_f32_16x16x32_bf16 v[44:47], a[108:111], a[124:127], v[44:47]
    ds_read_b128 a[120:123], v6 offset:6528
    v_cvt_pk_bf16_f32 v52, v52, v53
    v_mfma_f32_16x16x32_bf16 v[28:31], a[104:107], a[112:115], v[28:31]
    v_exp_f32 v54, v54
    v_mfma_f32_16x16x32_bf16 v[28:31], a[108:111], a[116:119], v[28:31]
    ds_read_b64_tr_b16 a[100:101], v3 offset:0
    ds_read_b64_tr_b16 a[102:103], v3 offset:2048
    v_mfma_f32_16x16x32_bf16 v[92:95], a[104:107], a[88:91], v[92:95]
    ds_read_b128 a[124:127], v6 offset:7616
    v_add_f32 v8, v8, v54
    v_mfma_f32_16x16x32_bf16 v[92:95], a[108:111], a[92:95], v[92:95]
    v_exp_f32 v55, v55
    v_mfma_f32_16x16x32_bf16 v[80:83], a[104:107], a[64:67], v[80:83]
    ds_read_b128 a[112:115], v6 offset:0
    v_add_f32 v8, v8, v55
    v_mfma_f32_16x16x32_bf16 v[80:83], a[108:111], a[68:71], v[80:83]
    v_exp_f32 v64, v64
    v_mfma_f32_16x16x32_bf16 v[68:71], a[104:107], a[40:43], v[68:71]
    ds_read_b128 a[116:119], v6 offset:1088
    v_cvt_pk_bf16_f32 v53, v54, v55
    v_mfma_f32_16x16x32_bf16 v[68:71], a[108:111], a[44:47], v[68:71]
    v_exp_f32 v65, v65
    v_mfma_f32_16x16x32_bf16 v[56:59], a[104:107], a[16:19], v[56:59]
    s_add_u32 m0, s46, 0
    v_exp_f32 v66, v66
    v_mfma_f32_16x16x32_bf16 v[56:59], a[108:111], a[20:23], v[56:59]
    s_waitcnt lgkmcnt(6)
    buffer_load_dwordx4 v7, s[28:31], s44 offen offset:0 nt lds
    v_mfma_f32_16x16x32_bf16 v[96:99], a[96:99], v[48:51], v[96:99]
    ds_read_b64_tr_b16 a[104:105], v4 offset:0
    ds_read_b64_tr_b16 a[106:107], v4 offset:2048
    v_mfma_f32_16x16x32_bf16 v[144:147], a[96:99], v[60:63], v[144:147]
    v_exp_f32 v67, v67
    v_mfma_f32_16x16x32_bf16 v[192:195], a[96:99], v[72:75], v[192:195]
    v_add_f32 v9, v9, v64
    v_add_f32 v9, v9, v65
    v_mfma_f32_16x16x32_bf16 v[240:243], a[96:99], v[84:87], v[240:243]
    ds_read_b64_tr_b16 a[108:109], v5 offset:0
    ds_read_b64_tr_b16 a[110:111], v5 offset:2048
    v_mfma_f32_16x16x32_bf16 a[160:163], a[96:99], v[16:19], a[160:163]
    v_exp_f32 v76, v76
    v_mfma_f32_16x16x32_bf16 a[208:211], a[96:99], v[32:35], a[208:211]
    s_waitcnt lgkmcnt(7)
    v_exp_f32 v77, v77
    v_mfma_f32_16x16x32_bf16 v[100:103], a[100:103], v[48:51], v[100:103]
    ds_read_b64_tr_b16 a[96:97], v2 offset:4096
    ds_read_b64_tr_b16 a[98:99], v2 offset:6144
    v_mfma_f32_16x16x32_bf16 v[148:151], a[100:103], v[60:63], v[148:151]
    v_cvt_pk_bf16_f32 v64, v64, v65
    v_add_f32 v9, v9, v66
    v_mfma_f32_16x16x32_bf16 v[196:199], a[100:103], v[72:75], v[196:199]
    s_add_u32 m0, s46, 3968
    v_add_f32 v9, v9, v67
    v_cvt_pk_bf16_f32 v65, v66, v67
    v_mfma_f32_16x16x32_bf16 v[244:247], a[100:103], v[84:87], v[244:247]
    buffer_load_dwordx4 v7, s[28:31], s44 offen offset:128 nt lds
    v_mfma_f32_16x16x32_bf16 a[164:167], a[100:103], v[16:19], a[164:167]
    v_exp_f32 v78, v78
    v_mfma_f32_16x16x32_bf16 a[212:215], a[100:103], v[32:35], a[212:215]
    s_waitcnt lgkmcnt(4)
    v_exp_f32 v79, v79
    v_mfma_f32_16x16x32_bf16 v[104:107], a[104:107], v[48:51], v[104:107]
    ds_read_b64_tr_b16 a[100:101], v3 offset:4096
    ds_read_b64_tr_b16 a[102:103], v3 offset:6144
    v_mfma_f32_16x16x32_bf16 v[152:155], a[104:107], v[60:63], v[152:155]
    v_add_f32 v10, v10, v76
    v_add_f32 v10, v10, v77
    v_mfma_f32_16x16x32_bf16 v[200:203], a[104:107], v[72:75], v[200:203]
    v_exp_f32 v88, v88
    v_mfma_f32_16x16x32_bf16 v[248:251], a[104:107], v[84:87], v[248:251]
    v_cvt_pk_bf16_f32 v76, v76, v77
    v_add_f32 v10, v10, v78
    v_mfma_f32_16x16x32_bf16 a[168:171], a[104:107], v[16:19], a[168:171]
    v_exp_f32 v89, v89
    v_mfma_f32_16x16x32_bf16 a[216:219], a[104:107], v[32:35], a[216:219]
    s_waitcnt lgkmcnt(4)
    v_add_f32 v10, v10, v79
    v_cvt_pk_bf16_f32 v77, v78, v79
    v_mfma_f32_16x16x32_bf16 v[108:111], a[108:111], v[48:51], v[108:111]
    ds_read_b64_tr_b16 a[104:105], v4 offset:4096
    ds_read_b64_tr_b16 a[106:107], v4 offset:6144
    v_mfma_f32_16x16x32_bf16 v[156:159], a[108:111], v[60:63], v[156:159]
    v_add_f32 v11, v11, v88
    v_add_f32 v11, v11, v89
    v_mfma_f32_16x16x32_bf16 v[204:207], a[108:111], v[72:75], v[204:207]
    s_add_u32 m0, s46, 7936
    v_exp_f32 v90, v90
    v_mfma_f32_16x16x32_bf16 v[252:255], a[108:111], v[84:87], v[252:255]
    buffer_load_dwordx4 v7, s[28:31], s44 offen offset:256 nt lds
    v_mfma_f32_16x16x32_bf16 a[172:175], a[108:111], v[16:19], a[172:175]
    s_add_u32 s44, s44, 12288
    v_exp_f32 v91, v91
    v_mfma_f32_16x16x32_bf16 a[220:223], a[108:111], v[32:35], a[220:223]
    s_waitcnt lgkmcnt(4)
    v_cvt_pk_bf16_f32 v88, v88, v89
    v_add_f32 v11, v11, v90
    v_mfma_f32_16x16x32_bf16 v[112:115], a[96:99], v[48:51], v[112:115]
    s_add_u32 s46, s46, 12288
    ds_read_b64_tr_b16 a[108:109], v5 offset:4096
    ds_read_b64_tr_b16 a[110:111], v5 offset:6144
    v_mfma_f32_16x16x32_bf16 v[160:163], a[96:99], v[60:63], v[160:163]
    s_cmp_eq_u32 s46, s51
    v_exp_f32 v92, v92
    v_mfma_f32_16x16x32_bf16 v[208:211], a[96:99], v[72:75], v[208:211]
    s_cselect_b32 s46, s53, s46
    v_add_f32 v11, v11, v91
    v_cvt_pk_bf16_f32 v89, v90, v91
    v_mfma_f32_16x16x32_bf16 a[128:131], a[96:99], v[84:87], a[128:131]
    v_exp_f32 v93, v93
    v_mfma_f32_16x16x32_bf16 a[176:179], a[96:99], v[16:19], a[176:179]
    v_add_f32 v11, v11, v92
    v_mfma_f32_16x16x32_bf16 a[224:227], a[96:99], v[32:35], a[224:227]
    s_waitcnt lgkmcnt(4)
    v_add_f32 v11, v11, v93
    v_mfma_f32_16x16x32_bf16 v[116:119], a[100:103], v[48:51], v[116:119]
    ds_read_b64_tr_b16 a[96:97], v2 offset:8192
    ds_read_b64_tr_b16 a[98:99], v2 offset:10240
    v_mfma_f32_16x16x32_bf16 v[164:167], a[100:103], v[60:63], v[164:167]
    v_exp_f32 v94, v94
    v_mfma_f32_16x16x32_bf16 v[212:215], a[100:103], v[72:75], v[212:215]
    s_add_u32 m0, s45, 0
    v_exp_f32 v95, v95
    v_mfma_f32_16x16x32_bf16 a[132:135], a[100:103], v[84:87], a[132:135]
    buffer_load_dwordx4 v7, s[24:27], s43 offen offset:0 nt lds
    v_mfma_f32_16x16x32_bf16 a[180:183], a[100:103], v[16:19], a[180:183]
    v_cvt_pk_bf16_f32 v90, v92, v93
    v_add_f32 v11, v11, v94
    v_mfma_f32_16x16x32_bf16 a[228:231], a[100:103], v[32:35], a[228:231]
    s_waitcnt lgkmcnt(4)
    v_add_f32 v11, v11, v95
    v_cvt_pk_bf16_f32 v91, v94, v95
    v_mfma_f32_16x16x32_bf16 v[120:123], a[104:107], v[48:51], v[120:123]
    ds_read_b64_tr_b16 a[100:101], v3 offset:8192
    ds_read_b64_tr_b16 a[102:103], v3 offset:10240
    v_mfma_f32_16x16x32_bf16 v[168:171], a[104:107], v[60:63], v[168:171]
    v_exp_f32 v80, v80
    v_mfma_f32_16x16x32_bf16 v[216:219], a[104:107], v[72:75], v[216:219]
    v_exp_f32 v81, v81
    v_mfma_f32_16x16x32_bf16 a[136:139], a[104:107], v[84:87], a[136:139]
    v_add_f32 v10, v10, v80
    v_add_f32 v10, v10, v81
    v_mfma_f32_16x16x32_bf16 a[184:187], a[104:107], v[16:19], a[184:187]
    v_cvt_pk_bf16_f32 v78, v80, v81
    v_mfma_f32_16x16x32_bf16 a[232:235], a[104:107], v[32:35], a[232:235]
    s_waitcnt lgkmcnt(4)
    v_exp_f32 v82, v82
    v_mfma_f32_16x16x32_bf16 v[124:127], a[108:111], v[48:51], v[124:127]
    ds_read_b64_tr_b16 a[104:105], v4 offset:8192
    ds_read_b64_tr_b16 a[106:107], v4 offset:10240
    v_mfma_f32_16x16x32_bf16 v[172:175], a[108:111], v[60:63], v[172:175]
    v_exp_f32 v83, v83
    v_mfma_f32_16x16x32_bf16 v[220:223], a[108:111], v[72:75], v[220:223]
    s_add_u32 m0, s45, 3968
    v_add_f32 v10, v10, v82
    v_mfma_f32_16x16x32_bf16 a[140:143], a[108:111], v[84:87], a[140:143]
    buffer_load_dwordx4 v7, s[24:27], s43 offen offset:128 nt lds
    v_mfma_f32_16x16x32_bf16 a[188:191], a[108:111], v[16:19], a[188:191]
    v_exp_f32 v68, v68
    v_mfma_f32_16x16x32_bf16 a[236:239], a[108:111], v[32:35], a[236:239]
    s_waitcnt lgkmcnt(4)
    v_add_f32 v10, v10, v83
    v_cvt_pk_bf16_f32 v79, v82, v83
    v_mfma_f32_16x16x32_bf16 v[128:131], a[96:99], v[48:51], v[128:131]
    ds_read_b64_tr_b16 a[108:109], v5 offset:8192
    ds_read_b64_tr_b16 a[110:111], v5 offset:10240
    v_mfma_f32_16x16x32_bf16 v[176:179], a[96:99], v[60:63], v[176:179]
    v_exp_f32 v69, v69
    v_mfma_f32_16x16x32_bf16 v[224:227], a[96:99], v[72:75], v[224:227]
    v_add_f32 v9, v9, v68
    v_add_f32 v9, v9, v69
    v_mfma_f32_16x16x32_bf16 a[144:147], a[96:99], v[84:87], a[144:147]
    v_cvt_pk_bf16_f32 v66, v68, v69
    v_mfma_f32_16x16x32_bf16 a[192:195], a[96:99], v[16:19], a[192:195]
    v_exp_f32 v70, v70
    v_mfma_f32_16x16x32_bf16 a[240:243], a[96:99], v[32:35], a[240:243]
    s_waitcnt lgkmcnt(4)
    v_exp_f32 v71, v71
    v_mfma_f32_16x16x32_bf16 v[132:135], a[100:103], v[48:51], v[132:135]
    v_mfma_f32_16x16x32_bf16 v[180:183], a[100:103], v[60:63], v[180:183]
    ds_read_b128 a[96:99], v0 offset:0
    v_add_f32 v9, v9, v70
    v_mfma_f32_16x16x32_bf16 v[228:231], a[100:103], v[72:75], v[228:231]
    v_add_f32 v9, v9, v71
    v_cvt_pk_bf16_f32 v67, v70, v71
    v_mfma_f32_16x16x32_bf16 a[148:151], a[100:103], v[84:87], a[148:151]
    s_add_u32 m0, s45, 7936
    v_exp_f32 v56, v56
    v_mfma_f32_16x16x32_bf16 a[196:199], a[100:103], v[16:19], a[196:199]
    buffer_load_dwordx4 v7, s[24:27], s43 offen offset:256 nt lds
    v_mfma_f32_16x16x32_bf16 a[244:247], a[100:103], v[32:35], a[244:247]
    s_waitcnt lgkmcnt(3)
    v_exp_f32 v57, v57
    v_mfma_f32_16x16x32_bf16 v[136:139], a[104:107], v[48:51], v[136:139]
    s_add_u32 s43, s43, 12288
    v_add_f32 v8, v8, v56
    v_mfma_f32_16x16x32_bf16 v[184:187], a[104:107], v[60:63], v[184:187]
    s_add_u32 s45, s45, 12288
    ds_read_b128 a[100:103], v1 offset:0
    v_add_f32 v8, v8, v57
    v_mfma_f32_16x16x32_bf16 v[232:235], a[104:107], v[72:75], v[232:235]
    s_cmp_eq_u32 s45, s50
    v_exp_f32 v58, v58
    v_mfma_f32_16x16x32_bf16 a[152:155], a[104:107], v[84:87], a[152:155]
    s_cselect_b32 s45, s52, s45
    v_cvt_pk_bf16_f32 v54, v56, v57
    v_mfma_f32_16x16x32_bf16 a[200:203], a[104:107], v[16:19], a[200:203]
    v_exp_f32 v59, v59
    v_mfma_f32_16x16x32_bf16 a[248:251], a[104:107], v[32:35], a[248:251]
    s_waitcnt lgkmcnt(2)
    v_add_f32 v8, v8, v58
    v_mfma_f32_16x16x32_bf16 v[140:143], a[108:111], v[48:51], v[140:143]
    v_add_f32 v8, v8, v59
    v_mfma_f32_16x16x32_bf16 v[188:191], a[108:111], v[60:63], v[188:191]
    s_add_u32 s42, s42, 1
    v_cvt_pk_bf16_f32 v55, v58, v59
    v_mfma_f32_16x16x32_bf16 v[236:239], a[108:111], v[72:75], v[236:239]
    s_cmp_lt_u32 s42, 7
    v_mfma_f32_16x16x32_bf16 a[156:159], a[108:111], v[84:87], a[156:159]
    v_mfma_f32_16x16x32_bf16 a[204:207], a[108:111], v[16:19], a[204:207]
    v_mfma_f32_16x16x32_bf16 a[252:255], a[108:111], v[32:35], a[252:255]
    s_waitcnt lgkmcnt(1)
    s_cbranch_scc1 L_loop
    v_subrev_u32 v0, 24576, v0
    v_subrev_u32 v1, 24576, v1
    v_mfma_f32_16x16x32_bf16 v[48:51], a[96:99], a[0:3], 0
    s_waitcnt lgkmcnt(0)
    ds_read_b128 a[104:107], v0 offset:28672
    ds_read_b128 a[108:111], v1 offset:28672
    v_mfma_f32_16x16x32_bf16 v[48:51], a[100:103], a[4:7], v[48:51]
    ds_read_b128 a[112:115], v0 offset:32768
    ds_read_b128 a[116:119], v1 offset:32768
    v_mfma_f32_16x16x32_bf16 v[60:63], a[96:99], a[24:27], 0
    v_exp_f32 v20, v20
    v_mfma_f32_16x16x32_bf16 v[60:63], a[100:103], a[28:31], v[60:63]
    ds_read_b128 a[120:123], v0 offset:26624
    v_add_f32 v12, v12, v20
    v_mfma_f32_16x16x32_bf16 v[72:75], a[96:99], a[48:51], 0
    ds_read_b128 a[124:127], v1 offset:26624
    v_mfma_f32_16x16x32_bf16 v[72:75], a[100:103], a[52:55], v[72:75]
    s_waitcnt lgkmcnt(5)
    v_exp_f32 v21, v21
    v_mfma_f32_16x16x32_bf16 v[48:51], a[104:107], a[8:11], v[48:51]
    s_waitcnt lgkmcnt(4)
    v_exp_f32 v22, v22
    v_mfma_f32_16x16x32_bf16 v[48:51], a[108:111], a[12:15], v[48:51]
    v_exp_f32 v23, v23
    v_mfma_f32_16x16x32_bf16 v[60:63], a[104:107], a[32:35], v[60:63]
    v_exp_f32 v28, v28
    v_mfma_f32_16x16x32_bf16 v[60:63], a[108:111], a[36:39], v[60:63]
    ds_read_b128 a[96:99], v0 offset:30720
    v_add_f32 v12, v12, v21
    v_mfma_f32_16x16x32_bf16 v[72:75], a[104:107], a[56:59], v[72:75]
    ds_read_b128 a[100:103], v1 offset:30720
    v_cvt_pk_bf16_f32 v20, v20, v21
    v_mfma_f32_16x16x32_bf16 v[72:75], a[108:111], a[60:63], v[72:75]
    s_waitcnt lgkmcnt(5)
    v_exp_f32 v29, v29
    v_mfma_f32_16x16x32_bf16 v[48:51], a[112:115], a[16:19], v[48:51]
    s_waitcnt lgkmcnt(4)
    v_exp_f32 v30, v30
    v_mfma_f32_16x16x32_bf16 v[48:51], a[116:119], a[20:23], v[48:51]
    v_exp_f32 v31, v31
    v_mfma_f32_16x16x32_bf16 v[60:63], a[112:115], a[40:43], v[60:63]
    v_add_f32 v12, v12, v22
    v_add_f32 v12, v12, v23
    v_mfma_f32_16x16x32_bf16 v[60:63], a[116:119], a[44:47], v[60:63]
    ds_read_b128 a[104:107], v0 offset:34816
    v_cvt_pk_bf16_f32 v21, v22, v23
    v_mfma_f32_16x16x32_bf16 v[72:75], a[112:115], a[64:67], v[72:75]
    ds_read_b128 a[108:111], v1 offset:34816
    v_add_f32 v12, v12, v28
    v_mfma_f32_16x16x32_bf16 v[72:75], a[116:119], a[68:71], v[72:75]
    s_waitcnt lgkmcnt(5)
    v_add_f32 v12, v12, v29
    v_cvt_pk_bf16_f32 v22, v28, v29
    v_mfma_f32_16x16x32_bf16 v[56:59], a[120:123], a[0:3], 0
    s_waitcnt lgkmcnt(4)
    v_exp_f32 v48, v48
    v_mfma_f32_16x16x32_bf16 v[56:59], a[124:127], a[4:7], v[56:59]
    v_exp_f32 v49, v49
    v_mfma_f32_16x16x32_bf16 v[68:71], a[120:123], a[24:27], 0
    v_exp_f32 v50, v50
    v_mfma_f32_16x16x32_bf16 v[68:71], a[124:127], a[28:31], v[68:71]
    ds_read_b64_tr_b16 a[112:113], v2 offset:36864
    ds_read_b64_tr_b16 a[114:115], v2 offset:38912
    v_mfma_f32_16x16x32_bf16 v[80:83], a[120:123], a[48:51], 0
    v_exp_f32 v51, v51
    v_mfma_f32_16x16x32_bf16 v[80:83], a[124:127], a[52:55], v[80:83]
    s_waitcnt lgkmcnt(5)
    v_exp_f32 v60, v60
    v_mfma_f32_16x16x32_bf16 v[56:59], a[96:99], a[8:11], v[56:59]
    s_waitcnt lgkmcnt(4)
    v_exp_f32 v61, v61
    v_mfma_f32_16x16x32_bf16 v[56:59], a[100:103], a[12:15], v[56:59]
    ds_read_b64_tr_b16 a[116:117], v3 offset:36864
    ds_read_b64_tr_b16 a[118:119], v3 offset:38912
    v_mfma_f32_16x16x32_bf16 v[68:71], a[96:99], a[32:35], v[68:71]
    v_add_f32 v12, v12, v30
    v_add_f32 v12, v12, v31
    v_mfma_f32_16x16x32_bf16 v[68:71], a[100:103], a[36:39], v[68:71]
    ds_read_b64_tr_b16 a[120:121], v4 offset:36864
    ds_read_b64_tr_b16 a[122:123], v4 offset:38912
    v_mfma_f32_16x16x32_bf16 v[80:83], a[96:99], a[56:59], v[80:83]
    v_exp_f32 v62, v62
    v_mfma_f32_16x16x32_bf16 v[80:83], a[100:103], a[60:63], v[80:83]
    s_waitcnt lgkmcnt(7)
    v_exp_f32 v63, v63
    v_mfma_f32_16x16x32_bf16 v[56:59], a[104:107], a[16:19], v[56:59]
    s_waitcnt lgkmcnt(6)
    v_exp_f32 v72, v72
    v_mfma_f32_16x16x32_bf16 v[56:59], a[108:111], a[20:23], v[56:59]
    ds_read_b64_tr_b16 a[124:125], v5 offset:36864
    ds_read_b64_tr_b16 a[126:127], v5 offset:38912
    v_mfma_f32_16x16x32_bf16 v[68:71], a[104:107], a[40:43], v[68:71]
    v_exp_f32 v73, v73
    v_mfma_f32_16x16x32_bf16 v[68:71], a[108:111], a[44:47], v[68:71]
    ds_read_b64_tr_b16 a[96:97], v2 offset:40960
    ds_read_b64_tr_b16 a[98:99], v2 offset:43008
    v_mfma_f32_16x16x32_bf16 v[80:83], a[104:107], a[64:67], v[80:83]
    v_cvt_pk_bf16_f32 v23, v30, v31
    v_add_f32 v8, v8, v48
    v_mfma_f32_16x16x32_bf16 v[80:83], a[108:111], a[68:71], v[80:83]
    s_waitcnt lgkmcnt(8)
    v_add_f32 v8, v8, v49
    v_cvt_pk_bf16_f32 v48, v48, v49
    v_mfma_f32_16x16x32_bf16 v[96:99], a[112:115], v[52:55], v[96:99]
    v_add_f32 v8, v8, v50
    v_add_f32 v8, v8, v51
    v_mfma_f32_16x16x32_bf16 v[144:147], a[112:115], v[64:67], v[144:147]
    ds_read_b64_tr_b16 a[100:101], v3 offset:40960
    ds_read_b64_tr_b16 a[102:103], v3 offset:43008
    v_mfma_f32_16x16x32_bf16 v[192:195], a[112:115], v[76:79], v[192:195]
    s_waitcnt lgkmcnt(8)
    v_exp_f32 v74, v74
    v_mfma_f32_16x16x32_bf16 v[100:103], a[116:119], v[52:55], v[100:103]
    ds_read_b64_tr_b16 a[104:105], v4 offset:40960
    ds_read_b64_tr_b16 a[106:107], v4 offset:43008
    v_mfma_f32_16x16x32_bf16 v[148:151], a[116:119], v[64:67], v[148:151]
    v_exp_f32 v75, v75
    v_mfma_f32_16x16x32_bf16 v[196:199], a[116:119], v[76:79], v[196:199]
    s_waitcnt lgkmcnt(8)
    v_exp_f32 v56, v56
    v_mfma_f32_16x16x32_bf16 v[104:107], a[120:123], v[52:55], v[104:107]
    v_exp_f32 v57, v57
    v_mfma_f32_16x16x32_bf16 v[152:155], a[120:123], v[64:67], v[152:155]
    ds_read_b64_tr_b16 a[108:109], v5 offset:40960
    ds_read_b64_tr_b16 a[110:111], v5 offset:43008
    v_mfma_f32_16x16x32_bf16 v[200:203], a[120:123], v[76:79], v[200:203]
    s_waitcnt lgkmcnt(8)
    v_cvt_pk_bf16_f32 v49, v50, v51
    v_add_f32 v9, v9, v60
    v_mfma_f32_16x16x32_bf16 v[108:111], a[124:127], v[52:55], v[108:111]
    ds_read_b64_tr_b16 a[112:113], v2 offset:45056
    ds_read_b64_tr_b16 a[114:115], v2 offset:47104
    v_mfma_f32_16x16x32_bf16 v[156:159], a[124:127], v[64:67], v[156:159]
    v_add_f32 v9, v9, v61
    v_cvt_pk_bf16_f32 v60, v60, v61
    v_mfma_f32_16x16x32_bf16 v[204:207], a[124:127], v[76:79], v[204:207]
    s_waitcnt lgkmcnt(8)
    v_add_f32 v9, v9, v62
    v_add_f32 v9, v9, v63
    v_mfma_f32_16x16x32_bf16 v[112:115], a[96:99], v[52:55], v[112:115]
    v_cvt_pk_bf16_f32 v61, v62, v63
    v_add_f32 v10, v10, v72
    v_mfma_f32_16x16x32_bf16 v[160:163], a[96:99], v[64:67], v[160:163]
    ds_read_b64_tr_b16 a[116:117], v3 offset:45056
    ds_read_b64_tr_b16 a[118:119], v3 offset:47104
    v_mfma_f32_16x16x32_bf16 v[208:211], a[96:99], v[76:79], v[208:211]
    s_waitcnt lgkmcnt(8)
    v_add_f32 v10, v10, v73
    v_cvt_pk_bf16_f32 v72, v72, v73
    v_mfma_f32_16x16x32_bf16 v[116:119], a[100:103], v[52:55], v[116:119]
    s_waitcnt vmcnt(12)
    ds_read_b64_tr_b16 a[120:121], v4 offset:45056
    ds_read_b64_tr_b16 a[122:123], v4 offset:47104
    v_mfma_f32_16x16x32_bf16 v[164:167], a[100:103], v[64:67], v[164:167]
    s_barrier
    v_add_f32 v10, v10, v74
    v_add_f32 v10, v10, v75
    v_mfma_f32_16x16x32_bf16 v[212:215], a[100:103], v[76:79], v[212:215]
    s_waitcnt lgkmcnt(8)
    v_exp_f32 v58, v58
    v_mfma_f32_16x16x32_bf16 v[120:123], a[104:107], v[52:55], v[120:123]
    v_exp_f32 v59, v59
    v_mfma_f32_16x16x32_bf16 v[168:171], a[104:107], v[64:67], v[168:171]
    ds_read_b64_tr_b16 a[124:125], v5 offset:45056
    ds_read_b64_tr_b16 a[126:127], v5 offset:47104
    v_mfma_f32_16x16x32_bf16 v[216:219], a[104:107], v[76:79], v[216:219]
    s_waitcnt lgkmcnt(8)
    v_cvt_pk_bf16_f32 v73, v74, v75
    v_add_f32 v8, v8, v56
    v_mfma_f32_16x16x32_bf16 v[124:127], a[108:111], v[52:55], v[124:127]
    ds_read_b128 a[96:99], v0 offset:36864
    v_add_f32 v8, v8, v57
    v_mfma_f32_16x16x32_bf16 v[172:175], a[108:111], v[64:67], v[172:175]
    ds_read_b128 a[100:103], v1 offset:36864
    v_cvt_pk_bf16_f32 v50, v56, v57
    v_mfma_f32_16x16x32_bf16 v[220:223], a[108:111], v[76:79], v[220:223]
    s_waitcnt lgkmcnt(8)
    v_exp_f32 v68, v68
    v_mfma_f32_16x16x32_bf16 v[128:131], a[112:115], v[52:55], v[128:131]
    v_exp_f32 v69, v69
    v_mfma_f32_16x16x32_bf16 v[176:179], a[112:115], v[64:67], v[176:179]
    v_add_f32 v8, v8, v58
    v_add_f32 v8, v8, v59
    v_mfma_f32_16x16x32_bf16 v[224:227], a[112:115], v[76:79], v[224:227]
    s_waitcnt lgkmcnt(6)
    v_exp_f32 v70, v70
    v_mfma_f32_16x16x32_bf16 v[132:135], a[116:119], v[52:55], v[132:135]
    ds_read_b128 a[104:107], v0 offset:38912
    v_cvt_pk_bf16_f32 v51, v58, v59
    v_mfma_f32_16x16x32_bf16 v[180:183], a[116:119], v[64:67], v[180:183]
    ds_read_b128 a[108:111], v1 offset:38912
    v_add_f32 v9, v9, v68
    v_mfma_f32_16x16x32_bf16 v[228:231], a[116:119], v[76:79], v[228:231]
    s_waitcnt lgkmcnt(6)
    v_exp_f32 v71, v71
    v_mfma_f32_16x16x32_bf16 v[136:139], a[120:123], v[52:55], v[136:139]
    v_exp_f32 v80, v80
    v_mfma_f32_16x16x32_bf16 v[184:187], a[120:123], v[64:67], v[184:187]
    v_exp_f32 v81, v81
    v_mfma_f32_16x16x32_bf16 v[232:235], a[120:123], v[76:79], v[232:235]
    s_waitcnt lgkmcnt(4)
    v_add_f32 v9, v9, v69
    v_cvt_pk_bf16_f32 v62, v68, v69
    v_mfma_f32_16x16x32_bf16 v[140:143], a[124:127], v[52:55], v[140:143]
    ds_read_b128 a[112:115], v0 offset:40960
    v_add_f32 v9, v9, v70
    v_mfma_f32_16x16x32_bf16 v[188:191], a[124:127], v[64:67], v[188:191]
    ds_read_b128 a[116:119], v1 offset:40960
    v_add_f32 v9, v9, v71
    v_mfma_f32_16x16x32_bf16 v[236:239], a[124:127], v[76:79], v[236:239]
    s_waitcnt lgkmcnt(5)
    v_exp_f32 v82, v82
    v_mfma_f32_16x16x32_bf16 v[52:55], a[96:99], a[0:3], 0
    s_waitcnt lgkmcnt(4)
    v_exp_f32 v83, v83
    v_mfma_f32_16x16x32_bf16 v[52:55], a[100:103], a[4:7], v[52:55]
    v_cvt_pk_bf16_f32 v63, v70, v71
    v_add_f32 v10, v10, v80
    v_mfma_f32_16x16x32_bf16 v[64:67], a[96:99], a[24:27], 0
    s_waitcnt vmcnt(9)
    v_add_f32 v10, v10, v81
    v_cvt_pk_bf16_f32 v74, v80, v81
    v_mfma_f32_16x16x32_bf16 v[64:67], a[100:103], a[28:31], v[64:67]
    s_barrier
    ds_read_b128 a[120:123], v0 offset:43008
    v_add_f32 v10, v10, v82
    v_mfma_f32_16x16x32_bf16 v[76:79], a[96:99], a[48:51], 0
    ds_read_b128 a[124:127], v1 offset:43008
    v_add_f32 v10, v10, v83
    v_mfma_f32_16x16x32_bf16 v[76:79], a[100:103], a[52:55], v[76:79]
    s_waitcnt lgkmcnt(5)
    v_cvt_pk_bf16_f32 v75, v82, v83
    v_mfma_f32_16x16x32_bf16 v[24:27], a[104:107], a[0:3], 0
    s_waitcnt lgkmcnt(4)
    v_mfma_f32_16x16x32_bf16 v[24:27], a[108:111], a[4:7], v[24:27]
    v_mfma_f32_16x16x32_bf16 v[40:43], a[104:107], a[24:27], 0
    ds_read_b64_tr_b16 a[0:1], v2 offset:12288
    ds_read_b64_tr_b16 a[2:3], v2 offset:14336
    v_mfma_f32_16x16x32_bf16 v[40:43], a[108:111], a[28:31], v[40:43]
    ds_read_b128 a[96:99], v0 offset:45056
    v_mfma_f32_16x16x32_bf16 v[32:35], a[104:107], a[48:51], 0
    ds_read_b128 a[100:103], v1 offset:45056
    v_mfma_f32_16x16x32_bf16 v[32:35], a[108:111], a[52:55], v[32:35]
    s_waitcnt lgkmcnt(7)
    ds_read_b64_tr_b16 a[4:5], v3 offset:12288
    ds_read_b64_tr_b16 a[6:7], v3 offset:14336
    v_mfma_f32_16x16x32_bf16 v[52:55], a[112:115], a[8:11], v[52:55]
    s_waitcnt lgkmcnt(8)
    ds_read_b64_tr_b16 a[24:25], v4 offset:12288
    ds_read_b64_tr_b16 a[26:27], v4 offset:14336
    v_mfma_f32_16x16x32_bf16 v[52:55], a[116:119], a[12:15], v[52:55]
    ds_read_b64_tr_b16 a[28:29], v5 offset:12288
    ds_read_b64_tr_b16 a[30:31], v5 offset:14336
    v_mfma_f32_16x16x32_bf16 v[64:67], a[112:115], a[32:35], v[64:67]
    ds_read_b64_tr_b16 a[48:49], v2 offset:16384
    ds_read_b64_tr_b16 a[50:51], v2 offset:18432
    v_mfma_f32_16x16x32_bf16 v[64:67], a[116:119], a[36:39], v[64:67]
    ds_read_b128 a[104:107], v0 offset:47104
    v_mfma_f32_16x16x32_bf16 v[76:79], a[112:115], a[56:59], v[76:79]
    ds_read_b128 a[108:111], v1 offset:47104
    v_mfma_f32_16x16x32_bf16 v[76:79], a[116:119], a[60:63], v[76:79]
    s_waitcnt lgkmcnt(12)
    ds_read_b64_tr_b16 a[52:53], v3 offset:16384
    ds_read_b64_tr_b16 a[54:55], v3 offset:18432
    v_mfma_f32_16x16x32_bf16 v[24:27], a[120:123], a[8:11], v[24:27]
    s_waitcnt vmcnt(0)
    ds_read_b64_tr_b16 a[112:113], v4 offset:16384
    ds_read_b64_tr_b16 a[114:115], v4 offset:18432
    v_mfma_f32_16x16x32_bf16 v[24:27], a[124:127], a[12:15], v[24:27]
    s_barrier
    ds_read_b64_tr_b16 a[116:117], v5 offset:16384
    ds_read_b64_tr_b16 a[118:119], v5 offset:18432
    v_mfma_f32_16x16x32_bf16 v[40:43], a[120:123], a[32:35], v[40:43]
    ds_read_b64_tr_b16 a[8:9], v2 offset:20480
    ds_read_b64_tr_b16 a[10:11], v2 offset:22528
    v_mfma_f32_16x16x32_bf16 v[40:43], a[124:127], a[36:39], v[40:43]
    ds_read_b64_tr_b16 a[12:13], v3 offset:20480
    ds_read_b64_tr_b16 a[14:15], v3 offset:22528
    v_mfma_f32_16x16x32_bf16 v[32:35], a[120:123], a[56:59], v[32:35]
    ds_read_b64_tr_b16 a[32:33], v4 offset:20480
    ds_read_b64_tr_b16 a[34:35], v4 offset:22528
    v_mfma_f32_16x16x32_bf16 v[32:35], a[124:127], a[60:63], v[32:35]
    s_waitcnt lgkmcnt(12)
    ds_read_b64_tr_b16 a[36:37], v5 offset:20480
    ds_read_b64_tr_b16 a[38:39], v5 offset:22528
    v_mfma_f32_16x16x32_bf16 v[52:55], a[96:99], a[16:19], v[52:55]
    ds_read_b64_tr_b16 a[56:57], v2 offset:49152
    ds_read_b64_tr_b16 a[58:59], v2 offset:51200
    v_mfma_f32_16x16x32_bf16 v[52:55], a[100:103], a[20:23], v[52:55]
    ds_read_b64_tr_b16 a[60:61], v3 offset:49152
    ds_read_b64_tr_b16 a[62:63], v3 offset:51200
    v_mfma_f32_16x16x32_bf16 v[64:67], a[96:99], a[40:43], v[64:67]
    ds_read_b64_tr_b16 a[120:121], v4 offset:49152
    ds_read_b64_tr_b16 a[122:123], v4 offset:51200
    v_mfma_f32_16x16x32_bf16 v[64:67], a[100:103], a[44:47], v[64:67]
    ds_read_b64_tr_b16 a[124:125], v5 offset:49152
    ds_read_b64_tr_b16 a[126:127], v5 offset:51200
    v_mfma_f32_16x16x32_bf16 v[76:79], a[96:99], a[64:67], v[76:79]
    v_mfma_f32_16x16x32_bf16 v[76:79], a[100:103], a[68:71], v[76:79]
    ds_read_b64_tr_b16 a[96:97], v2 offset:53248
    ds_read_b64_tr_b16 a[98:99], v2 offset:55296
    v_mfma_f32_16x16x32_bf16 v[24:27], a[104:107], a[16:19], v[24:27]
    ds_read_b64_tr_b16 a[100:101], v3 offset:53248
    ds_read_b64_tr_b16 a[102:103], v3 offset:55296
    v_mfma_f32_16x16x32_bf16 v[24:27], a[108:111], a[20:23], v[24:27]
    v_exp_f32 v52, v52
    v_mfma_f32_16x16x32_bf16 v[40:43], a[104:107], a[40:43], v[40:43]
    ds_read_b64_tr_b16 a[16:17], v4 offset:53248
    ds_read_b64_tr_b16 a[18:19], v4 offset:55296
    v_mfma_f32_16x16x32_bf16 v[40:43], a[108:111], a[44:47], v[40:43]
    v_exp_f32 v53, v53
    v_mfma_f32_16x16x32_bf16 v[32:35], a[104:107], a[64:67], v[32:35]
    ds_read_b64_tr_b16 a[20:21], v5 offset:53248
    ds_read_b64_tr_b16 a[22:23], v5 offset:55296
    v_mfma_f32_16x16x32_bf16 v[32:35], a[108:111], a[68:71], v[32:35]
    v_exp_f32 v54, v54
    v_mfma_f32_16x16x32_bf16 v[96:99], a[0:3], v[48:51], v[96:99]
    ds_read_b64_tr_b16 a[40:41], v2 offset:57344
    ds_read_b64_tr_b16 a[42:43], v2 offset:59392
    v_exp_f32 v55, v55
    v_mfma_f32_16x16x32_bf16 v[100:103], a[4:7], v[48:51], v[100:103]
    v_exp_f32 v24, v24
    v_add_f32 v8, v8, v52
    v_mfma_f32_16x16x32_bf16 v[104:107], a[24:27], v[48:51], v[104:107]
    ds_read_b64_tr_b16 a[44:45], v3 offset:57344
    ds_read_b64_tr_b16 a[46:47], v3 offset:59392
    v_add_f32 v8, v8, v53
    v_mfma_f32_16x16x32_bf16 v[108:111], a[28:31], v[48:51], v[108:111]
    v_exp_f32 v25, v25
    v_cvt_pk_bf16_f32 v52, v52, v53
    v_mfma_f32_16x16x32_bf16 v[112:115], a[48:51], v[48:51], v[112:115]
    s_waitcnt lgkmcnt(12)
    ds_read_b64_tr_b16 a[64:65], v4 offset:57344
    ds_read_b64_tr_b16 a[66:67], v4 offset:59392
    v_add_f32 v8, v8, v54
    v_mfma_f32_16x16x32_bf16 v[116:119], a[52:55], v[48:51], v[116:119]
    v_exp_f32 v26, v26
    v_add_f32 v8, v8, v55
    v_mfma_f32_16x16x32_bf16 v[120:123], a[112:115], v[48:51], v[120:123]
    ds_read_b64_tr_b16 a[68:69], v5 offset:57344
    ds_read_b64_tr_b16 a[70:71], v5 offset:59392
    v_cvt_pk_bf16_f32 v53, v54, v55
    v_mfma_f32_16x16x32_bf16 v[124:127], a[116:119], v[48:51], v[124:127]
    v_add_f32 v8, v8, v24
    v_add_f32 v8, v8, v25
    v_cvt_pk_bf16_f32 v54, v24, v25
    v_mfma_f32_16x16x32_bf16 v[128:131], a[8:11], v[48:51], v[128:131]
    v_add_f32 v8, v8, v26
    v_exp_f32 v27, v27
    v_mfma_f32_16x16x32_bf16 v[132:135], a[12:15], v[48:51], v[132:135]
    v_add_f32 v8, v8, v27
    v_cvt_pk_bf16_f32 v55, v26, v27
    v_mov_b32 v24, v8
    v_mfma_f32_16x16x32_bf16 v[136:139], a[32:35], v[48:51], v[136:139]
    v_exp_f32 v64, v64
    v_mfma_f32_16x16x32_bf16 v[140:143], a[36:39], v[48:51], v[140:143]
    v_exp_f32 v65, v65
    v_mfma_f32_16x16x32_bf16 v[96:99], a[56:59], v[52:55], v[96:99]
    v_exp_f32 v66, v66
    v_mfma_f32_16x16x32_bf16 v[100:103], a[60:63], v[52:55], v[100:103]
    v_exp_f32 v67, v67
    v_mfma_f32_16x16x32_bf16 v[104:107], a[120:123], v[52:55], v[104:107]
    v_permlane32_swap_b32 v8, v24
    v_add_f32 v8, v8, v24
    v_mfma_f32_16x16x32_bf16 v[108:111], a[124:127], v[52:55], v[108:111]
    s_waitcnt lgkmcnt(12)
    v_mov_b32 v24, v8
    v_add_f32 v9, v9, v64
    v_mfma_f32_16x16x32_bf16 v[112:115], a[96:99], v[52:55], v[112:115]
L_hop1:
    s_cbranch_execz L_hopback0
    ds_read_b64 v[16:17], v6 offset:13056
    v_add_f32 v9, v9, v65
    v_mfma_f32_16x16x32_bf16 v[116:119], a[100:103], v[52:55], v[116:119]
    s_waitcnt lgkmcnt(11)
    v_permlane16_swap_b32 v8, v24
    v_add_f32 v8, v8, v24
    v_mfma_f32_16x16x32_bf16 v[120:123], a[16:19], v[52:55], v[120:123]
    s_waitcnt lgkmcnt(9)
    v_cmp_nle_f32 vcc, s76, v8
    v_cmp_nge_f32 s[80:81], s77, v8
    v_mfma_f32_16x16x32_bf16 v[124:127], a[20:23], v[52:55], v[124:127]
    s_waitcnt lgkmcnt(7)
    v_rcp_f32 v8, v8
    v_mfma_f32_16x16x32_bf16 v[128:131], a[40:43], v[52:55], v[128:131]
    s_waitcnt lgkmcnt(5)
    v_cvt_pk_bf16_f32 v64, v64, v65
    v_add_f32 v9, v9, v66
    v_mfma_f32_16x16x32_bf16 v[132:135], a[44:47], v[52:55], v[132:135]
    s_waitcnt lgkmcnt(3)
    v_add_f32 v9, v9, v67
    v_cvt_pk_bf16_f32 v65, v66, v67
    v_mfma_f32_16x16x32_bf16 v[136:139], a[64:67], v[52:55], v[136:139]
    s_waitcnt lgkmcnt(1)
    v_mfma_f32_16x16x32_bf16 v[140:143], a[68:71], v[52:55], v[140:143]
    s_waitcnt lgkmcnt(0)
    v_mov_b32 v15, v17
    v_xor_b32 v17, 32, v16
    v_xor_b32 v18, 64, v16
    v_xor_b32 v19, 96, v16
    s_or_b64 s[78:79], s[78:79], vcc
    s_or_b64 s[78:79], s[78:79], s[80:81]
    v_pk_mul_f32 v[96:97], v[96:97], v[8:9] op_sel:[0,0] op_sel_hi:[1,0]
    v_pk_mul_f32 v[98:99], v[98:99], v[8:9] op_sel:[0,0] op_sel_hi:[1,0]
    v_pk_mul_f32 v[100:101], v[100:101], v[8:9] op_sel:[0,0] op_sel_hi:[1,0]
    v_pk_mul_f32 v[102:103], v[102:103], v[8:9] op_sel:[0,0] op_sel_hi:[1,0]
    v_pk_mul_f32 v[104:105], v[104:105], v[8:9] op_sel:[0,0] op_sel_hi:[1,0]
    v_pk_mul_f32 v[106:107], v[106:107], v[8:9] op_sel:[0,0] op_sel_hi:[1,0]
    v_pk_mul_f32 v[108:109], v[108:109], v[8:9] op_sel:[0,0] op_sel_hi:[1,0]
    v_pk_mul_f32 v[110:111], v[110:111], v[8:9] op_sel:[0,0] op_sel_hi:[1,0]
    v_cvt_pk_bf16_f32 v96, v96, v97
    v_cvt_pk_bf16_f32 v97, v98, v99
    v_cvt_pk_bf16_f32 v98, v100, v101
    v_cvt_pk_bf16_f32 v99, v102, v103
    v_cvt_pk_bf16_f32 v100, v104, v105
    v_cvt_pk_bf16_f32 v101, v106, v107
    v_cvt_pk_bf16_f32 v102, v108, v109
    v_cvt_pk_bf16_f32 v103, v110, v111
    ds_write_b64 v16, v[96:97] offset:0
    ds_write_b64 v17, v[98:99] offset:0
    ds_write_b64 v18, v[100:101] offset:0
    ds_write_b64 v19, v[102:103] offset:0
    v_pk_mul_f32 v[112:113], v[112:113], v[8:9] op_sel:[0,0] op_sel_hi:[1,0]
    v_pk_mul_f32 v[114:115], v[114:115], v[8:9] op_sel:[0,0] op_sel_hi:[1,0]
    v_pk_mul_f32 v[116:117], v[116:117], v[8:9] op_sel:[0,0] op_sel_hi:[1,0]
    v_pk_mul_f32 v[118:119], v[118:119], v[8:9] op_sel:[0,0] op_sel_hi:[1,0]
    v_pk_mul_f32 v[120:121], v[120:121], v[8:9] op_sel:[0,0] op_sel_hi:[1,0]
    v_pk_mul_f32 v[122:123], v[122:123], v[8:9] op_sel:[0,0] op_sel_hi:[1,0]
    v_pk_mul_f32 v[124:125], v[124:125], v[8:9] op_sel:[0,0] op_sel_hi:[1,0]
    v_pk_mul_f32 v[126:127], v[126:127], v[8:9] op_sel:[0,0] op_sel_hi:[1,0]
    v_cvt_pk_bf16_f32 v112, v112, v113
    v_cvt_pk_bf16_f32 v113, v114, v115
    v_cvt_pk_bf16_f32 v114, v116, v117
    v_cvt_pk_bf16_f32 v115, v118, v119
    v_cvt_pk_bf16_f32 v116, v120, v121
    v_cvt_pk_bf16_f32 v117, v122, v123
    v_cvt_pk_bf16_f32 v118, v124, v125
    v_cvt_pk_bf16_f32 v119, v126, v127
    ds_read_b128 v[104:107], v15 offset:0
    ds_read_b64 v[108:109], v15 offset:1032
    ds_read_b64 v[110:111], v15 offset:1024
    ds_write_b64 v16, v[112:113] offset:2048
    ds_write_b64 v17, v[114:115] offset:2048
    ds_write_b64 v18, v[116:117] offset:2048
    ds_write_b64 v19, v[118:119] offset:2048
    v_pk_mul_f32 v[128:129], v[128:129], v[8:9] op_sel:[0,0] op_sel_hi:[1,0]
    v_pk_mul_f32 v[130:131], v[130:131], v[8:9] op_sel:[0,0] op_sel_hi:[1,0]
    v_pk_mul_f32 v[132:133], v[132:133], v[8:9] op_sel:[0,0] op_sel_hi:[1,0]
    v_pk_mul_f32 v[134:135], v[134:135], v[8:9] op_sel:[0,0] op_sel_hi:[1,0]
    v_pk_mul_f32 v[136:137], v[136:137], v[8:9] op_sel:[0,0] op_sel_hi:[1,0]
    v_pk_mul_f32 v[138:139], v[138:139], v[8:9] op_sel:[0,0] op_sel_hi:[1,0]
    v_pk_mul_f32 v[140:141], v[140:141], v[8:9] op_sel:[0,0] op_sel_hi:[1,0]
    v_pk_mul_f32 v[142:143], v[142:143], v[8:9] op_sel:[0,0] op_sel_hi:[1,0]
    s_waitcnt lgkmcnt(4)
    buffer_store_dwordx4 v[104:107], v14, s[32:35], 0 offen offset:0 sc1
    v_cvt_pk_bf16_f32 v128, v128, v129
    v_cvt_pk_bf16_f32 v129, v130, v131
    v_cvt_pk_bf16_f32 v130, v132, v133
    v_cvt_pk_bf16_f32 v131, v134, v135
    v_cvt_pk_bf16_f32 v132, v136, v137
    v_cvt_pk_bf16_f32 v133, v138, v139
    v_cvt_pk_bf16_f32 v134, v140, v141
    v_cvt_pk_bf16_f32 v135, v142, v143
    buffer_store_dwordx4 v[108:111], v14, s[32:35], 0 offen offset:3072 sc1
    ds_read_b128 v[120:123], v15 offset:2048
    ds_read_b64 v[124:125], v15 offset:3080
    ds_read_b64 v[126:127], v15 offset:3072
    ds_write_b64 v16, v[128:129] offset:4096
    ds_write_b64 v17, v[130:131] offset:4096
    ds_write_b64 v18, v[132:133] offset:4096
    ds_write_b64 v19, v[134:135] offset:4096
    v_mfma_f32_16x16x32_bf16 v[144:147], a[0:3], v[60:63], v[144:147]
    s_waitcnt lgkmcnt(4)
    v_exp_f32 v40, v40
    v_mfma_f32_16x16x32_bf16 v[148:151], a[4:7], v[60:63], v[148:151]
    buffer_store_dwordx4 v[120:123], v14, s[32:35], 0 offen offset:128 sc1
    v_mfma_f32_16x16x32_bf16 v[152:155], a[24:27], v[60:63], v[152:155]
    v_exp_f32 v41, v41
    v_mfma_f32_16x16x32_bf16 v[156:159], a[28:31], v[60:63], v[156:159]
    v_exp_f32 v42, v42
    v_mfma_f32_16x16x32_bf16 v[160:163], a[48:51], v[60:63], v[160:163]
    buffer_store_dwordx4 v[124:127], v14, s[32:35], 0 offen offset:3200 sc1
    v_mfma_f32_16x16x32_bf16 v[164:167], a[52:55], v[60:63], v[164:167]
    v_exp_f32 v43, v43
    v_add_f32 v9, v9, v40
    v_mfma_f32_16x16x32_bf16 v[168:171], a[112:115], v[60:63], v[168:171]
    v_exp_f32 v76, v76
    v_mfma_f32_16x16x32_bf16 v[172:175], a[116:119], v[60:63], v[172:175]
    ds_read_b128 v[136:139], v15 offset:4096
    ds_read_b64 v[140:141], v15 offset:5128
    v_mfma_f32_16x16x32_bf16 v[176:179], a[8:11], v[60:63], v[176:179]
    ds_read_b64 v[142:143], v15 offset:5120
    v_add_f32 v9, v9, v41
    v_mfma_f32_16x16x32_bf16 v[180:183], a[12:15], v[60:63], v[180:183]
    v_cvt_pk_bf16_f32 v66, v40, v41
    v_add_f32 v9, v9, v42
    v_mfma_f32_16x16x32_bf16 v[184:187], a[32:35], v[60:63], v[184:187]
    v_add_f32 v9, v9, v43
    v_cvt_pk_bf16_f32 v67, v42, v43
    v_mfma_f32_16x16x32_bf16 v[188:191], a[36:39], v[60:63], v[188:191]
    v_exp_f32 v77, v77
    v_mfma_f32_16x16x32_bf16 v[144:147], a[56:59], v[64:67], v[144:147]
    v_exp_f32 v78, v78
    v_mfma_f32_16x16x32_bf16 v[148:151], a[60:63], v[64:67], v[148:151]
    v_exp_f32 v79, v79
    v_mfma_f32_16x16x32_bf16 v[152:155], a[120:123], v[64:67], v[152:155]
    v_mov_b32 v40, v9
    v_add_f32 v10, v10, v76
    v_mfma_f32_16x16x32_bf16 v[156:159], a[124:127], v[64:67], v[156:159]
    v_add_f32 v10, v10, v77
    v_cvt_pk_bf16_f32 v76, v76, v77
    v_mfma_f32_16x16x32_bf16 v[160:163], a[96:99], v[64:67], v[160:163]
    s_waitcnt lgkmcnt(0)
    v_permlane32_swap_b32 v9, v40
    v_add_f32 v9, v9, v40
    v_mfma_f32_16x16x32_bf16 v[164:167], a[100:103], v[64:67], v[164:167]
    buffer_store_dwordx4 v[136:139], v14, s[32:35], 0 offen offset:256 sc1
    v_mfma_f32_16x16x32_bf16 v[168:171], a[16:19], v[64:67], v[168:171]
    v_mov_b32 v40, v9
    v_add_f32 v10, v10, v78
    v_mfma_f32_16x16x32_bf16 v[172:175], a[20:23], v[64:67], v[172:175]
    v_add_f32 v10, v10, v79
    v_cvt_pk_bf16_f32 v77, v78, v79
    v_mfma_f32_16x16x32_bf16 v[176:179], a[40:43], v[64:67], v[176:179]
    buffer_store_dwordx4 v[140:143], v14, s[32:35], 0 offen offset:3328 sc1
    v_mfma_f32_16x16x32_bf16 v[180:183], a[44:47], v[64:67], v[180:183]
    v_permlane16_swap_b32 v9, v40
    v_add_f32 v9, v9, v40
    v_mfma_f32_16x16x32_bf16 v[184:187], a[64:67], v[64:67], v[184:187]
    v_cmp_nle_f32 vcc, s76, v9
    v_cmp_nge_f32 s[80:81], s77, v9
    v_mfma_f32_16x16x32_bf16 v[188:191], a[68:71], v[64:67], v[188:191]
    v_rcp_f32 v9, v9
    s_or_b64 s[78:79], s[78:79], vcc
    s_or_b64 s[78:79], s[78:79], s[80:81]
    v_pk_mul_f32 v[144:145], v[144:145], v[8:9] op_sel:[0,1] op_sel_hi:[1,1]
    v_pk_mul_f32 v[146:147], v[146:147], v[8:9] op_sel:[0,1] op_sel_hi:[1,1]
    v_pk_mul_f32 v[148:149], v[148:149], v[8:9] op_sel:[0,1] op_sel_hi:[1,1]
    v_pk_mul_f32 v[150:151], v[150:151], v[8:9] op_sel:[0,1] op_sel_hi:[1,1]
    v_pk_mul_f32 v[152:153], v[152:153], v[8:9] op_sel:[0,1] op_sel_hi:[1,1]
    v_pk_mul_f32 v[154:155], v[154:155], v[8:9] op_sel:[0,1] op_sel_hi:[1,1]
    v_pk_mul_f32 v[156:157], v[156:157], v[8:9] op_sel:[0,1] op_sel_hi:[1,1]
    v_pk_mul_f32 v[158:159], v[158:159], v[8:9] op_sel:[0,1] op_sel_hi:[1,1]
    v_cvt_pk_bf16_f32 v144, v144, v145
    v_cvt_pk_bf16_f32 v145, v146, v147
    v_cvt_pk_bf16_f32 v146, v148, v149
    v_cvt_pk_bf16_f32 v147, v150, v151
    v_cvt_pk_bf16_f32 v148, v152, v153
    v_cvt_pk_bf16_f32 v149, v154, v155
    v_cvt_pk_bf16_f32 v150, v156, v157
    v_cvt_pk_bf16_f32 v151, v158, v159
    ds_write_b64 v16, v[144:145] offset:0
    ds_write_b64 v17, v[146:147] offset:0
    ds_write_b64 v18, v[148:149] offset:0
    ds_write_b64 v19, v[150:151] offset:0
    v_pk_mul_f32 v[160:161], v[160:161], v[8:9] op_sel:[0,1] op_sel_hi:[1,1]
    v_pk_mul_f32 v[162:163], v[162:163], v[8:9] op_sel:[0,1] op_sel_hi:[1,1]
    v_pk_mul_f32 v[164:165], v[164:165], v[8:9] op_sel:[0,1] op_sel_hi:[1,1]
    v_pk_mul_f32 v[166:167], v[166:167], v[8:9] op_sel:[0,1] op_sel_hi:[1,1]
    v_pk_mul_f32 v[168:169], v[168:169], v[8:9] op_sel:[0,1] op_sel_hi:[1,1]
    v_pk_mul_f32 v[170:171], v[170:171], v[8:9] op_sel:[0,1] op_sel_hi:[1,1]
    v_pk_mul_f32 v[172:173], v[172:173], v[8:9] op_sel:[0,1] op_sel_hi:[1,1]
    v_pk_mul_f32 v[174:175], v[174:175], v[8:9] op_sel:[0,1] op_sel_hi:[1,1]
    v_cvt_pk_bf16_f32 v160, v160, v161
    v_cvt_pk_bf16_f32 v161, v162, v163
    v_cvt_pk_bf16_f32 v162, v164, v165
    v_cvt_pk_bf16_f32 v163, v166, v167
    v_cvt_pk_bf16_f32 v164, v168, v169
    v_cvt_pk_bf16_f32 v165, v170, v171
    v_cvt_pk_bf16_f32 v166, v172, v173
    v_cvt_pk_bf16_f32 v167, v174, v175
    ds_read_b128 v[152:155], v15 offset:0
    ds_read_b64 v[156:157], v15 offset:1032
    ds_read_b64 v[158:159], v15 offset:1024
    ds_write_b64 v16, v[160:161] offset:2048
    ds_write_b64 v17, v[162:163] offset:2048
    ds_write_b64 v18, v[164:165] offset:2048
    ds_write_b64 v19, v[166:167] offset:2048
    v_pk_mul_f32 v[176:177], v[176:177], v[8:9] op_sel:[0,1] op_sel_hi:[1,1]
    v_pk_mul_f32 v[178:179], v[178:179], v[8:9] op_sel:[0,1] op_sel_hi:[1,1]
    v_pk_mul_f32 v[180:181], v[180:181], v[8:9] op_sel:[0,1] op_sel_hi:[1,1]
    v_pk_mul_f32 v[182:183], v[182:183], v[8:9] op_sel:[0,1] op_sel_hi:[1,1]
    v_pk_mul_f32 v[184:185], v[184:185], v[8:9] op_sel:[0,1] op_sel_hi:[1,1]
    v_pk_mul_f32 v[186:187], v[186:187], v[8:9] op_sel:[0,1] op_sel_hi:[1,1]
    v_pk_mul_f32 v[188:189], v[188:189], v[8:9] op_sel:[0,1] op_sel_hi:[1,1]
    v_pk_mul_f32 v[190:191], v[190:191], v[8:9] op_sel:[0,1] op_sel_hi:[1,1]
    s_waitcnt lgkmcnt(4)
    buffer_store_dwordx4 v[152:155], v14, s[32:35], s55 offen offset:0 sc1
    v_cvt_pk_bf16_f32 v176, v176, v177
    v_cvt_pk_bf16_f32 v177, v178, v179
    v_cvt_pk_bf16_f32 v178, v180, v181
    v_cvt_pk_bf16_f32 v179, v182, v183
    v_cvt_pk_bf16_f32 v180, v184, v185
    v_cvt_pk_bf16_f32 v181, v186, v187
    v_cvt_pk_bf16_f32 v182, v188, v189
    v_cvt_pk_bf16_f32 v183, v190, v191
    buffer_store_dwordx4 v[156:159], v14, s[32:35], s55 offen offset:3072 sc1
    ds_read_b128 v[168:171], v15 offset:2048
    ds_read_b64 v[172:173], v15 offset:3080
    ds_read_b64 v[174:175], v15 offset:3072
    ds_write_b64 v16, v[176:177] offset:4096
    ds_write_b64 v17, v[178:179] offset:4096
    ds_write_b64 v18, v[180:181] offset:4096
    ds_write_b64 v19, v[182:183] offset:4096
    v_mfma_f32_16x16x32_bf16 v[192:195], a[0:3], v[72:75], v[192:195]
    s_waitcnt lgkmcnt(4)
    v_exp_f32 v32, v32
    v_mfma_f32_16x16x32_bf16 v[196:199], a[4:7], v[72:75], v[196:199]
    buffer_store_dwordx4 v[168:171], v14, s[32:35], s55 offen offset:128 sc1
    v_mfma_f32_16x16x32_bf16 v[200:203], a[24:27], v[72:75], v[200:203]
    v_exp_f32 v33, v33
    v_add_f32 v10, v10, v32
    v_mfma_f32_16x16x32_bf16 v[204:207], a[28:31], v[72:75], v[204:207]
    v_exp_f32 v34, v34
    v_add_f32 v10, v10, v33
    v_mfma_f32_16x16x32_bf16 v[208:211], a[48:51], v[72:75], v[208:211]
    buffer_store_dwordx4 v[172:175], v14, s[32:35], s55 offen offset:3200 sc1
    v_mfma_f32_16x16x32_bf16 v[212:215], a[52:55], v[72:75], v[212:215]
    v_exp_f32 v35, v35
    v_cvt_pk_bf16_f32 v78, v32, v33
    v_mfma_f32_16x16x32_bf16 v[216:219], a[112:115], v[72:75], v[216:219]
    v_add_f32 v10, v10, v34
    v_add_f32 v10, v10, v35
    v_mfma_f32_16x16x32_bf16 v[220:223], a[116:119], v[72:75], v[220:223]
    ds_read_b128 v[184:187], v15 offset:4096
    ds_read_b64 v[188:189], v15 offset:5128
    v_mfma_f32_16x16x32_bf16 v[224:227], a[8:11], v[72:75], v[224:227]
    ds_read_b64 v[190:191], v15 offset:5120
    v_cvt_pk_bf16_f32 v79, v34, v35
    v_mov_b32 v32, v10
    v_mfma_f32_16x16x32_bf16 v[228:231], a[12:15], v[72:75], v[228:231]
    v_mfma_f32_16x16x32_bf16 v[232:235], a[32:35], v[72:75], v[232:235]
    v_permlane32_swap_b32 v10, v32
    v_add_f32 v10, v10, v32
    v_mov_b32 v32, v10
    v_mfma_f32_16x16x32_bf16 v[236:239], a[36:39], v[72:75], v[236:239]
    ds_read_b128 v[96:99], v0 offset:24576
    ds_read_b128 v[100:103], v1 offset:24576
    v_mfma_f32_16x16x32_bf16 v[192:195], a[56:59], v[76:79], v[192:195]
    v_permlane16_swap_b32 v10, v32
    v_add_f32 v10, v10, v32
    v_cmp_nle_f32 vcc, s76, v10
    v_mfma_f32_16x16x32_bf16 v[196:199], a[60:63], v[76:79], v[196:199]
    v_cmp_nge_f32 s[80:81], s77, v10
    v_mfma_f32_16x16x32_bf16 v[200:203], a[120:123], v[76:79], v[200:203]
    ds_read_b128 v[104:107], v0 offset:28672
    ds_read_b128 v[108:111], v1 offset:28672
    v_mfma_f32_16x16x32_bf16 v[204:207], a[124:127], v[76:79], v[204:207]
    v_rcp_f32 v10, v10
    v_mfma_f32_16x16x32_bf16 v[208:211], a[96:99], v[76:79], v[208:211]
    s_waitcnt lgkmcnt(4)
    v_mfma_f32_16x16x32_bf16 v[212:215], a[100:103], v[76:79], v[212:215]
    buffer_store_dwordx4 v[184:187], v14, s[32:35], s55 offen offset:256 sc1
    v_mfma_f32_16x16x32_bf16 v[216:219], a[16:19], v[76:79], v[216:219]
    ds_read_b128 v[128:131], v6 offset:0
    ds_read_b128 v[152:155], v6 offset:6528
    v_mfma_f32_16x16x32_bf16 v[220:223], a[20:23], v[76:79], v[220:223]
    ds_read_b128 v[132:135], v6 offset:1088
    ds_read_b128 v[156:159], v6 offset:7616
    v_mfma_f32_16x16x32_bf16 v[224:227], a[40:43], v[76:79], v[224:227]
    buffer_store_dwordx4 v[188:191], v14, s[32:35], s55 offen offset:3328 sc1
    v_mfma_f32_16x16x32_bf16 v[228:231], a[44:47], v[76:79], v[228:231]
    ds_read_b128 v[136:139], v6 offset:2176
    ds_read_b128 v[160:163], v6 offset:8704
    v_mfma_f32_16x16x32_bf16 v[232:235], a[64:67], v[76:79], v[232:235]
    ds_read_b128 v[140:143], v6 offset:3264
    ds_read_b128 v[164:167], v6 offset:9792
    v_mfma_f32_16x16x32_bf16 v[236:239], a[68:71], v[76:79], v[236:239]
    ds_read_b128 v[144:147], v6 offset:4352
    ds_read_b128 v[168:171], v6 offset:10880
    ds_read_b128 v[148:151], v6 offset:5440
    ds_read_b128 v[172:175], v6 offset:11968
    v_mov_b32 v48, v16
    v_mov_b32 v49, v17
    v_mov_b32 v50, v18
    v_mov_b32 v51, v19
    s_or_b64 s[78:79], s[78:79], vcc
    s_or_b64 s[78:79], s[78:79], s[80:81]
    v_pk_mul_f32 v[192:193], v[192:193], v[10:11] op_sel:[0,0] op_sel_hi:[1,0]
    v_pk_mul_f32 v[194:195], v[194:195], v[10:11] op_sel:[0,0] op_sel_hi:[1,0]
    v_pk_mul_f32 v[196:197], v[196:197], v[10:11] op_sel:[0,0] op_sel_hi:[1,0]
    v_pk_mul_f32 v[198:199], v[198:199], v[10:11] op_sel:[0,0] op_sel_hi:[1,0]
    v_pk_mul_f32 v[200:201], v[200:201], v[10:11] op_sel:[0,0] op_sel_hi:[1,0]
    v_pk_mul_f32 v[202:203], v[202:203], v[10:11] op_sel:[0,0] op_sel_hi:[1,0]
    v_pk_mul_f32 v[204:205], v[204:205], v[10:11] op_sel:[0,0] op_sel_hi:[1,0]
    v_pk_mul_f32 v[206:207], v[206:207], v[10:11] op_sel:[0,0] op_sel_hi:[1,0]
    v_cvt_pk_bf16_f32 v192, v192, v193
    v_cvt_pk_bf16_f32 v193, v194, v195
    v_cvt_pk_bf16_f32 v194, v196, v197
    v_cvt_pk_bf16_f32 v195, v198, v199
    v_cvt_pk_bf16_f32 v196, v200, v201
    v_cvt_pk_bf16_f32 v197, v202, v203
    v_cvt_pk_bf16_f32 v198, v204, v205
    v_cvt_pk_bf16_f32 v199, v206, v207
    ds_write_b64 v48, v[192:193] offset:0
    ds_write_b64 v49, v[194:195] offset:0
    ds_write_b64 v50, v[196:197] offset:0
    ds_write_b64 v51, v[198:199] offset:0
    v_pk_mul_f32 v[208:209], v[208:209], v[10:11] op_sel:[0,0] op_sel_hi:[1,0]
    v_pk_mul_f32 v[210:211], v[210:211], v[10:11] op_sel:[0,0] op_sel_hi:[1,0]
    v_pk_mul_f32 v[212:213], v[212:213], v[10:11] op_sel:[0,0] op_sel_hi:[1,0]
    v_pk_mul_f32 v[214:215], v[214:215], v[10:11] op_sel:[0,0] op_sel_hi:[1,0]
    v_pk_mul_f32 v[216:217], v[216:217], v[10:11] op_sel:[0,0] op_sel_hi:[1,0]
    v_pk_mul_f32 v[218:219], v[218:219], v[10:11] op_sel:[0,0] op_sel_hi:[1,0]
    v_pk_mul_f32 v[220:221], v[220:221], v[10:11] op_sel:[0,0] op_sel_hi:[1,0]
    v_pk_mul_f32 v[222:223], v[222:223], v[10:11] op_sel:[0,0] op_sel_hi:[1,0]
    v_cvt_pk_bf16_f32 v208, v208, v209
    v_cvt_pk_bf16_f32 v209, v210, v211
    v_cvt_pk_bf16_f32 v210, v212, v213
    v_cvt_pk_bf16_f32 v211, v214, v215
    v_cvt_pk_bf16_f32 v212, v216, v217
    v_cvt_pk_bf16_f32 v213, v218, v219
    v_cvt_pk_bf16_f32 v214, v220, v221
    v_cvt_pk_bf16_f32 v215, v222, v223
    ds_read_b128 v[200:203], v15 offset:0
    ds_read_b64 v[204:205], v15 offset:1032
    ds_read_b64 v[206:207], v15 offset:1024
    ds_write_b64 v48, v[208:209] offset:2048
    ds_write_b64 v49, v[210:211] offset:2048
    ds_write_b64 v50, v[212:213] offset:2048
    ds_write_b64 v51, v[214:215] offset:2048
    v_pk_mul_f32 v[224:225], v[224:225], v[10:11] op_sel:[0,0] op_sel_hi:[1,0]
    v_pk_mul_f32 v[226:227], v[226:227], v[10:11] op_sel:[0,0] op_sel_hi:[1,0]
    v_pk_mul_f32 v[228:229], v[228:229], v[10:11] op_sel:[0,0] op_sel_hi:[1,0]
    v_pk_mul_f32 v[230:231], v[230:231], v[10:11] op_sel:[0,0] op_sel_hi:[1,0]
    v_pk_mul_f32 v[232:233], v[232:233], v[10:11] op_sel:[0,0] op_sel_hi:[1,0]
    v_pk_mul_f32 v[234:235], v[234:235], v[10:11] op_sel:[0,0] op_sel_hi:[1,0]
    v_pk_mul_f32 v[236:237], v[236:237], v[10:11] op_sel:[0,0] op_sel_hi:[1,0]
    v_pk_mul_f32 v[238:239], v[238:239], v[10:11] op_sel:[0,0] op_sel_hi:[1,0]
    s_waitcnt lgkmcnt(4)
    buffer_store_dwordx4 v[200:203], v14, s[32:35], s56 offen offset:0 sc1
    v_cvt_pk_bf16_f32 v224, v224, v225
    v_cvt_pk_bf16_f32 v225, v226, v227
    v_cvt_pk_bf16_f32 v226, v228, v229
    v_cvt_pk_bf16_f32 v227, v230, v231
    v_cvt_pk_bf16_f32 v228, v232, v233
    v_cvt_pk_bf16_f32 v229, v234, v235
    v_cvt_pk_bf16_f32 v230, v236, v237
    v_cvt_pk_bf16_f32 v231, v238, v239
    buffer_store_dwordx4 v[204:207], v14, s[32:35], s56 offen offset:3072 sc1
    ds_read_b128 v[216:219], v15 offset:2048
    ds_read_b64 v[220:221], v15 offset:3080
    ds_read_b64 v[222:223], v15 offset:3072
    ds_write_b64 v48, v[224:225] offset:4096
    ds_write_b64 v49, v[226:227] offset:4096
    ds_write_b64 v50, v[228:229] offset:4096
    ds_write_b64 v51, v[230:231] offset:4096
    v_mfma_f32_16x16x32_bf16 v[84:87], v[96:99], a[72:75], 0
    s_waitcnt lgkmcnt(4)
    ds_read_b128 v[112:115], v0 offset:32768
    ds_read_b128 v[116:119], v1 offset:32768
    v_mfma_f32_16x16x32_bf16 v[84:87], v[100:103], a[76:79], v[84:87]
    buffer_store_dwordx4 v[216:219], v14, s[32:35], s56 offen offset:128 sc1
    v_mfma_f32_16x16x32_bf16 v[16:19], v[96:99], v[128:131], 0
    v_exp_f32 v36, v36
    v_mfma_f32_16x16x32_bf16 v[16:19], v[100:103], v[132:135], v[16:19]
    ds_read_b128 v[120:123], v0 offset:26624
    v_add_f32 v13, v13, v36
    v_mfma_f32_16x16x32_bf16 v[32:35], v[96:99], v[152:155], 0
    buffer_store_dwordx4 v[220:223], v14, s[32:35], s56 offen offset:3200 sc1
    v_mfma_f32_16x16x32_bf16 v[32:35], v[100:103], v[156:159], v[32:35]
    ds_read_b128 v[124:127], v1 offset:26624
    v_mfma_f32_16x16x32_bf16 v[84:87], v[104:107], a[80:83], v[84:87]
    v_exp_f32 v37, v37
    v_mfma_f32_16x16x32_bf16 v[84:87], v[108:111], a[84:87], v[84:87]
    ds_read_b128 v[232:235], v15 offset:4096
    ds_read_b64 v[236:237], v15 offset:5128
    v_mfma_f32_16x16x32_bf16 v[16:19], v[104:107], v[136:139], v[16:19]
    ds_read_b64 v[238:239], v15 offset:5120
    v_add_f32 v13, v13, v37
    v_mfma_f32_16x16x32_bf16 v[16:19], v[108:111], v[140:143], v[16:19]
    ds_read_b128 v[96:99], v0 offset:30720
    v_cvt_pk_bf16_f32 v36, v36, v37
    v_mfma_f32_16x16x32_bf16 v[32:35], v[104:107], v[160:163], v[32:35]
    ds_read_b128 v[100:103], v1 offset:30720
    v_mfma_f32_16x16x32_bf16 v[32:35], v[108:111], v[164:167], v[32:35]
    s_waitcnt lgkmcnt(8)
    v_exp_f32 v38, v38
    v_mfma_f32_16x16x32_bf16 v[84:87], v[112:115], a[88:91], v[84:87]
    s_waitcnt lgkmcnt(7)
    v_exp_f32 v39, v39
    v_mfma_f32_16x16x32_bf16 v[84:87], v[116:119], a[92:95], v[84:87]
    v_exp_f32 v44, v44
    v_mfma_f32_16x16x32_bf16 v[16:19], v[112:115], v[144:147], v[16:19]
    v_exp_f32 v45, v45
    v_mfma_f32_16x16x32_bf16 v[16:19], v[116:119], v[148:151], v[16:19]
    ds_read_b128 v[104:107], v0 offset:34816
    v_add_f32 v13, v13, v38
    v_mfma_f32_16x16x32_bf16 v[32:35], v[112:115], v[168:171], v[32:35]
    s_waitcnt lgkmcnt(3)
    ds_read_b128 v[108:111], v1 offset:34816
    v_add_f32 v13, v13, v39
    v_mfma_f32_16x16x32_bf16 v[32:35], v[116:119], v[172:175], v[32:35]
    s_waitcnt lgkmcnt(8)
    buffer_store_dwordx4 v[232:235], v14, s[32:35], s56 offen offset:256 sc1
    v_mfma_f32_16x16x32_bf16 v[92:95], v[120:123], a[72:75], 0
    s_waitcnt lgkmcnt(7)
    v_exp_f32 v46, v46
    v_mfma_f32_16x16x32_bf16 v[92:95], v[124:127], a[76:79], v[92:95]
    v_exp_f32 v47, v47
    v_mfma_f32_16x16x32_bf16 v[24:27], v[120:123], v[128:131], 0
    buffer_store_dwordx4 v[236:239], v14, s[32:35], s56 offen offset:3328 sc1
    v_mfma_f32_16x16x32_bf16 v[24:27], v[124:127], v[132:135], v[24:27]
    ds_read_b128 v[112:115], v0 offset:36864
    v_cvt_pk_bf16_f32 v37, v38, v39
    v_mfma_f32_16x16x32_bf16 v[40:43], v[120:123], v[152:155], 0
    ds_read_b128 v[116:119], v1 offset:36864
    v_add_f32 v13, v13, v44
    v_mfma_f32_16x16x32_bf16 v[40:43], v[124:127], v[156:159], v[40:43]
    s_waitcnt lgkmcnt(5)
    ds_read_b64_tr_b16 v[192:193], v2 offset:36864
    ds_read_b64_tr_b16 v[194:195], v2 offset:38912
    v_mfma_f32_16x16x32_bf16 v[92:95], v[96:99], a[80:83], v[92:95]
    s_waitcnt lgkmcnt(6)
    v_exp_f32 v84, v84
    v_mfma_f32_16x16x32_bf16 v[92:95], v[100:103], a[84:87], v[92:95]
    v_exp_f32 v85, v85
    v_mfma_f32_16x16x32_bf16 v[24:27], v[96:99], v[136:139], v[24:27]
    ds_read_b64_tr_b16 v[196:197], v3 offset:36864
    ds_read_b64_tr_b16 v[198:199], v3 offset:38912
    v_mfma_f32_16x16x32_bf16 v[24:27], v[100:103], v[140:143], v[24:27]
    ds_read_b128 v[120:123], v0 offset:40960
    v_add_f32 v13, v13, v45
    v_mfma_f32_16x16x32_bf16 v[40:43], v[96:99], v[160:163], v[40:43]
    ds_read_b128 v[124:127], v1 offset:40960
    v_cvt_pk_bf16_f32 v38, v44, v45
    v_mfma_f32_16x16x32_bf16 v[40:43], v[100:103], v[164:167], v[40:43]
    s_waitcnt lgkmcnt(9)
    ds_read_b64_tr_b16 v[200:201], v4 offset:36864
    ds_read_b64_tr_b16 v[202:203], v4 offset:38912
    v_mfma_f32_16x16x32_bf16 v[92:95], v[104:107], a[88:91], v[92:95]
    s_waitcnt lgkmcnt(10)
    v_exp_f32 v86, v86
    v_mfma_f32_16x16x32_bf16 v[92:95], v[108:111], a[92:95], v[92:95]
    v_exp_f32 v87, v87
    v_mfma_f32_16x16x32_bf16 v[24:27], v[104:107], v[144:147], v[24:27]
    ds_read_b64_tr_b16 v[204:205], v5 offset:36864
    ds_read_b64_tr_b16 v[206:207], v5 offset:38912
    v_mfma_f32_16x16x32_bf16 v[24:27], v[108:111], v[148:151], v[24:27]
    ds_read_b128 v[96:99], v0 offset:45056
    v_add_f32 v13, v13, v46
    v_mfma_f32_16x16x32_bf16 v[40:43], v[104:107], v[168:171], v[40:43]
    ds_read_b128 v[100:103], v1 offset:45056
    v_add_f32 v13, v13, v47
    v_mfma_f32_16x16x32_bf16 v[40:43], v[108:111], v[172:175], v[40:43]
    s_waitcnt lgkmcnt(12)
    ds_read_b64_tr_b16 v[208:209], v2 offset:40960
    ds_read_b64_tr_b16 v[210:211], v2 offset:43008
    v_mfma_f32_16x16x32_bf16 v[60:63], v[112:115], a[72:75], 0
    v_exp_f32 v16, v16
    v_mfma_f32_16x16x32_bf16 v[60:63], v[116:119], a[76:79], v[60:63]
    v_exp_f32 v17, v17
    v_mfma_f32_16x16x32_bf16 v[64:67], v[112:115], v[128:131], 0
    ds_read_b64_tr_b16 v[212:213], v3 offset:40960
    ds_read_b64_tr_b16 v[214:215], v3 offset:43008
    v_mfma_f32_16x16x32_bf16 v[64:67], v[116:119], v[132:135], v[64:67]
    ds_read_b128 v[104:107], v0 offset:38912
    v_cvt_pk_bf16_f32 v39, v46, v47
    v_mfma_f32_16x16x32_bf16 v[72:75], v[112:115], v[152:155], 0
    ds_read_b128 v[108:111], v1 offset:38912
    v_add_f32 v11, v11, v84
    v_mfma_f32_16x16x32_bf16 v[72:75], v[116:119], v[156:159], v[72:75]
    s_waitcnt lgkmcnt(12)
    ds_read_b64_tr_b16 v[216:217], v4 offset:40960
    ds_read_b64_tr_b16 v[218:219], v4 offset:43008
    v_mfma_f32_16x16x32_bf16 v[60:63], v[120:123], a[80:83], v[60:63]
    v_exp_f32 v18, v18
    v_mfma_f32_16x16x32_bf16 v[60:63], v[124:127], a[84:87], v[60:63]
    v_exp_f32 v19, v19
    v_mfma_f32_16x16x32_bf16 v[64:67], v[120:123], v[136:139], v[64:67]
    ds_read_b64_tr_b16 v[220:221], v5 offset:40960
    ds_read_b64_tr_b16 v[222:223], v5 offset:43008
    v_mfma_f32_16x16x32_bf16 v[64:67], v[124:127], v[140:143], v[64:67]
    ds_read_b128 v[112:115], v0 offset:43008
    v_add_f32 v11, v11, v85
    v_mfma_f32_16x16x32_bf16 v[72:75], v[120:123], v[160:163], v[72:75]
    ds_read_b128 v[116:119], v1 offset:43008
    v_cvt_pk_bf16_f32 v84, v84, v85
    v_mfma_f32_16x16x32_bf16 v[72:75], v[124:127], v[164:167], v[72:75]
    s_waitcnt lgkmcnt(12)
    ds_read_b64_tr_b16 v[224:225], v2 offset:45056
    ds_read_b64_tr_b16 v[226:227], v2 offset:47104
    v_mfma_f32_16x16x32_bf16 v[60:63], v[96:99], a[88:91], v[60:63]
    v_exp_f32 v32, v32
    v_mfma_f32_16x16x32_bf16 v[60:63], v[100:103], a[92:95], v[60:63]
    v_exp_f32 v33, v33
    v_mfma_f32_16x16x32_bf16 v[64:67], v[96:99], v[144:147], v[64:67]
    ds_read_b64_tr_b16 v[228:229], v3 offset:45056
    ds_read_b64_tr_b16 v[230:231], v3 offset:47104
    v_mfma_f32_16x16x32_bf16 v[64:67], v[100:103], v[148:151], v[64:67]
    ds_read_b128 v[120:123], v0 offset:47104
    v_add_f32 v11, v11, v86
    v_mfma_f32_16x16x32_bf16 v[72:75], v[96:99], v[168:171], v[72:75]
    ds_read_b128 v[124:127], v1 offset:47104
    v_add_f32 v11, v11, v87
    v_mfma_f32_16x16x32_bf16 v[72:75], v[100:103], v[172:175], v[72:75]
    s_waitcnt lgkmcnt(12)
    ds_read_b64_tr_b16 v[232:233], v4 offset:45056
    ds_read_b64_tr_b16 v[234:235], v4 offset:47104
    v_mfma_f32_16x16x32_bf16 v[56:59], v[104:107], a[72:75], 0
    v_exp_f32 v34, v34
    v_mfma_f32_16x16x32_bf16 v[56:59], v[108:111], a[76:79], v[56:59]
    v_exp_f32 v35, v35
    v_mfma_f32_16x16x32_bf16 v[28:31], v[104:107], v[128:131], 0
    ds_read_b64_tr_b16 v[236:237], v5 offset:45056
    ds_read_b64_tr_b16 v[238:239], v5 offset:47104
    v_mfma_f32_16x16x32_bf16 v[28:31], v[108:111], v[132:135], v[28:31]
    v_exp_f32 v92, v92
    v_mfma_f32_16x16x32_bf16 v[44:47], v[104:107], v[152:155], 0
    v_exp_f32 v93, v93
    v_mfma_f32_16x16x32_bf16 v[44:47], v[108:111], v[156:159], v[44:47]
    s_waitcnt lgkmcnt(11)
    v_cvt_pk_bf16_f32 v85, v86, v87
    v_add_f32 v12, v12, v16
    v_mfma_f32_16x16x32_bf16 v[56:59], v[112:115], a[80:83], v[56:59]
    s_waitcnt lgkmcnt(10)
    v_add_f32 v12, v12, v17
    v_cvt_pk_bf16_f32 v16, v16, v17
    v_mfma_f32_16x16x32_bf16 v[56:59], v[116:119], a[84:87], v[56:59]
    v_add_f32 v12, v12, v18
    v_add_f32 v12, v12, v19
    v_mfma_f32_16x16x32_bf16 v[28:31], v[112:115], v[136:139], v[28:31]
    v_cvt_pk_bf16_f32 v17, v18, v19
    v_add_f32 v13, v13, v32
    v_mfma_f32_16x16x32_bf16 v[28:31], v[116:119], v[140:143], v[28:31]
    v_add_f32 v13, v13, v33
    v_cvt_pk_bf16_f32 v32, v32, v33
    v_mfma_f32_16x16x32_bf16 v[44:47], v[112:115], v[160:163], v[44:47]
    v_add_f32 v13, v13, v34
    v_add_f32 v13, v13, v35
    v_mfma_f32_16x16x32_bf16 v[44:47], v[116:119], v[164:167], v[44:47]
    s_waitcnt lgkmcnt(5)
    v_exp_f32 v94, v94
    v_mfma_f32_16x16x32_bf16 v[56:59], v[120:123], a[88:91], v[56:59]
    s_waitcnt lgkmcnt(4)
    v_exp_f32 v95, v95
    v_mfma_f32_16x16x32_bf16 v[56:59], v[124:127], a[92:95], v[56:59]
    v_cvt_pk_bf16_f32 v33, v34, v35
    v_add_f32 v11, v11, v92
    v_mfma_f32_16x16x32_bf16 v[28:31], v[120:123], v[144:147], v[28:31]
    v_exp_f32 v24, v24
    v_mfma_f32_16x16x32_bf16 v[28:31], v[124:127], v[148:151], v[28:31]
    v_exp_f32 v25, v25
    v_mfma_f32_16x16x32_bf16 v[44:47], v[120:123], v[168:171], v[44:47]
    v_add_f32 v11, v11, v93
    v_cvt_pk_bf16_f32 v86, v92, v93
    v_mfma_f32_16x16x32_bf16 v[44:47], v[124:127], v[172:175], v[44:47]
    v_add_f32 v11, v11, v94
    v_add_f32 v11, v11, v95
    v_mfma_f32_16x16x32_bf16 v[240:243], v[192:195], v[88:91], v[240:243]
    v_exp_f32 v26, v26
    v_mfma_f32_16x16x32_bf16 v[244:247], v[196:199], v[88:91], v[244:247]
L_hop2:
    s_cbranch_execz L_hopback0
    v_exp_f32 v27, v27
    v_mfma_f32_16x16x32_bf16 v[248:251], v[200:203], v[88:91], v[248:251]
    v_cvt_pk_bf16_f32 v87, v94, v95
    v_add_f32 v12, v12, v24
    v_mfma_f32_16x16x32_bf16 v[252:255], v[204:207], v[88:91], v[252:255]
    v_exp_f32 v60, v60
    v_mfma_f32_16x16x32_bf16 a[128:131], v[208:211], v[88:91], a[128:131]
    v_exp_f32 v61, v61
    v_mfma_f32_16x16x32_bf16 a[132:135], v[212:215], v[88:91], a[132:135]
    v_add_f32 v12, v12, v25
    v_cvt_pk_bf16_f32 v18, v24, v25
    v_mfma_f32_16x16x32_bf16 a[136:139], v[216:219], v[88:91], a[136:139]
    v_exp_f32 v62, v62
    v_mfma_f32_16x16x32_bf16 a[140:143], v[220:223], v[88:91], a[140:143]
    v_exp_f32 v63, v63
    v_mfma_f32_16x16x32_bf16 a[144:147], v[224:227], v[88:91], a[144:147]
    v_exp_f32 v56, v56
    v_mfma_f32_16x16x32_bf16 a[148:151], v[228:231], v[88:91], a[148:151]
    s_waitcnt lgkmcnt(2)
    v_exp_f32 v57, v57
    v_mfma_f32_16x16x32_bf16 a[152:155], v[232:235], v[88:91], a[152:155]
    s_waitcnt lgkmcnt(0)
    v_exp_f32 v58, v58
    v_mfma_f32_16x16x32_bf16 a[156:159], v[236:239], v[88:91], a[156:159]
    v_exp_f32 v59, v59
    v_mfma_f32_16x16x32_bf16 v[240:243], a[0:3], v[84:87], v[240:243]
    v_exp_f32 v40, v40
    v_mfma_f32_16x16x32_bf16 v[244:247], a[4:7], v[84:87], v[244:247]
    v_exp_f32 v41, v41
    v_mfma_f32_16x16x32_bf16 v[248:251], a[24:27], v[84:87], v[248:251]
    v_add_f32 v12, v12, v26
    v_add_f32 v12, v12, v27
    v_mfma_f32_16x16x32_bf16 v[252:255], a[28:31], v[84:87], v[252:255]
    v_cvt_pk_bf16_f32 v19, v26, v27
    v_add_f32 v11, v11, v60
    v_mfma_f32_16x16x32_bf16 a[128:131], a[48:51], v[84:87], a[128:131]
    v_add_f32 v11, v11, v61
    v_cvt_pk_bf16_f32 v60, v60, v61
    v_mfma_f32_16x16x32_bf16 a[132:135], a[52:55], v[84:87], a[132:135]
    v_add_f32 v11, v11, v62
    v_add_f32 v11, v11, v63
    v_mfma_f32_16x16x32_bf16 a[136:139], a[112:115], v[84:87], a[136:139]
    v_cvt_pk_bf16_f32 v61, v62, v63
    v_add_f32 v11, v11, v56
    v_mfma_f32_16x16x32_bf16 a[140:143], a[116:119], v[84:87], a[140:143]
    v_add_f32 v11, v11, v57
    v_cvt_pk_bf16_f32 v62, v56, v57
    v_mfma_f32_16x16x32_bf16 a[144:147], a[8:11], v[84:87], a[144:147]
    v_add_f32 v11, v11, v58
    v_add_f32 v11, v11, v59
    v_mfma_f32_16x16x32_bf16 a[148:151], a[12:15], v[84:87], a[148:151]
    v_cvt_pk_bf16_f32 v63, v58, v59
    v_mov_b32 v56, v11
    v_mfma_f32_16x16x32_bf16 a[152:155], a[32:35], v[84:87], a[152:155]
    v_exp_f32 v42, v42
    v_mfma_f32_16x16x32_bf16 a[156:159], a[36:39], v[84:87], a[156:159]
    v_exp_f32 v43, v43
    v_mfma_f32_16x16x32_bf16 v[240:243], a[56:59], v[60:63], v[240:243]
    v_permlane32_swap_b32 v11, v56
    v_add_f32 v11, v11, v56
    v_mfma_f32_16x16x32_bf16 v[244:247], a[60:63], v[60:63], v[244:247]
    v_mov_b32 v56, v11
    v_add_f32 v13, v13, v40
    v_mfma_f32_16x16x32_bf16 v[248:251], a[120:123], v[60:63], v[248:251]
    v_add_f32 v13, v13, v41
    v_cvt_pk_bf16_f32 v34, v40, v41
    v_mfma_f32_16x16x32_bf16 v[252:255], a[124:127], v[60:63], v[252:255]
    v_permlane16_swap_b32 v11, v56
    v_add_f32 v11, v11, v56
    v_mfma_f32_16x16x32_bf16 a[128:131], a[96:99], v[60:63], a[128:131]
    v_cmp_nle_f32 vcc, s76, v11
    v_cmp_nge_f32 s[80:81], s77, v11
    v_mfma_f32_16x16x32_bf16 a[132:135], a[100:103], v[60:63], a[132:135]
    v_rcp_f32 v11, v11
    v_mfma_f32_16x16x32_bf16 a[136:139], a[16:19], v[60:63], a[136:139]
    v_add_f32 v13, v13, v42
    v_add_f32 v13, v13, v43
    v_mfma_f32_16x16x32_bf16 a[140:143], a[20:23], v[60:63], a[140:143]
    v_cvt_pk_bf16_f32 v35, v42, v43
    v_mfma_f32_16x16x32_bf16 a[144:147], a[40:43], v[60:63], a[144:147]
    v_mfma_f32_16x16x32_bf16 a[148:151], a[44:47], v[60:63], a[148:151]
    v_mfma_f32_16x16x32_bf16 a[152:155], a[64:67], v[60:63], a[152:155]
    v_mfma_f32_16x16x32_bf16 a[156:159], a[68:71], v[60:63], a[156:159]
    s_or_b64 s[78:79], s[78:79], vcc
    s_or_b64 s[78:79], s[78:79], s[80:81]
    v_pk_mul_f32 v[240:241], v[240:241], v[10:11] op_sel:[0,1] op_sel_hi:[1,1]
    v_pk_mul_f32 v[242:243], v[242:243], v[10:11] op_sel:[0,1] op_sel_hi:[1,1]
    v_pk_mul_f32 v[244:245], v[244:245], v[10:11] op_sel:[0,1] op_sel_hi:[1,1]
    v_pk_mul_f32 v[246:247], v[246:247], v[10:11] op_sel:[0,1] op_sel_hi:[1,1]
    v_pk_mul_f32 v[248:249], v[248:249], v[10:11] op_sel:[0,1] op_sel_hi:[1,1]
    v_pk_mul_f32 v[250:251], v[250:251], v[10:11] op_sel:[0,1] op_sel_hi:[1,1]
    v_pk_mul_f32 v[252:253], v[252:253], v[10:11] op_sel:[0,1] op_sel_hi:[1,1]
    v_pk_mul_f32 v[254:255], v[254:255], v[10:11] op_sel:[0,1] op_sel_hi:[1,1]
    v_cvt_pk_bf16_f32 v240, v240, v241
    v_cvt_pk_bf16_f32 v241, v242, v243
    v_cvt_pk_bf16_f32 v242, v244, v245
    v_cvt_pk_bf16_f32 v243, v246, v247
    v_cvt_pk_bf16_f32 v244, v248, v249
    v_cvt_pk_bf16_f32 v245, v250, v251
    v_cvt_pk_bf16_f32 v246, v252, v253
    v_cvt_pk_bf16_f32 v247, v254, v255
    ds_write_b64 v48, v[240:241] offset:0
    ds_write_b64 v49, v[242:243] offset:0
    ds_write_b64 v50, v[244:245] offset:0
    ds_write_b64 v51, v[246:247] offset:0
    v_accvgpr_read_b32 v160, a128
    v_accvgpr_read_b32 v161, a129
    v_accvgpr_read_b32 v162, a130
    v_accvgpr_read_b32 v163, a131
    v_accvgpr_read_b32 v164, a132
    v_accvgpr_read_b32 v165, a133
    v_accvgpr_read_b32 v166, a134
    v_accvgpr_read_b32 v167, a135
    v_accvgpr_read_b32 v168, a136
    v_accvgpr_read_b32 v169, a137
    v_accvgpr_read_b32 v170, a138
    v_accvgpr_read_b32 v171, a139
    v_accvgpr_read_b32 v172, a140
    v_accvgpr_read_b32 v173, a141
    v_accvgpr_read_b32 v174, a142
    v_accvgpr_read_b32 v175, a143
    v_pk_mul_f32 v[160:161], v[160:161], v[10:11] op_sel:[0,1] op_sel_hi:[1,1]
    v_pk_mul_f32 v[162:163], v[162:163], v[10:11] op_sel:[0,1] op_sel_hi:[1,1]
    v_pk_mul_f32 v[164:165], v[164:165], v[10:11] op_sel:[0,1] op_sel_hi:[1,1]
    v_pk_mul_f32 v[166:167], v[166:167], v[10:11] op_sel:[0,1] op_sel_hi:[1,1]
    v_pk_mul_f32 v[168:169], v[168:169], v[10:11] op_sel:[0,1] op_sel_hi:[1,1]
    v_pk_mul_f32 v[170:171], v[170:171], v[10:11] op_sel:[0,1] op_sel_hi:[1,1]
    v_pk_mul_f32 v[172:173], v[172:173], v[10:11] op_sel:[0,1] op_sel_hi:[1,1]
    v_pk_mul_f32 v[174:175], v[174:175], v[10:11] op_sel:[0,1] op_sel_hi:[1,1]
    v_cvt_pk_bf16_f32 v160, v160, v161
    v_cvt_pk_bf16_f32 v161, v162, v163
    v_cvt_pk_bf16_f32 v162, v164, v165
    v_cvt_pk_bf16_f32 v163, v166, v167
    v_cvt_pk_bf16_f32 v164, v168, v169
    v_cvt_pk_bf16_f32 v165, v170, v171
    v_cvt_pk_bf16_f32 v166, v172, v173
    v_cvt_pk_bf16_f32 v167, v174, v175
    ds_read_b128 v[248:251], v15 offset:0
    ds_read_b64 v[252:253], v15 offset:1032
    ds_read_b64 v[254:255], v15 offset:1024
    ds_write_b64 v48, v[160:161] offset:2048
    ds_write_b64 v49, v[162:163] offset:2048
    ds_write_b64 v50, v[164:165] offset:2048
    ds_write_b64 v51, v[166:167] offset:2048
    v_accvgpr_read_b32 v176, a144
    v_accvgpr_read_b32 v177, a145
    v_accvgpr_read_b32 v178, a146
    v_accvgpr_read_b32 v179, a147
    v_accvgpr_read_b32 v180, a148
    v_accvgpr_read_b32 v181, a149
    v_accvgpr_read_b32 v182, a150
    v_accvgpr_read_b32 v183, a151
    v_accvgpr_read_b32 v184, a152
    v_accvgpr_read_b32 v185, a153
    v_accvgpr_read_b32 v186, a154
    v_accvgpr_read_b32 v187, a155
    v_accvgpr_read_b32 v188, a156
    v_accvgpr_read_b32 v189, a157
    v_accvgpr_read_b32 v190, a158
    v_accvgpr_read_b32 v191, a159
    v_pk_mul_f32 v[176:177], v[176:177], v[10:11] op_sel:[0,1] op_sel_hi:[1,1]
    v_pk_mul_f32 v[178:179], v[178:179], v[10:11] op_sel:[0,1] op_sel_hi:[1,1]
    v_pk_mul_f32 v[180:181], v[180:181], v[10:11] op_sel:[0,1] op_sel_hi:[1,1]
    v_pk_mul_f32 v[182:183], v[182:183], v[10:11] op_sel:[0,1] op_sel_hi:[1,1]
    v_pk_mul_f32 v[184:185], v[184:185], v[10:11] op_sel:[0,1] op_sel_hi:[1,1]
    v_pk_mul_f32 v[186:187], v[186:187], v[10:11] op_sel:[0,1] op_sel_hi:[1,1]
    v_pk_mul_f32 v[188:189], v[188:189], v[10:11] op_sel:[0,1] op_sel_hi:[1,1]
    v_pk_mul_f32 v[190:191], v[190:191], v[10:11] op_sel:[0,1] op_sel_hi:[1,1]
    s_waitcnt lgkmcnt(4)
    buffer_store_dwordx4 v[248:251], v14, s[32:35], s57 offen offset:0 sc1
    v_cvt_pk_bf16_f32 v176, v176, v177
    v_cvt_pk_bf16_f32 v177, v178, v179
    v_cvt_pk_bf16_f32 v178, v180, v181
    v_cvt_pk_bf16_f32 v179, v182, v183
    v_cvt_pk_bf16_f32 v180, v184, v185
    v_cvt_pk_bf16_f32 v181, v186, v187
    v_cvt_pk_bf16_f32 v182, v188, v189
    v_cvt_pk_bf16_f32 v183, v190, v191
    buffer_store_dwordx4 v[252:255], v14, s[32:35], s57 offen offset:3072 sc1
    ds_read_b128 v[168:171], v15 offset:2048
    ds_read_b64 v[172:173], v15 offset:3080
    ds_read_b64 v[174:175], v15 offset:3072
    ds_write_b64 v48, v[176:177] offset:4096
    ds_write_b64 v49, v[178:179] offset:4096
    ds_write_b64 v50, v[180:181] offset:4096
    ds_write_b64 v51, v[182:183] offset:4096
    v_mfma_f32_16x16x32_bf16 a[160:163], v[192:195], v[20:23], a[160:163]
    s_waitcnt lgkmcnt(4)
    v_exp_f32 v64, v64
    v_mfma_f32_16x16x32_bf16 a[164:167], v[196:199], v[20:23], a[164:167]
    buffer_store_dwordx4 v[168:171], v14, s[32:35], s57 offen offset:128 sc1
    v_mfma_f32_16x16x32_bf16 a[168:171], v[200:203], v[20:23], a[168:171]
    v_exp_f32 v65, v65
    v_add_f32 v12, v12, v64
    v_mfma_f32_16x16x32_bf16 a[172:175], v[204:207], v[20:23], a[172:175]
    v_exp_f32 v66, v66
    v_add_f32 v12, v12, v65
    v_mfma_f32_16x16x32_bf16 a[176:179], v[208:211], v[20:23], a[176:179]
    buffer_store_dwordx4 v[172:175], v14, s[32:35], s57 offen offset:3200 sc1
    v_mfma_f32_16x16x32_bf16 a[180:183], v[212:215], v[20:23], a[180:183]
    v_exp_f32 v67, v67
    v_cvt_pk_bf16_f32 v64, v64, v65
    v_mfma_f32_16x16x32_bf16 a[184:187], v[216:219], v[20:23], a[184:187]
    v_exp_f32 v28, v28
    v_mfma_f32_16x16x32_bf16 a[188:191], v[220:223], v[20:23], a[188:191]
    ds_read_b128 v[184:187], v15 offset:4096
    ds_read_b64 v[188:189], v15 offset:5128
    v_mfma_f32_16x16x32_bf16 a[192:195], v[224:227], v[20:23], a[192:195]
    ds_read_b64 v[190:191], v15 offset:5120
    v_exp_f32 v29, v29
    v_mfma_f32_16x16x32_bf16 a[196:199], v[228:231], v[20:23], a[196:199]
    v_exp_f32 v30, v30
    v_mfma_f32_16x16x32_bf16 a[200:203], v[232:235], v[20:23], a[200:203]
    v_exp_f32 v31, v31
    v_mfma_f32_16x16x32_bf16 a[204:207], v[236:239], v[20:23], a[204:207]
    v_exp_f32 v72, v72
    v_add_f32 v12, v12, v66
    v_mfma_f32_16x16x32_bf16 a[160:163], a[0:3], v[16:19], a[160:163]
    v_exp_f32 v73, v73
    v_mfma_f32_16x16x32_bf16 a[164:167], a[4:7], v[16:19], a[164:167]
    v_exp_f32 v74, v74
    v_add_f32 v12, v12, v67
    v_mfma_f32_16x16x32_bf16 a[168:171], a[24:27], v[16:19], a[168:171]
    v_exp_f32 v75, v75
    v_mfma_f32_16x16x32_bf16 a[172:175], a[28:31], v[16:19], a[172:175]
    v_exp_f32 v44, v44
    v_mfma_f32_16x16x32_bf16 a[176:179], a[48:51], v[16:19], a[176:179]
    s_waitcnt lgkmcnt(0)
    v_exp_f32 v45, v45
    v_cvt_pk_bf16_f32 v65, v66, v67
    v_mfma_f32_16x16x32_bf16 a[180:183], a[52:55], v[16:19], a[180:183]
    buffer_store_dwordx4 v[184:187], v14, s[32:35], s57 offen offset:256 sc1
    v_mfma_f32_16x16x32_bf16 a[184:187], a[112:115], v[16:19], a[184:187]
    v_add_f32 v12, v12, v28
    v_add_f32 v12, v12, v29
    v_mfma_f32_16x16x32_bf16 a[188:191], a[116:119], v[16:19], a[188:191]
    v_exp_f32 v46, v46
    v_cvt_pk_bf16_f32 v66, v28, v29
    v_mfma_f32_16x16x32_bf16 a[192:195], a[8:11], v[16:19], a[192:195]
    buffer_store_dwordx4 v[188:191], v14, s[32:35], s57 offen offset:3328 sc1
    v_mfma_f32_16x16x32_bf16 a[196:199], a[12:15], v[16:19], a[196:199]
    v_add_f32 v12, v12, v30
    v_add_f32 v12, v12, v31
    v_mfma_f32_16x16x32_bf16 a[200:203], a[32:35], v[16:19], a[200:203]
    v_cvt_pk_bf16_f32 v67, v30, v31
    v_exp_f32 v47, v47
    v_mfma_f32_16x16x32_bf16 a[204:207], a[36:39], v[16:19], a[204:207]
    v_mov_b32 v28, v12
    v_add_f32 v13, v13, v72
    v_mfma_f32_16x16x32_bf16 a[160:163], a[56:59], v[64:67], a[160:163]
    v_add_f32 v13, v13, v73
    v_cvt_pk_bf16_f32 v72, v72, v73
    v_mfma_f32_16x16x32_bf16 a[164:167], a[60:63], v[64:67], a[164:167]
    v_permlane32_swap_b32 v12, v28
    v_add_f32 v12, v12, v28
    v_mfma_f32_16x16x32_bf16 a[168:171], a[120:123], v[64:67], a[168:171]
    v_mov_b32 v28, v12
    v_add_f32 v13, v13, v74
    v_mfma_f32_16x16x32_bf16 a[172:175], a[124:127], v[64:67], a[172:175]
    v_add_f32 v13, v13, v75
    v_cvt_pk_bf16_f32 v73, v74, v75
    v_mfma_f32_16x16x32_bf16 a[176:179], a[96:99], v[64:67], a[176:179]
    v_permlane16_swap_b32 v12, v28
    v_add_f32 v12, v12, v28
    v_mfma_f32_16x16x32_bf16 a[180:183], a[100:103], v[64:67], a[180:183]
    v_cmp_nle_f32 vcc, s76, v12
    v_cmp_nge_f32 s[80:81], s77, v12
    v_mfma_f32_16x16x32_bf16 a[184:187], a[16:19], v[64:67], a[184:187]
    v_rcp_f32 v12, v12
    v_mfma_f32_16x16x32_bf16 a[188:191], a[20:23], v[64:67], a[188:191]
    v_add_f32 v13, v13, v44
    v_add_f32 v13, v13, v45
    v_mfma_f32_16x16x32_bf16 a[192:195], a[40:43], v[64:67], a[192:195]
    v_cvt_pk_bf16_f32 v74, v44, v45
    v_add_f32 v13, v13, v46
    v_mfma_f32_16x16x32_bf16 a[196:199], a[44:47], v[64:67], a[196:199]
    v_add_f32 v13, v13, v47
    v_cvt_pk_bf16_f32 v75, v46, v47
    v_mfma_f32_16x16x32_bf16 a[200:203], a[64:67], v[64:67], a[200:203]
    v_mfma_f32_16x16x32_bf16 a[204:207], a[68:71], v[64:67], a[204:207]
    s_or_b64 s[78:79], s[78:79], vcc
    s_or_b64 s[78:79], s[78:79], s[80:81]
    v_accvgpr_read_b32 v96, a160
    v_accvgpr_read_b32 v97, a161
    v_accvgpr_read_b32 v98, a162
    v_accvgpr_read_b32 v99, a163
    v_accvgpr_read_b32 v100, a164
    v_accvgpr_read_b32 v101, a165
    v_accvgpr_read_b32 v102, a166
    v_accvgpr_read_b32 v103, a167
    v_accvgpr_read_b32 v104, a168
    v_accvgpr_read_b32 v105, a169
    v_accvgpr_read_b32 v106, a170
    v_accvgpr_read_b32 v107, a171
    v_accvgpr_read_b32 v108, a172
    v_accvgpr_read_b32 v109, a173
    v_accvgpr_read_b32 v110, a174
    v_accvgpr_read_b32 v111, a175
    v_pk_mul_f32 v[96:97], v[96:97], v[12:13] op_sel:[0,0] op_sel_hi:[1,0]
    v_pk_mul_f32 v[98:99], v[98:99], v[12:13] op_sel:[0,0] op_sel_hi:[1,0]
    v_pk_mul_f32 v[100:101], v[100:101], v[12:13] op_sel:[0,0] op_sel_hi:[1,0]
    v_pk_mul_f32 v[102:103], v[102:103], v[12:13] op_sel:[0,0] op_sel_hi:[1,0]
    v_pk_mul_f32 v[104:105], v[104:105], v[12:13] op_sel:[0,0] op_sel_hi:[1,0]
    v_pk_mul_f32 v[106:107], v[106:107], v[12:13] op_sel:[0,0] op_sel_hi:[1,0]
    v_pk_mul_f32 v[108:109], v[108:109], v[12:13] op_sel:[0,0] op_sel_hi:[1,0]
    v_pk_mul_f32 v[110:111], v[110:111], v[12:13] op_sel:[0,0] op_sel_hi:[1,0]
    v_cvt_pk_bf16_f32 v96, v96, v97
    v_cvt_pk_bf16_f32 v97, v98, v99
    v_cvt_pk_bf16_f32 v98, v100, v101
    v_cvt_pk_bf16_f32 v99, v102, v103
    v_cvt_pk_bf16_f32 v100, v104, v105
    v_cvt_pk_bf16_f32 v101, v106, v107
    v_cvt_pk_bf16_f32 v102, v108, v109
    v_cvt_pk_bf16_f32 v103, v110, v111
    ds_write_b64 v48, v[96:97] offset:0
    ds_write_b64 v49, v[98:99] offset:0
    ds_write_b64 v50, v[100:101] offset:0
    ds_write_b64 v51, v[102:103] offset:0
    v_accvgpr_read_b32 v112, a176
    v_accvgpr_read_b32 v113, a177
    v_accvgpr_read_b32 v114, a178
    v_accvgpr_read_b32 v115, a179
    v_accvgpr_read_b32 v116, a180
    v_accvgpr_read_b32 v117, a181
    v_accvgpr_read_b32 v118, a182
    v_accvgpr_read_b32 v119, a183
    v_accvgpr_read_b32 v120, a184
    v_accvgpr_read_b32 v121, a185
    v_accvgpr_read_b32 v122, a186
    v_accvgpr_read_b32 v123, a187
    v_accvgpr_read_b32 v124, a188
    v_accvgpr_read_b32 v125, a189
    v_accvgpr_read_b32 v126, a190
    v_accvgpr_read_b32 v127, a191
    v_pk_mul_f32 v[112:113], v[112:113], v[12:13] op_sel:[0,0] op_sel_hi:[1,0]
    v_pk_mul_f32 v[114:115], v[114:115], v[12:13] op_sel:[0,0] op_sel_hi:[1,0]
    v_pk_mul_f32 v[116:117], v[116:117], v[12:13] op_sel:[0,0] op_sel_hi:[1,0]
    v_pk_mul_f32 v[118:119], v[118:119], v[12:13] op_sel:[0,0] op_sel_hi:[1,0]
    v_pk_mul_f32 v[120:121], v[120:121], v[12:13] op_sel:[0,0] op_sel_hi:[1,0]
    v_pk_mul_f32 v[122:123], v[122:123], v[12:13] op_sel:[0,0] op_sel_hi:[1,0]
    v_pk_mul_f32 v[124:125], v[124:125], v[12:13] op_sel:[0,0] op_sel_hi:[1,0]
    v_pk_mul_f32 v[126:127], v[126:127], v[12:13] op_sel:[0,0] op_sel_hi:[1,0]
    v_cvt_pk_bf16_f32 v112, v112, v113
    v_cvt_pk_bf16_f32 v113, v114, v115
    v_cvt_pk_bf16_f32 v114, v116, v117
    v_cvt_pk_bf16_f32 v115, v118, v119
    v_cvt_pk_bf16_f32 v116, v120, v121
    v_cvt_pk_bf16_f32 v117, v122, v123
    v_cvt_pk_bf16_f32 v118, v124, v125
    v_cvt_pk_bf16_f32 v119, v126, v127
    ds_read_b128 v[104:107], v15 offset:0
    ds_read_b64 v[108:109], v15 offset:1032
    ds_read_b64 v[110:111], v15 offset:1024
    ds_write_b64 v48, v[112:113] offset:2048
    ds_write_b64 v49, v[114:115] offset:2048
    ds_write_b64 v50, v[116:117] offset:2048
    ds_write_b64 v51, v[118:119] offset:2048
    v_accvgpr_read_b32 v128, a192
    v_accvgpr_read_b32 v129, a193
    v_accvgpr_read_b32 v130, a194
    v_accvgpr_read_b32 v131, a195
    v_accvgpr_read_b32 v132, a196
    v_accvgpr_read_b32 v133, a197
    v_accvgpr_read_b32 v134, a198
    v_accvgpr_read_b32 v135, a199
    v_accvgpr_read_b32 v136, a200
    v_accvgpr_read_b32 v137, a201
    v_accvgpr_read_b32 v138, a202
    v_accvgpr_read_b32 v139, a203
    v_accvgpr_read_b32 v140, a204
    v_accvgpr_read_b32 v141, a205
    v_accvgpr_read_b32 v142, a206
    v_accvgpr_read_b32 v143, a207
    v_pk_mul_f32 v[128:129], v[128:129], v[12:13] op_sel:[0,0] op_sel_hi:[1,0]
    v_pk_mul_f32 v[130:131], v[130:131], v[12:13] op_sel:[0,0] op_sel_hi:[1,0]
    v_pk_mul_f32 v[132:133], v[132:133], v[12:13] op_sel:[0,0] op_sel_hi:[1,0]
    v_pk_mul_f32 v[134:135], v[134:135], v[12:13] op_sel:[0,0] op_sel_hi:[1,0]
    v_pk_mul_f32 v[136:137], v[136:137], v[12:13] op_sel:[0,0] op_sel_hi:[1,0]
    v_pk_mul_f32 v[138:139], v[138:139], v[12:13] op_sel:[0,0] op_sel_hi:[1,0]
    v_pk_mul_f32 v[140:141], v[140:141], v[12:13] op_sel:[0,0] op_sel_hi:[1,0]
    v_pk_mul_f32 v[142:143], v[142:143], v[12:13] op_sel:[0,0] op_sel_hi:[1,0]
    s_waitcnt lgkmcnt(4)
    buffer_store_dwordx4 v[104:107], v14, s[32:35], s58 offen offset:0 sc1
    v_cvt_pk_bf16_f32 v128, v128, v129
    v_cvt_pk_bf16_f32 v129, v130, v131
    v_cvt_pk_bf16_f32 v130, v132, v133
    v_cvt_pk_bf16_f32 v131, v134, v135
    v_cvt_pk_bf16_f32 v132, v136, v137
    v_cvt_pk_bf16_f32 v133, v138, v139
    v_cvt_pk_bf16_f32 v134, v140, v141
    v_cvt_pk_bf16_f32 v135, v142, v143
    buffer_store_dwordx4 v[108:111], v14, s[32:35], s58 offen offset:3072 sc1
    ds_read_b128 v[120:123], v15 offset:2048
    ds_read_b64 v[124:125], v15 offset:3080
    ds_read_b64 v[126:127], v15 offset:3072
    ds_write_b64 v48, v[128:129] offset:4096
    ds_write_b64 v49, v[130:131] offset:4096
    ds_write_b64 v50, v[132:133] offset:4096
    ds_write_b64 v51, v[134:135] offset:4096
    v_mfma_f32_16x16x32_bf16 a[208:211], v[192:195], v[36:39], a[208:211]
    s_waitcnt lgkmcnt(4)
    v_mov_b32 v44, v13
    v_mfma_f32_16x16x32_bf16 a[208:211], a[0:3], v[32:35], a[208:211]
    buffer_store_dwordx4 v[120:123], v14, s[32:35], s58 offen offset:128 sc1
    v_mfma_f32_16x16x32_bf16 a[208:211], a[56:59], v[72:75], a[208:211]
    v_permlane32_swap_b32 v13, v44
    v_add_f32 v13, v13, v44
    v_mfma_f32_16x16x32_bf16 a[212:215], v[196:199], v[36:39], a[212:215]
    v_mov_b32 v44, v13
    v_mfma_f32_16x16x32_bf16 a[212:215], a[4:7], v[32:35], a[212:215]
    buffer_store_dwordx4 v[124:127], v14, s[32:35], s58 offen offset:3200 sc1
    v_mfma_f32_16x16x32_bf16 a[212:215], a[60:63], v[72:75], a[212:215]
    v_permlane16_swap_b32 v13, v44
    v_add_f32 v13, v13, v44
    v_mfma_f32_16x16x32_bf16 a[216:219], v[200:203], v[36:39], a[216:219]
    v_cmp_nle_f32 vcc, s76, v13
    v_cmp_nge_f32 s[80:81], s77, v13
    v_mfma_f32_16x16x32_bf16 a[216:219], a[24:27], v[32:35], a[216:219]
    ds_read_b128 v[136:139], v15 offset:4096
    ds_read_b64 v[140:141], v15 offset:5128
    v_mfma_f32_16x16x32_bf16 a[216:219], a[120:123], v[72:75], a[216:219]
    ds_read_b64 v[142:143], v15 offset:5120
    v_accvgpr_read_b32 v144, a208
    v_mfma_f32_16x16x32_bf16 a[220:223], v[204:207], v[36:39], a[220:223]
    v_rcp_f32 v13, v13
    v_mfma_f32_16x16x32_bf16 a[220:223], a[28:31], v[32:35], a[220:223]
    v_accvgpr_read_b32 v145, a209
    v_accvgpr_read_b32 v146, a210
    v_mfma_f32_16x16x32_bf16 a[220:223], a[124:127], v[72:75], a[220:223]
    v_accvgpr_read_b32 v147, a211
    v_accvgpr_read_b32 v148, a212
    v_mfma_f32_16x16x32_bf16 a[224:227], v[208:211], v[36:39], a[224:227]
    v_accvgpr_read_b32 v149, a213
    v_accvgpr_read_b32 v150, a214
    v_mfma_f32_16x16x32_bf16 a[224:227], a[48:51], v[32:35], a[224:227]
    v_accvgpr_read_b32 v151, a215
    v_accvgpr_read_b32 v152, a216
    v_mfma_f32_16x16x32_bf16 a[224:227], a[96:99], v[72:75], a[224:227]
    v_accvgpr_read_b32 v153, a217
    v_accvgpr_read_b32 v154, a218
    v_mfma_f32_16x16x32_bf16 a[228:231], v[212:215], v[36:39], a[228:231]
    v_accvgpr_read_b32 v155, a219
    v_mfma_f32_16x16x32_bf16 a[228:231], a[52:55], v[32:35], a[228:231]
    s_waitcnt lgkmcnt(0)
    v_accvgpr_read_b32 v156, a220
    v_accvgpr_read_b32 v157, a221
    v_mfma_f32_16x16x32_bf16 a[228:231], a[100:103], v[72:75], a[228:231]
    buffer_store_dwordx4 v[136:139], v14, s[32:35], s58 offen offset:256 sc1
    v_mfma_f32_16x16x32_bf16 a[232:235], v[216:219], v[36:39], a[232:235]
    v_accvgpr_read_b32 v158, a222
    v_accvgpr_read_b32 v159, a223
    v_mfma_f32_16x16x32_bf16 a[232:235], a[112:115], v[32:35], a[232:235]
    v_accvgpr_read_b32 v160, a224
    v_accvgpr_read_b32 v161, a225
    v_mfma_f32_16x16x32_bf16 a[232:235], a[16:19], v[72:75], a[232:235]
    buffer_store_dwordx4 v[140:143], v14, s[32:35], s58 offen offset:3328 sc1
    v_mfma_f32_16x16x32_bf16 a[236:239], v[220:223], v[36:39], a[236:239]
    v_accvgpr_read_b32 v162, a226
    v_accvgpr_read_b32 v163, a227
    v_mfma_f32_16x16x32_bf16 a[236:239], a[116:119], v[32:35], a[236:239]
    v_accvgpr_read_b32 v164, a228
    v_accvgpr_read_b32 v165, a229
    v_mfma_f32_16x16x32_bf16 a[236:239], a[20:23], v[72:75], a[236:239]
    v_accvgpr_read_b32 v166, a230
    v_accvgpr_read_b32 v167, a231
    v_mfma_f32_16x16x32_bf16 a[240:243], v[224:227], v[36:39], a[240:243]
    v_mfma_f32_16x16x32_bf16 a[240:243], a[8:11], v[32:35], a[240:243]
    v_accvgpr_read_b32 v168, a232
    v_accvgpr_read_b32 v169, a233
    v_mfma_f32_16x16x32_bf16 a[240:243], a[40:43], v[72:75], a[240:243]
    v_accvgpr_read_b32 v170, a234
    v_accvgpr_read_b32 v171, a235
    v_mfma_f32_16x16x32_bf16 a[244:247], v[228:231], v[36:39], a[244:247]
    v_mfma_f32_16x16x32_bf16 a[244:247], a[12:15], v[32:35], a[244:247]
    v_accvgpr_read_b32 v172, a236
    v_accvgpr_read_b32 v173, a237
    v_mfma_f32_16x16x32_bf16 a[244:247], a[44:47], v[72:75], a[244:247]
    v_accvgpr_read_b32 v174, a238
    v_accvgpr_read_b32 v175, a239
    v_mfma_f32_16x16x32_bf16 a[248:251], v[232:235], v[36:39], a[248:251]
    v_mfma_f32_16x16x32_bf16 a[248:251], a[32:35], v[32:35], a[248:251]
    v_accvgpr_read_b32 v176, a240
    v_accvgpr_read_b32 v177, a241
    v_mfma_f32_16x16x32_bf16 a[248:251], a[64:67], v[72:75], a[248:251]
    v_accvgpr_read_b32 v178, a242
    v_accvgpr_read_b32 v179, a243
    v_mfma_f32_16x16x32_bf16 a[252:255], v[236:239], v[36:39], a[252:255]
    v_mfma_f32_16x16x32_bf16 a[252:255], a[36:39], v[32:35], a[252:255]
    v_mfma_f32_16x16x32_bf16 a[252:255], a[68:71], v[72:75], a[252:255]
    s_or_b64 s[78:79], s[78:79], vcc
    s_or_b64 s[78:79], s[78:79], s[80:81]
    v_pk_mul_f32 v[144:145], v[144:145], v[12:13] op_sel:[0,1] op_sel_hi:[1,1]
    v_pk_mul_f32 v[146:147], v[146:147], v[12:13] op_sel:[0,1] op_sel_hi:[1,1]
    v_pk_mul_f32 v[148:149], v[148:149], v[12:13] op_sel:[0,1] op_sel_hi:[1,1]
    v_pk_mul_f32 v[150:151], v[150:151], v[12:13] op_sel:[0,1] op_sel_hi:[1,1]
    v_pk_mul_f32 v[152:153], v[152:153], v[12:13] op_sel:[0,1] op_sel_hi:[1,1]
    v_pk_mul_f32 v[154:155], v[154:155], v[12:13] op_sel:[0,1] op_sel_hi:[1,1]
    v_pk_mul_f32 v[156:157], v[156:157], v[12:13] op_sel:[0,1] op_sel_hi:[1,1]
    v_pk_mul_f32 v[158:159], v[158:159], v[12:13] op_sel:[0,1] op_sel_hi:[1,1]
    v_cvt_pk_bf16_f32 v144, v144, v145
    v_cvt_pk_bf16_f32 v145, v146, v147
    v_cvt_pk_bf16_f32 v146, v148, v149
    v_cvt_pk_bf16_f32 v147, v150, v151
    v_cvt_pk_bf16_f32 v148, v152, v153
    v_cvt_pk_bf16_f32 v149, v154, v155
    v_cvt_pk_bf16_f32 v150, v156, v157
    v_cvt_pk_bf16_f32 v151, v158, v159
    ds_write_b64 v48, v[144:145] offset:0
    ds_write_b64 v49, v[146:147] offset:0
    ds_write_b64 v50, v[148:149] offset:0
    ds_write_b64 v51, v[150:151] offset:0
    v_pk_mul_f32 v[160:161], v[160:161], v[12:13] op_sel:[0,1] op_sel_hi:[1,1]
    v_pk_mul_f32 v[162:163], v[162:163], v[12:13] op_sel:[0,1] op_sel_hi:[1,1]
    v_pk_mul_f32 v[164:165], v[164:165], v[12:13] op_sel:[0,1] op_sel_hi:[1,1]
    v_pk_mul_f32 v[166:167], v[166:167], v[12:13] op_sel:[0,1] op_sel_hi:[1,1]
    v_pk_mul_f32 v[168:169], v[168:169], v[12:13] op_sel:[0,1] op_sel_hi:[1,1]
    v_pk_mul_f32 v[170:171], v[170:171], v[12:13] op_sel:[0,1] op_sel_hi:[1,1]
    v_pk_mul_f32 v[172:173], v[172:173], v[12:13] op_sel:[0,1] op_sel_hi:[1,1]
    v_pk_mul_f32 v[174:175], v[174:175], v[12:13] op_sel:[0,1] op_sel_hi:[1,1]
    v_cvt_pk_bf16_f32 v160, v160, v161
    v_cvt_pk_bf16_f32 v161, v162, v163
    v_cvt_pk_bf16_f32 v162, v164, v165
    v_cvt_pk_bf16_f32 v163, v166, v167
    v_cvt_pk_bf16_f32 v164, v168, v169
    v_cvt_pk_bf16_f32 v165, v170, v171
    v_cvt_pk_bf16_f32 v166, v172, v173
    v_cvt_pk_bf16_f32 v167, v174, v175
    ds_read_b128 v[152:155], v15 offset:0
    ds_read_b64 v[156:157], v15 offset:1032
    ds_read_b64 v[158:159], v15 offset:1024
    ds_write_b64 v48, v[160:161] offset:2048
    ds_write_b64 v49, v[162:163] offset:2048
    ds_write_b64 v50, v[164:165] offset:2048
    ds_write_b64 v51, v[166:167] offset:2048
    v_accvgpr_read_b32 v180, a244
    v_accvgpr_read_b32 v181, a245
    v_accvgpr_read_b32 v182, a246
    v_accvgpr_read_b32 v183, a247
    v_accvgpr_read_b32 v184, a248
    v_accvgpr_read_b32 v185, a249
    v_accvgpr_read_b32 v186, a250
    v_accvgpr_read_b32 v187, a251
    v_accvgpr_read_b32 v188, a252
    v_accvgpr_read_b32 v189, a253
    v_accvgpr_read_b32 v190, a254
    v_accvgpr_read_b32 v191, a255
    v_pk_mul_f32 v[176:177], v[176:177], v[12:13] op_sel:[0,1] op_sel_hi:[1,1]
    v_pk_mul_f32 v[178:179], v[178:179], v[12:13] op_sel:[0,1] op_sel_hi:[1,1]
    v_pk_mul_f32 v[180:181], v[180:181], v[12:13] op_sel:[0,1] op_sel_hi:[1,1]
    v_pk_mul_f32 v[182:183], v[182:183], v[12:13] op_sel:[0,1] op_sel_hi:[1,1]
    v_pk_mul_f32 v[184:185], v[184:185], v[12:13] op_sel:[0,1] op_sel_hi:[1,1]
    v_pk_mul_f32 v[186:187], v[186:187], v[12:13] op_sel:[0,1] op_sel_hi:[1,1]
    v_pk_mul_f32 v[188:189], v[188:189], v[12:13] op_sel:[0,1] op_sel_hi:[1,1]
    v_pk_mul_f32 v[190:191], v[190:191], v[12:13] op_sel:[0,1] op_sel_hi:[1,1]
    s_waitcnt lgkmcnt(4)
    buffer_store_dwordx4 v[152:155], v14, s[32:35], s59 offen offset:0 sc1
    v_cvt_pk_bf16_f32 v176, v176, v177
    v_cvt_pk_bf16_f32 v177, v178, v179
    v_cvt_pk_bf16_f32 v178, v180, v181
    v_cvt_pk_bf16_f32 v179, v182, v183
    v_cvt_pk_bf16_f32 v180, v184, v185
L_hop3:
    s_cbranch_execz L_hopback0
    v_cvt_pk_bf16_f32 v181, v186, v187
    v_cvt_pk_bf16_f32 v182, v188, v189
    v_cvt_pk_bf16_f32 v183, v190, v191
    buffer_store_dwordx4 v[156:159], v14, s[32:35], s59 offen offset:3072 sc1
    ds_read_b128 v[168:171], v15 offset:2048
    ds_read_b64 v[172:173], v15 offset:3080
    ds_read_b64 v[174:175], v15 offset:3072
    ds_write_b64 v48, v[176:177] offset:4096
    ds_write_b64 v49, v[178:179] offset:4096
    ds_write_b64 v50, v[180:181] offset:4096
    ds_write_b64 v51, v[182:183] offset:4096
    s_waitcnt lgkmcnt(4)
    buffer_store_dwordx4 v[168:171], v14, s[32:35], s59 offen offset:128 sc1
    buffer_store_dwordx4 v[172:175], v14, s[32:35], s59 offen offset:3200 sc1
    ds_read_b128 v[184:187], v15 offset:4096
    ds_read_b64 v[188:189], v15 offset:5128
    ds_read_b64 v[190:191], v15 offset:5120
    s_cmp_eq_u64 s[78:79], 0
    s_cbranch_scc1 L_good
    v_mov_b32 v2, 154624
    v_mov_b32 v3, 1
    ds_write_b32 v2, v3
L_good:
    s_waitcnt lgkmcnt(0)
    buffer_store_dwordx4 v[184:187], v14, s[32:35], s59 offen offset:256 sc1
    buffer_store_dwordx4 v[188:191], v14, s[32:35], s59 offen offset:3328 sc1
    s_barrier
    v_mov_b32 v0, 154624
    ds_read_b32 v0, v0
    s_waitcnt lgkmcnt(0)
    v_readfirstlane_b32 s48, v0
    s_cmp_eq_u32 s48, 0
    s_cbranch_scc0 L_redo
L_end:
    s_endpgm
L_hotend:
L_redo:
    s_waitcnt vmcnt(0)
    s_barrier
    v_mbcnt_lo_u32_b32 v0, -1, 0
    v_mbcnt_hi_u32_b32 v0, -1, v0
    s_lshl_b32 s48, s47, 6
    v_add_u32 v0, s48, v0
    s_load_dwordx4 s[4:7], s[0:1], 0
    s_load_dwordx4 s[8:11], s[0:1], 16
    v_lshrrev_b32 v8, 6, v0
    v_and_b32 v20, 63, v0
    s_mul_i32 s14, s2, 147456
    v_readfirstlane_b32 s47, v8
    s_mul_i32 s15, s2, 196608
    s_bfe_u32 s17, s2, 0x30003
    v_lshrrev_b32 v11, 3, v20
    v_mul_u32_u24 v8, 384, v11
    v_lshrrev_b32 v9, 4, v20
    v_lshlrev_b32 v10, 1, v9
    v_xor_b32 v10, v10, v20
    v_and_b32 v10, 7, v10
    v_lshl_add_u32 v7, v10, 4, v8
    s_mul_i32 s48, s47, 3072
    v_add_u32 v7, s48, v7
    v_and_b32 v10, 7, v20
    v_lshl_add_u32 v22, v10, 4, v8
    s_mul_i32 s49, s47, 36864
    v_add_u32 v22, s49, v22
    s_lshl_b32 s52, s47, 10
    s_add_u32 s53, s52, 49152
    s_mov_b32 s55, 6144
    s_mov_b32 s56, 12288
    s_mov_b32 s57, 18432
    s_mov_b32 s58, 24576
    s_mov_b32 s59, 30720
    s_waitcnt lgkmcnt(0)
    s_add_u32 s24, s6, s15
    s_addc_u32 s25, s7, 0
    s_mov_b32 s26, 196608
    s_mov_b32 s27, 0x20000
    s_mov_b32 s48, 0
    s_add_u32 m0, s52, 0
    s_nop 0
    buffer_load_dwordx4 v7, s[24:27], s48 offen offset:0 nt lds
    s_add_u32 m0, s52, 3968
    s_nop 0
    buffer_load_dwordx4 v7, s[24:27], s48 offen offset:128 nt lds
    s_add_u32 m0, s52, 7936
    s_nop 0
    buffer_load_dwordx4 v7, s[24:27], s48 offen offset:256 nt lds
    s_add_u32 s20, s4, s14
    s_addc_u32 s21, s5, 0
    s_mov_b32 s22, 147456
    s_mov_b32 s23, 0x20000
    buffer_load_dwordx4 v[112:115], v22, s[20:23], 0 offen offset:0 nt
    buffer_load_dwordx4 v[116:119], v22, s[20:23], 0 offen offset:128 nt
    buffer_load_dwordx4 v[120:123], v22, s[20:23], 0 offen offset:256 nt
    buffer_load_dwordx4 v[124:127], v22, s[20:23], 0 offen offset:3072 nt
    buffer_load_dwordx4 v[128:131], v22, s[20:23], 0 offen offset:3200 nt
    buffer_load_dwordx4 v[132:135], v22, s[20:23], 0 offen offset:3328 nt
    buffer_load_dwordx4 v[136:139], v22, s[20:23], s55 offen offset:0 nt
    buffer_load_dwordx4 v[140:143], v22, s[20:23], s55 offen offset:128 nt
    buffer_load_dwordx4 v[144:147], v22, s[20:23], s55 offen offset:256 nt
    buffer_load_dwordx4 v[148:151], v22, s[20:23], s55 offen offset:3072 nt
    buffer_load_dwordx4 v[152:155], v22, s[20:23], s55 offen offset:3200 nt
    buffer_load_dwordx4 v[156:159], v22, s[20:23], s55 offen offset:3328 nt
    buffer_load_dwordx4 v[160:163], v22, s[20:23], s56 offen offset:0 nt
    buffer_load_dwordx4 v[164:167], v22, s[20:23], s56 offen offset:128 nt
    buffer_load_dwordx4 v[168:171], v22, s[20:23], s56 offen offset:256 nt
    buffer_load_dwordx4 v[172:175], v22, s[20:23], s56 offen offset:3072 nt
    buffer_load_dwordx4 v[176:179], v22, s[20:23], s56 offen offset:3200 nt
    buffer_load_dwordx4 v[180:183], v22, s[20:23], s56 offen offset:3328 nt
    s_add_u32 s28, s8, s15
    s_addc_u32 s29, s9, 0
    s_mov_b32 s30, 196608
    s_mov_b32 s31, 0x20000
    s_add_u32 s32, s10, s14
    s_addc_u32 s33, s11, 0
    s_mov_b32 s34, 147456
    s_mov_b32 s35, 0x20000
    s_add_u32 s50, s52, 49152
    s_add_u32 s51, s53, 49152
    s_mul_i32 s16, s47, 13056
    s_add_u32 s16, s16, 98304
    v_and_b32 v10, 3, v20
    v_xor_b32 v8, v11, v10
    v_lshlrev_b32 v8, 4, v8
    v_lshl_add_u32 v8, v10, 8, v8
    v_bfe_u32 v10, v20, 2, 1
    v_mul_u32_u24 v10, 1088, v10
    v_add3_u32 v23, v8, v10, s16
    v_and_b32 v8, 15, v20
    v_xor_b32 v10, v8, v9
    v_lshlrev_b32 v10, 4, v10
    v_lshl_add_u32 v10, v9, 8, v10
    v_add_u32 v6, s16, v10
    v_and_b32 v10, 6, v20
    v_xor_b32 v10, v10, v9
    v_lshlrev_b32 v10, 4, v10
    v_lshl_add_u32 v0, v8, 7, v10
    v_xor_b32 v1, 64, v0
    v_lshrrev_b32 v10, 2, v20
    v_lshlrev_b32 v10, 7, v10
    v_and_b32 v8, 3, v20
    v_lshl_add_u32 v10, v8, 3, v10
    v_bfe_u32 v8, v20, 3, 2
    v_lshl_add_u32 v10, v8, 5, v10
    v_add_u32 v2, 73728, v10
    v_xor_b32 v3, 32, v2
    v_xor_b32 v4, 64, v2
    v_xor_b32 v5, 96, v2
    s_mov_b32 s40, 0x3dd53b95
    s_mov_b32 s41, 0x41000000
    s_mov_b32 s42, 0
    s_mov_b32 s43, 49152
    s_mov_b32 s44, 36864
    s_mov_b32 s45, s52
    s_add_u32 s46, s53, 36864
    v_accvgpr_write_b32 a112, 0
    v_accvgpr_write_b32 a113, 0
    v_accvgpr_write_b32 a114, 0
    v_accvgpr_write_b32 a115, 0
    v_accvgpr_write_b32 a116, 0
    v_accvgpr_write_b32 a117, 0
    v_accvgpr_write_b32 a118, 0
    v_accvgpr_write_b32 a119, 0
    v_accvgpr_write_b32 a120, 0
    v_accvgpr_write_b32 a121, 0
    v_accvgpr_write_b32 a122, 0
    v_accvgpr_write_b32 a123, 0
    v_accvgpr_write_b32 a124, 0
    v_accvgpr_write_b32 a125, 0
    v_accvgpr_write_b32 a126, 0
    v_accvgpr_write_b32 a127, 0
    v_accvgpr_write_b32 a128, 0
    v_accvgpr_write_b32 a129, 0
    v_accvgpr_write_b32 a130, 0
    v_accvgpr_write_b32 a131, 0
    v_accvgpr_write_b32 a132, 0
    v_accvgpr_write_b32 a133, 0
    v_accvgpr_write_b32 a134, 0
    v_accvgpr_write_b32 a135, 0
    v_accvgpr_write_b32 a136, 0
    v_accvgpr_write_b32 a137, 0
    v_accvgpr_write_b32 a138, 0
    v_accvgpr_write_b32 a139, 0
    v_accvgpr_write_b32 a140, 0
    v_accvgpr_write_b32 a141, 0
    v_accvgpr_write_b32 a142, 0
    v_accvgpr_write_b32 a143, 0
    v_accvgpr_write_b32 a144, 0
    v_accvgpr_write_b32 a145, 0
    v_accvgpr_write_b32 a146, 0
    v_accvgpr_write_b32 a147, 0
    v_accvgpr_write_b32 a148, 0
    v_accvgpr_write_b32 a149, 0
    v_accvgpr_write_b32 a150, 0
    v_accvgpr_write_b32 a151, 0
    v_accvgpr_write_b32 a152, 0
    v_accvgpr_write_b32 a153, 0
    v_accvgpr_write_b32 a154, 0
    v_accvgpr_write_b32 a155, 0
    v_accvgpr_write_b32 a156, 0
    v_accvgpr_write_b32 a157, 0
    v_accvgpr_write_b32 a158, 0
    v_accvgpr_write_b32 a159, 0
    v_accvgpr_write_b32 a160, 0
    v_accvgpr_write_b32 a161, 0
    v_accvgpr_write_b32 a162, 0
    v_accvgpr_write_b32 a163, 0
    v_accvgpr_write_b32 a164, 0
    v_accvgpr_write_b32 a165, 0
    v_accvgpr_write_b32 a166, 0
    v_accvgpr_write_b32 a167, 0
    v_accvgpr_write_b32 a168, 0
    v_accvgpr_write_b32 a169, 0
    v_accvgpr_write_b32 a170, 0
    v_accvgpr_write_b32 a171, 0
    v_accvgpr_write_b32 a172, 0
    v_accvgpr_write_b32 a173, 0
    v_accvgpr_write_b32 a174, 0
    v_accvgpr_write_b32 a175, 0
    v_accvgpr_write_b32 a176, 0
    v_accvgpr_write_b32 a177, 0
    v_accvgpr_write_b32 a178, 0
    v_accvgpr_write_b32 a179, 0
    v_accvgpr_write_b32 a180, 0
    v_accvgpr_write_b32 a181, 0
    v_accvgpr_write_b32 a182, 0
    v_accvgpr_write_b32 a183, 0
    v_accvgpr_write_b32 a184, 0
    v_accvgpr_write_b32 a185, 0
    v_accvgpr_write_b32 a186, 0
    v_accvgpr_write_b32 a187, 0
    v_accvgpr_write_b32 a188, 0
    v_accvgpr_write_b32 a189, 0
    v_accvgpr_write_b32 a190, 0
    v_accvgpr_write_b32 a191, 0
    v_accvgpr_write_b32 a192, 0
    v_accvgpr_write_b32 a193, 0
    v_accvgpr_write_b32 a194, 0
    v_accvgpr_write_b32 a195, 0
    v_accvgpr_write_b32 a196, 0
    v_accvgpr_write_b32 a197, 0
    v_accvgpr_write_b32 a198, 0
    v_accvgpr_write_b32 a199, 0
    v_accvgpr_write_b32 a200, 0
    v_accvgpr_write_b32 a201, 0
    v_accvgpr_write_b32 a202, 0
    v_accvgpr_write_b32 a203, 0
    v_accvgpr_write_b32 a204, 0
    v_accvgpr_write_b32 a205, 0
    v_accvgpr_write_b32 a206, 0
    v_accvgpr_write_b32 a207, 0
    v_accvgpr_write_b32 a208, 0
    v_accvgpr_write_b32 a209, 0
    v_accvgpr_write_b32 a210, 0
    v_accvgpr_write_b32 a211, 0
    v_accvgpr_write_b32 a212, 0
    v_accvgpr_write_b32 a213, 0
    v_accvgpr_write_b32 a214, 0
    v_accvgpr_write_b32 a215, 0
    v_accvgpr_write_b32 a216, 0
    v_accvgpr_write_b32 a217, 0
    v_accvgpr_write_b32 a218, 0
    v_accvgpr_write_b32 a219, 0
    v_accvgpr_write_b32 a220, 0
    v_accvgpr_write_b32 a221, 0
    v_accvgpr_write_b32 a222, 0
    v_accvgpr_write_b32 a223, 0
    v_accvgpr_write_b32 a224, 0
    v_accvgpr_write_b32 a225, 0
    v_accvgpr_write_b32 a226, 0
    v_accvgpr_write_b32 a227, 0
    v_accvgpr_write_b32 a228, 0
    v_accvgpr_write_b32 a229, 0
    v_accvgpr_write_b32 a230, 0
    v_accvgpr_write_b32 a231, 0
    v_accvgpr_write_b32 a232, 0
    v_accvgpr_write_b32 a233, 0
    v_accvgpr_write_b32 a234, 0
    v_accvgpr_write_b32 a235, 0
    v_accvgpr_write_b32 a236, 0
    v_accvgpr_write_b32 a237, 0
    v_accvgpr_write_b32 a238, 0
    v_accvgpr_write_b32 a239, 0
    v_accvgpr_write_b32 a240, 0
    v_accvgpr_write_b32 a241, 0
    v_accvgpr_write_b32 a242, 0
    v_accvgpr_write_b32 a243, 0
    v_accvgpr_write_b32 a244, 0
    v_accvgpr_write_b32 a245, 0
    v_accvgpr_write_b32 a246, 0
    v_accvgpr_write_b32 a247, 0
    v_accvgpr_write_b32 a248, 0
    v_accvgpr_write_b32 a249, 0
    v_accvgpr_write_b32 a250, 0
    v_accvgpr_write_b32 a251, 0
    v_accvgpr_write_b32 a252, 0
    v_accvgpr_write_b32 a253, 0
    v_accvgpr_write_b32 a254, 0
    v_accvgpr_write_b32 a255, 0
    v_mov_b32 v14, 0
    v_mov_b32 v15, 0
    v_mov_b32 v16, 0
    v_mov_b32 v17, 0
    v_mov_b32 v18, 0
    v_mov_b32 v19, 0
    s_waitcnt vmcnt(18)
    s_barrier
    ds_read_b128 v[80:83], v0 offset:0
    ds_read_b128 v[92:95], v0 offset:2048
    ds_read_b128 v[104:107], v1 offset:0
    ds_read_b128 v[32:35], v1 offset:2048
    ds_read_b128 v[48:51], v0 offset:4096
    ds_read_b128 v[64:67], v0 offset:6144
    ds_read_b128 v[40:43], v1 offset:4096
    ds_read_b128 v[56:59], v1 offset:6144
    ds_read_b128 v[72:75], v0 offset:8192
    ds_read_b128 a[96:99], v0 offset:10240
    ds_read_b128 a[100:103], v1 offset:8192
    ds_read_b128 a[104:107], v1 offset:10240
    s_waitcnt vmcnt(12)
    ds_write_b128 v23, v[112:115] offset:0
    ds_write_b128 v23, v[116:119] offset:2176
    ds_write_b128 v23, v[120:123] offset:4352
    ds_write_b128 v23, v[124:127] offset:128
    ds_write_b128 v23, v[128:131] offset:2304
    ds_write_b128 v23, v[132:135] offset:4480
    buffer_load_dwordx4 v[184:187], v22, s[20:23], s57 offen offset:0 nt
    buffer_load_dwordx4 v[188:191], v22, s[20:23], s57 offen offset:128 nt
    buffer_load_dwordx4 v[192:195], v22, s[20:23], s57 offen offset:256 nt
    buffer_load_dwordx4 v[196:199], v22, s[20:23], s57 offen offset:3072 nt
    buffer_load_dwordx4 v[200:203], v22, s[20:23], s57 offen offset:3200 nt
    buffer_load_dwordx4 v[204:207], v22, s[20:23], s57 offen offset:3328 nt
    s_waitcnt lgkmcnt(0)
    ds_read_b128 a[0:3], v6 offset:0
    ds_read_b128 a[4:7], v6 offset:1088
    ds_read_b128 a[8:11], v6 offset:2176
    ds_read_b128 a[12:15], v6 offset:3264
    ds_read_b128 a[16:19], v6 offset:4352
    ds_read_b128 a[20:23], v6 offset:5440
    v_mov_b32 v112, 0
    v_mov_b32 v113, 0
    v_mov_b32 v114, 0
    v_mov_b32 v115, 0
    v_mov_b32 v116, 0
    v_mov_b32 v117, 0
    v_mov_b32 v118, 0
    v_mov_b32 v119, 0
    v_mov_b32 v120, 0
    v_mov_b32 v121, 0
    v_mov_b32 v122, 0
    v_mov_b32 v123, 0
    v_mov_b32 v124, 0
    v_mov_b32 v125, 0
    v_mov_b32 v126, 0
    v_mov_b32 v127, 0
    v_mov_b32 v128, 0
    v_mov_b32 v129, 0
    v_mov_b32 v130, 0
    v_mov_b32 v131, 0
    v_mov_b32 v132, 0
    v_mov_b32 v133, 0
    v_mov_b32 v134, 0
    v_mov_b32 v135, 0
    s_waitcnt lgkmcnt(5)
    v_mfma_f32_16x16x32_bf16 v[76:79], v[80:83], a[0:3], 0
    v_mfma_f32_16x16x32_bf16 v[84:87], v[92:95], a[0:3], 0
    s_waitcnt lgkmcnt(4)
    v_mfma_f32_16x16x32_bf16 v[76:79], v[104:107], a[4:7], v[76:79]
    v_mfma_f32_16x16x32_bf16 v[84:87], v[32:35], a[4:7], v[84:87]
    s_waitcnt lgkmcnt(3)
    v_mfma_f32_16x16x32_bf16 v[76:79], v[48:51], a[8:11], v[76:79]
    v_mfma_f32_16x16x32_bf16 v[84:87], v[64:67], a[8:11], v[84:87]
    s_waitcnt lgkmcnt(2)
    v_mfma_f32_16x16x32_bf16 v[76:79], v[40:43], a[12:15], v[76:79]
    v_mfma_f32_16x16x32_bf16 v[84:87], v[56:59], a[12:15], v[84:87]
    s_waitcnt lgkmcnt(1)
    v_mfma_f32_16x16x32_bf16 v[76:79], v[72:75], a[16:19], v[76:79]
    v_mfma_f32_16x16x32_bf16 v[84:87], a[96:99], a[16:19], v[84:87]
    s_waitcnt lgkmcnt(0)
    v_mfma_f32_16x16x32_bf16 v[76:79], a[100:103], a[20:23], v[76:79]
    v_mfma_f32_16x16x32_bf16 v[84:87], a[104:107], a[20:23], v[84:87]
    s_nop 7
    v_max3_f32 v8, v76, v77, v78
    v_max3_f32 v8, v79, v84, v8
    v_max3_f32 v8, v85, v86, v8
    v_max_f32 v8, v87, v8
    v_mov_b32 v21, v8
    s_nop 1
    v_permlane32_swap_b32 v8, v21
    v_max_f32 v8, v8, v21
    v_mov_b32 v21, v8
    s_nop 1
    v_permlane16_swap_b32 v8, v21
    v_max_f32 v8, v8, v21
    v_mul_f32 v8, s40, v8
    v_ceil_f32 v8, v8
    v_fma_f32 v76, v76, s40, -v8
    v_fma_f32 v77, v77, s40, -v8
    v_fma_f32 v78, v78, s40, -v8
    v_fma_f32 v79, v79, s40, -v8
    v_fma_f32 v84, v84, s40, -v8
    v_fma_f32 v85, v85, s40, -v8
    v_fma_f32 v86, v86, s40, -v8
    v_fma_f32 v87, v87, s40, -v8
    v_exp_f32 v76, v76
    v_exp_f32 v77, v77
    v_exp_f32 v78, v78
    v_exp_f32 v79, v79
    v_exp_f32 v84, v84
    v_exp_f32 v85, v85
    v_exp_f32 v86, v86
    v_exp_f32 v87, v87
    s_nop 0
    v_add_f32 v14, v14, v76
    v_add_f32 v14, v14, v77
    v_cvt_pk_bf16_f32 v76, v76, v77
    v_add_f32 v14, v14, v78
    v_add_f32 v14, v14, v79
    v_cvt_pk_bf16_f32 v77, v78, v79
    v_add_f32 v14, v14, v84
    v_add_f32 v14, v14, v85
    v_cvt_pk_bf16_f32 v78, v84, v85
    v_add_f32 v14, v14, v86
    v_add_f32 v14, v14, v87
    v_cvt_pk_bf16_f32 v79, v86, v87
    s_waitcnt vmcnt(12)
    ds_write_b128 v23, v[136:139] offset:6528
    ds_write_b128 v23, v[140:143] offset:8704
    ds_write_b128 v23, v[144:147] offset:10880
    ds_write_b128 v23, v[148:151] offset:6656
    ds_write_b128 v23, v[152:155] offset:8832
    ds_write_b128 v23, v[156:159] offset:11008
    buffer_load_dwordx4 v[208:211], v22, s[20:23], s58 offen offset:0 nt
    buffer_load_dwordx4 v[212:215], v22, s[20:23], s58 offen offset:128 nt
    buffer_load_dwordx4 v[216:219], v22, s[20:23], s58 offen offset:256 nt
    buffer_load_dwordx4 v[220:223], v22, s[20:23], s58 offen offset:3072 nt
    buffer_load_dwordx4 v[224:227], v22, s[20:23], s58 offen offset:3200 nt
    buffer_load_dwordx4 v[228:231], v22, s[20:23], s58 offen offset:3328 nt
    s_waitcnt lgkmcnt(0)
    ds_read_b128 a[24:27], v6 offset:6528
    ds_read_b128 a[28:31], v6 offset:7616
    ds_read_b128 a[32:35], v6 offset:8704
    ds_read_b128 a[36:39], v6 offset:9792
    ds_read_b128 a[40:43], v6 offset:10880
    ds_read_b128 a[44:47], v6 offset:11968
    v_mov_b32 v136, 0
    v_mov_b32 v137, 0
    v_mov_b32 v138, 0
    v_mov_b32 v139, 0
    v_mov_b32 v140, 0
    v_mov_b32 v141, 0
    v_mov_b32 v142, 0
    v_mov_b32 v143, 0
    v_mov_b32 v144, 0
    v_mov_b32 v145, 0
    v_mov_b32 v146, 0
    v_mov_b32 v147, 0
    v_mov_b32 v148, 0
    v_mov_b32 v149, 0
    v_mov_b32 v150, 0
    v_mov_b32 v151, 0
    v_mov_b32 v152, 0
    v_mov_b32 v153, 0
    v_mov_b32 v154, 0
    v_mov_b32 v155, 0
    v_mov_b32 v156, 0
    v_mov_b32 v157, 0
    v_mov_b32 v158, 0
    v_mov_b32 v159, 0
    s_waitcnt lgkmcnt(5)
    v_mfma_f32_16x16x32_bf16 v[88:91], v[80:83], a[24:27], 0
    v_mfma_f32_16x16x32_bf16 v[96:99], v[92:95], a[24:27], 0
    s_waitcnt lgkmcnt(4)
    v_mfma_f32_16x16x32_bf16 v[88:91], v[104:107], a[28:31], v[88:91]
    v_mfma_f32_16x16x32_bf16 v[96:99], v[32:35], a[28:31], v[96:99]
    s_waitcnt lgkmcnt(3)
    v_mfma_f32_16x16x32_bf16 v[88:91], v[48:51], a[32:35], v[88:91]
    v_mfma_f32_16x16x32_bf16 v[96:99], v[64:67], a[32:35], v[96:99]
    s_waitcnt lgkmcnt(2)
    v_mfma_f32_16x16x32_bf16 v[88:91], v[40:43], a[36:39], v[88:91]
    v_mfma_f32_16x16x32_bf16 v[96:99], v[56:59], a[36:39], v[96:99]
    s_waitcnt lgkmcnt(1)
    v_mfma_f32_16x16x32_bf16 v[88:91], v[72:75], a[40:43], v[88:91]
    v_mfma_f32_16x16x32_bf16 v[96:99], a[96:99], a[40:43], v[96:99]
    s_waitcnt lgkmcnt(0)
    v_mfma_f32_16x16x32_bf16 v[88:91], a[100:103], a[44:47], v[88:91]
    v_mfma_f32_16x16x32_bf16 v[96:99], a[104:107], a[44:47], v[96:99]
    s_nop 7
    v_max3_f32 v9, v88, v89, v90
    v_max3_f32 v9, v91, v96, v9
    v_max3_f32 v9, v97, v98, v9
    v_max_f32 v9, v99, v9
    v_mov_b32 v21, v9
    s_nop 1
    v_permlane32_swap_b32 v9, v21
    v_max_f32 v9, v9, v21
    v_mov_b32 v21, v9
    s_nop 1
    v_permlane16_swap_b32 v9, v21
    v_max_f32 v9, v9, v21
    v_mul_f32 v9, s40, v9
    v_ceil_f32 v9, v9
    v_fma_f32 v88, v88, s40, -v9
    v_fma_f32 v89, v89, s40, -v9
    v_fma_f32 v90, v90, s40, -v9
    v_fma_f32 v91, v91, s40, -v9
    v_fma_f32 v96, v96, s40, -v9
    v_fma_f32 v97, v97, s40, -v9
    v_fma_f32 v98, v98, s40, -v9
    v_fma_f32 v99, v99, s40, -v9
    v_exp_f32 v88, v88
    v_exp_f32 v89, v89
    v_exp_f32 v90, v90
    v_exp_f32 v91, v91
    v_exp_f32 v96, v96
    v_exp_f32 v97, v97
    v_exp_f32 v98, v98
    v_exp_f32 v99, v99
    s_nop 0
    v_add_f32 v15, v15, v88
    v_add_f32 v15, v15, v89
    v_cvt_pk_bf16_f32 v88, v88, v89
    v_add_f32 v15, v15, v90
    v_add_f32 v15, v15, v91
    v_cvt_pk_bf16_f32 v89, v90, v91
    v_add_f32 v15, v15, v96
    v_add_f32 v15, v15, v97
    v_cvt_pk_bf16_f32 v90, v96, v97
    v_add_f32 v15, v15, v98
    v_add_f32 v15, v15, v99
    v_cvt_pk_bf16_f32 v91, v98, v99
    s_waitcnt vmcnt(12)
    ds_write_b128 v23, v[160:163] offset:0
    ds_write_b128 v23, v[164:167] offset:2176
    ds_write_b128 v23, v[168:171] offset:4352
    ds_write_b128 v23, v[172:175] offset:128
    ds_write_b128 v23, v[176:179] offset:2304
    ds_write_b128 v23, v[180:183] offset:4480
    buffer_load_dwordx4 v[232:235], v22, s[20:23], s59 offen offset:0 nt
    buffer_load_dwordx4 v[236:239], v22, s[20:23], s59 offen offset:128 nt
    buffer_load_dwordx4 v[240:243], v22, s[20:23], s59 offen offset:256 nt
    buffer_load_dwordx4 v[244:247], v22, s[20:23], s59 offen offset:3072 nt
    buffer_load_dwordx4 v[248:251], v22, s[20:23], s59 offen offset:3200 nt
    buffer_load_dwordx4 v[252:255], v22, s[20:23], s59 offen offset:3328 nt
    s_waitcnt lgkmcnt(0)
    ds_read_b128 a[48:51], v6 offset:0
    ds_read_b128 a[52:55], v6 offset:1088
    ds_read_b128 a[56:59], v6 offset:2176
    ds_read_b128 a[60:63], v6 offset:3264
    ds_read_b128 a[64:67], v6 offset:4352
    ds_read_b128 a[68:71], v6 offset:5440
    v_mov_b32 v160, 0
    v_mov_b32 v161, 0
    v_mov_b32 v162, 0
    v_mov_b32 v163, 0
    v_mov_b32 v164, 0
    v_mov_b32 v165, 0
    v_mov_b32 v166, 0
    v_mov_b32 v167, 0
    v_mov_b32 v168, 0
    v_mov_b32 v169, 0
    v_mov_b32 v170, 0
    v_mov_b32 v171, 0
    v_mov_b32 v172, 0
    v_mov_b32 v173, 0
    v_mov_b32 v174, 0
    v_mov_b32 v175, 0
    v_mov_b32 v176, 0
    v_mov_b32 v177, 0
    v_mov_b32 v178, 0
    v_mov_b32 v179, 0
    v_mov_b32 v180, 0
    v_mov_b32 v181, 0
    v_mov_b32 v182, 0
    v_mov_b32 v183, 0
    s_waitcnt lgkmcnt(5)
    v_mfma_f32_16x16x32_bf16 v[100:103], v[80:83], a[48:51], 0
    v_mfma_f32_16x16x32_bf16 v[108:111], v[92:95], a[48:51], 0
    s_waitcnt lgkmcnt(4)
    v_mfma_f32_16x16x32_bf16 v[100:103], v[104:107], a[52:55], v[100:103]
    v_mfma_f32_16x16x32_bf16 v[108:111], v[32:35], a[52:55], v[108:111]
    s_waitcnt lgkmcnt(3)
    v_mfma_f32_16x16x32_bf16 v[100:103], v[48:51], a[56:59], v[100:103]
    v_mfma_f32_16x16x32_bf16 v[108:111], v[64:67], a[56:59], v[108:111]
    s_waitcnt lgkmcnt(2)
    v_mfma_f32_16x16x32_bf16 v[100:103], v[40:43], a[60:63], v[100:103]
    v_mfma_f32_16x16x32_bf16 v[108:111], v[56:59], a[60:63], v[108:111]
    s_waitcnt lgkmcnt(1)
    v_mfma_f32_16x16x32_bf16 v[100:103], v[72:75], a[64:67], v[100:103]
    v_mfma_f32_16x16x32_bf16 v[108:111], a[96:99], a[64:67], v[108:111]
    s_waitcnt lgkmcnt(0)
    v_mfma_f32_16x16x32_bf16 v[100:103], a[100:103], a[68:71], v[100:103]
    v_mfma_f32_16x16x32_bf16 v[108:111], a[104:107], a[68:71], v[108:111]
    s_nop 7
    v_max3_f32 v10, v100, v101, v102
    v_max3_f32 v10, v103, v108, v10
    v_max3_f32 v10, v109, v110, v10
    v_max_f32 v10, v111, v10
    v_mov_b32 v21, v10
    s_nop 1
    v_permlane32_swap_b32 v10, v21
    v_max_f32 v10, v10, v21
    v_mov_b32 v21, v10
    s_nop 1
    v_permlane16_swap_b32 v10, v21
    v_max_f32 v10, v10, v21
    v_mul_f32 v10, s40, v10
    v_ceil_f32 v10, v10
    v_fma_f32 v100, v100, s40, -v10
    v_fma_f32 v101, v101, s40, -v10
    v_fma_f32 v102, v102, s40, -v10
    v_fma_f32 v103, v103, s40, -v10
    v_fma_f32 v108, v108, s40, -v10
    v_fma_f32 v109, v109, s40, -v10
    v_fma_f32 v110, v110, s40, -v10
    v_fma_f32 v111, v111, s40, -v10
    v_exp_f32 v100, v100
    v_exp_f32 v101, v101
    v_exp_f32 v102, v102
    v_exp_f32 v103, v103
    v_exp_f32 v108, v108
    v_exp_f32 v109, v109
    v_exp_f32 v110, v110
    v_exp_f32 v111, v111
    s_nop 0
    v_add_f32 v16, v16, v100
    v_add_f32 v16, v16, v101
    v_cvt_pk_bf16_f32 v100, v100, v101
    v_add_f32 v16, v16, v102
    v_add_f32 v16, v16, v103
    v_cvt_pk_bf16_f32 v101, v102, v103
    v_add_f32 v16, v16, v108
    v_add_f32 v16, v16, v109
    v_cvt_pk_bf16_f32 v102, v108, v109
    v_add_f32 v16, v16, v110
    v_add_f32 v16, v16, v111
    v_cvt_pk_bf16_f32 v103, v110, v111
    s_waitcnt vmcnt(12)
    ds_write_b128 v23, v[184:187] offset:6528
    ds_write_b128 v23, v[188:191] offset:8704
    ds_write_b128 v23, v[192:195] offset:10880
    ds_write_b128 v23, v[196:199] offset:6656
    ds_write_b128 v23, v[200:203] offset:8832
    ds_write_b128 v23, v[204:207] offset:11008
    s_mov_b32 s48, 12288
    s_add_u32 m0, s52, 12288
    s_nop 0
    buffer_load_dwordx4 v7, s[24:27], s48 offen offset:0 nt lds
    s_add_u32 m0, s52, 16256
    s_nop 0
    buffer_load_dwordx4 v7, s[24:27], s48 offen offset:128 nt lds
    s_add_u32 m0, s52, 20224
    s_nop 0
    buffer_load_dwordx4 v7, s[24:27], s48 offen offset:256 nt lds
    s_mov_b32 s48, 0
    s_add_u32 m0, s53, 0
    s_nop 0
    buffer_load_dwordx4 v7, s[28:31], s48 offen offset:0 nt lds
    s_add_u32 m0, s53, 3968
    s_nop 0
    buffer_load_dwordx4 v7, s[28:31], s48 offen offset:128 nt lds
    s_add_u32 m0, s53, 7936
    s_nop 0
    buffer_load_dwordx4 v7, s[28:31], s48 offen offset:256 nt lds
    s_waitcnt lgkmcnt(0)
    ds_read_b128 a[72:75], v6 offset:6528
    ds_read_b128 a[76:79], v6 offset:7616
    ds_read_b128 a[80:83], v6 offset:8704
    ds_read_b128 a[84:87], v6 offset:9792
    ds_read_b128 a[88:91], v6 offset:10880
    ds_read_b128 a[92:95], v6 offset:11968
    v_mov_b32 v184, 0
    v_mov_b32 v185, 0
    v_mov_b32 v186, 0
    v_mov_b32 v187, 0
    v_mov_b32 v188, 0
    v_mov_b32 v189, 0
    v_mov_b32 v190, 0
    v_mov_b32 v191, 0
    v_mov_b32 v192, 0
    v_mov_b32 v193, 0
    v_mov_b32 v194, 0
    v_mov_b32 v195, 0
    v_mov_b32 v196, 0
    v_mov_b32 v197, 0
    v_mov_b32 v198, 0
    v_mov_b32 v199, 0
    v_mov_b32 v200, 0
    v_mov_b32 v201, 0
    v_mov_b32 v202, 0
    v_mov_b32 v203, 0
    v_mov_b32 v204, 0
    v_mov_b32 v205, 0
    v_mov_b32 v206, 0
    v_mov_b32 v207, 0
    s_waitcnt lgkmcnt(5)
    v_mfma_f32_16x16x32_bf16 v[28:31], v[80:83], a[72:75], 0
    v_mfma_f32_16x16x32_bf16 v[36:39], v[92:95], a[72:75], 0
    s_waitcnt lgkmcnt(4)
    v_mfma_f32_16x16x32_bf16 v[28:31], v[104:107], a[76:79], v[28:31]
    v_mfma_f32_16x16x32_bf16 v[36:39], v[32:35], a[76:79], v[36:39]
    s_waitcnt lgkmcnt(3)
    v_mfma_f32_16x16x32_bf16 v[28:31], v[48:51], a[80:83], v[28:31]
    v_mfma_f32_16x16x32_bf16 v[36:39], v[64:67], a[80:83], v[36:39]
    s_waitcnt lgkmcnt(2)
    v_mfma_f32_16x16x32_bf16 v[28:31], v[40:43], a[84:87], v[28:31]
    v_mfma_f32_16x16x32_bf16 v[36:39], v[56:59], a[84:87], v[36:39]
    s_waitcnt lgkmcnt(1)
    v_mfma_f32_16x16x32_bf16 v[28:31], v[72:75], a[88:91], v[28:31]
    v_mfma_f32_16x16x32_bf16 v[36:39], a[96:99], a[88:91], v[36:39]
    s_waitcnt lgkmcnt(0)
    v_mfma_f32_16x16x32_bf16 v[28:31], a[100:103], a[92:95], v[28:31]
    v_mfma_f32_16x16x32_bf16 v[36:39], a[104:107], a[92:95], v[36:39]
    s_nop 7
    v_max3_f32 v11, v28, v29, v30
    v_max3_f32 v11, v31, v36, v11
    v_max3_f32 v11, v37, v38, v11
    v_max_f32 v11, v39, v11
    v_mov_b32 v21, v11
    s_nop 1
    v_permlane32_swap_b32 v11, v21
    v_max_f32 v11, v11, v21
    v_mov_b32 v21, v11
    s_nop 1
    v_permlane16_swap_b32 v11, v21
    v_max_f32 v11, v11, v21
    v_mul_f32 v11, s40, v11
    v_ceil_f32 v11, v11
    s_waitcnt vmcnt(12)
    ds_write_b128 v23, v[208:211] offset:0
    ds_write_b128 v23, v[212:215] offset:2176
    ds_write_b128 v23, v[216:219] offset:4352
    ds_write_b128 v23, v[220:223] offset:128
    ds_write_b128 v23, v[224:227] offset:2304
    ds_write_b128 v23, v[228:231] offset:4480
    s_mov_b32 s48, 24576
    s_add_u32 m0, s52, 24576
    s_nop 0
    buffer_load_dwordx4 v7, s[24:27], s48 offen offset:0 nt lds
    s_add_u32 m0, s52, 28544
    s_nop 0
    buffer_load_dwordx4 v7, s[24:27], s48 offen offset:128 nt lds
    s_add_u32 m0, s52, 32512
    s_nop 0
    buffer_load_dwordx4 v7, s[24:27], s48 offen offset:256 nt lds
    s_mov_b32 s48, 12288
    s_add_u32 m0, s53, 12288
    s_nop 0
    buffer_load_dwordx4 v7, s[28:31], s48 offen offset:0 nt lds
    s_add_u32 m0, s53, 16256
    s_nop 0
    buffer_load_dwordx4 v7, s[28:31], s48 offen offset:128 nt lds
    s_add_u32 m0, s53, 20224
    s_nop 0
    buffer_load_dwordx4 v7, s[28:31], s48 offen offset:256 nt lds
    s_waitcnt lgkmcnt(0)
    ds_read_b128 v[208:211], v6 offset:0
    ds_read_b128 v[212:215], v6 offset:1088
    ds_read_b128 v[216:219], v6 offset:2176
    ds_read_b128 v[220:223], v6 offset:3264
    ds_read_b128 v[224:227], v6 offset:4352
    ds_read_b128 v[228:231], v6 offset:5440
    s_waitcnt lgkmcnt(5)
    v_mfma_f32_16x16x32_bf16 v[44:47], v[80:83], v[208:211], 0
    v_mfma_f32_16x16x32_bf16 v[52:55], v[92:95], v[208:211], 0
    s_waitcnt lgkmcnt(4)
    v_mfma_f32_16x16x32_bf16 v[44:47], v[104:107], v[212:215], v[44:47]
    v_mfma_f32_16x16x32_bf16 v[52:55], v[32:35], v[212:215], v[52:55]
    s_waitcnt lgkmcnt(3)
    v_mfma_f32_16x16x32_bf16 v[44:47], v[48:51], v[216:219], v[44:47]
    v_mfma_f32_16x16x32_bf16 v[52:55], v[64:67], v[216:219], v[52:55]
    s_waitcnt lgkmcnt(2)
    v_mfma_f32_16x16x32_bf16 v[44:47], v[40:43], v[220:223], v[44:47]
    v_mfma_f32_16x16x32_bf16 v[52:55], v[56:59], v[220:223], v[52:55]
    s_waitcnt lgkmcnt(1)
    v_mfma_f32_16x16x32_bf16 v[44:47], v[72:75], v[224:227], v[44:47]
    v_mfma_f32_16x16x32_bf16 v[52:55], a[96:99], v[224:227], v[52:55]
    s_waitcnt lgkmcnt(0)
    v_mfma_f32_16x16x32_bf16 v[44:47], a[100:103], v[228:231], v[44:47]
    v_mfma_f32_16x16x32_bf16 v[52:55], a[104:107], v[228:231], v[52:55]
    v_mov_b32 v208, 0
    v_mov_b32 v209, 0
    v_mov_b32 v210, 0
    v_mov_b32 v211, 0
    v_mov_b32 v212, 0
    v_mov_b32 v213, 0
    v_mov_b32 v214, 0
    v_mov_b32 v215, 0
    v_mov_b32 v216, 0
    v_mov_b32 v217, 0
    v_mov_b32 v218, 0
    v_mov_b32 v219, 0
    v_mov_b32 v220, 0
    v_mov_b32 v221, 0
    v_mov_b32 v222, 0
    v_mov_b32 v223, 0
    v_mov_b32 v224, 0
    v_mov_b32 v225, 0
    v_mov_b32 v226, 0
    v_mov_b32 v227, 0
    v_mov_b32 v228, 0
    v_mov_b32 v229, 0
    v_mov_b32 v230, 0
    v_mov_b32 v231, 0
    v_max3_f32 v12, v44, v45, v46
    v_max3_f32 v12, v47, v52, v12
    v_max3_f32 v12, v53, v54, v12
    v_max_f32 v12, v55, v12
    v_mov_b32 v21, v12
    s_nop 1
    v_permlane32_swap_b32 v12, v21
    v_max_f32 v12, v12, v21
    v_mov_b32 v21, v12
    s_nop 1
    v_permlane16_swap_b32 v12, v21
    v_max_f32 v12, v12, v21
    v_mul_f32 v12, s40, v12
    v_ceil_f32 v12, v12
    s_waitcnt vmcnt(12)
    ds_write_b128 v23, v[232:235] offset:6528
    ds_write_b128 v23, v[236:239] offset:8704
    ds_write_b128 v23, v[240:243] offset:10880
    ds_write_b128 v23, v[244:247] offset:6656
    ds_write_b128 v23, v[248:251] offset:8832
    ds_write_b128 v23, v[252:255] offset:11008
    s_mov_b32 s48, 36864
    s_add_u32 m0, s52, 36864
    s_nop 0
    buffer_load_dwordx4 v7, s[24:27], s48 offen offset:0 nt lds
    s_add_u32 m0, s52, 40832
    s_nop 0
    buffer_load_dwordx4 v7, s[24:27], s48 offen offset:128 nt lds
    s_add_u32 m0, s52, 44800
    s_nop 0
    buffer_load_dwordx4 v7, s[24:27], s48 offen offset:256 nt lds
    s_mov_b32 s48, 24576
    s_add_u32 m0, s53, 24576
    s_nop 0
    buffer_load_dwordx4 v7, s[28:31], s48 offen offset:0 nt lds
    s_add_u32 m0, s53, 28544
    s_nop 0
    buffer_load_dwordx4 v7, s[28:31], s48 offen offset:128 nt lds
    s_add_u32 m0, s53, 32512
    s_nop 0
    buffer_load_dwordx4 v7, s[28:31], s48 offen offset:256 nt lds
    s_waitcnt lgkmcnt(0)
    ds_read_b128 v[232:235], v6 offset:6528
    ds_read_b128 v[236:239], v6 offset:7616
    ds_read_b128 v[240:243], v6 offset:8704
    ds_read_b128 v[244:247], v6 offset:9792
    ds_read_b128 v[248:251], v6 offset:10880
    ds_read_b128 v[252:255], v6 offset:11968
    s_waitcnt lgkmcnt(5)
    v_mfma_f32_16x16x32_bf16 v[60:63], v[80:83], v[232:235], 0
    v_mfma_f32_16x16x32_bf16 v[68:71], v[92:95], v[232:235], 0
    s_waitcnt lgkmcnt(4)
    v_mfma_f32_16x16x32_bf16 v[60:63], v[104:107], v[236:239], v[60:63]
    v_mfma_f32_16x16x32_bf16 v[68:71], v[32:35], v[236:239], v[68:71]
    s_waitcnt lgkmcnt(3)
    v_mfma_f32_16x16x32_bf16 v[60:63], v[48:51], v[240:243], v[60:63]
    v_mfma_f32_16x16x32_bf16 v[68:71], v[64:67], v[240:243], v[68:71]
    s_waitcnt lgkmcnt(2)
    v_mfma_f32_16x16x32_bf16 v[60:63], v[40:43], v[244:247], v[60:63]
    v_mfma_f32_16x16x32_bf16 v[68:71], v[56:59], v[244:247], v[68:71]
    s_waitcnt lgkmcnt(1)
    v_mfma_f32_16x16x32_bf16 v[60:63], v[72:75], v[248:251], v[60:63]
    v_mfma_f32_16x16x32_bf16 v[68:71], a[96:99], v[248:251], v[68:71]
    s_waitcnt lgkmcnt(0)
    v_mfma_f32_16x16x32_bf16 v[60:63], a[100:103], v[252:255], v[60:63]
    v_mfma_f32_16x16x32_bf16 v[68:71], a[104:107], v[252:255], v[68:71]
    s_waitcnt vmcnt(15)
    s_barrier
    ds_read_b128 a[96:99], v0 offset:12288
    ds_read_b128 a[108:111], v6 offset:0
    ds_read_b128 a[100:103], v0 offset:14336
    ds_read_b128 v[24:27], v6 offset:6528
    v_mov_b32 v232, 0
    v_mov_b32 v233, 0
    v_mov_b32 v234, 0
    v_mov_b32 v235, 0
    v_mov_b32 v236, 0
    v_mov_b32 v237, 0
    v_mov_b32 v238, 0
    v_mov_b32 v239, 0
    v_mov_b32 v240, 0
    v_mov_b32 v241, 0
    v_mov_b32 v242, 0
    v_mov_b32 v243, 0
    v_mov_b32 v244, 0
    v_mov_b32 v245, 0
    v_mov_b32 v246, 0
    v_mov_b32 v247, 0
    v_mov_b32 v248, 0
    v_mov_b32 v249, 0
    v_mov_b32 v250, 0
    v_mov_b32 v251, 0
    v_mov_b32 v252, 0
    v_mov_b32 v253, 0
    v_mov_b32 v254, 0
    v_mov_b32 v255, 0
    v_max3_f32 v13, v60, v61, v62
    v_max3_f32 v13, v63, v68, v13
    v_max3_f32 v13, v69, v70, v13
    v_max_f32 v13, v71, v13
    v_mov_b32 v21, v13
    s_nop 1
    v_permlane32_swap_b32 v13, v21
    v_max_f32 v13, v13, v21
    v_mov_b32 v21, v13
    s_nop 1
    v_permlane16_swap_b32 v13, v21
    v_max_f32 v13, v13, v21
    v_mul_f32 v13, s40, v13
    v_ceil_f32 v13, v13
    s_waitcnt lgkmcnt(0)
.p2align 6
S_loop:
    v_mfma_f32_16x16x32_bf16 v[80:83], a[96:99], a[0:3], 0
    ds_read_b128 a[104:107], v1 offset:12288
    v_fma_f32 v28, v28, s40, -v11
    v_mfma_f32_16x16x32_bf16 v[92:95], a[96:99], a[24:27], 0
    v_fma_f32 v29, v29, s40, -v11
    v_max_f32 v20, v28, v29
    v_mfma_f32_16x16x32_bf16 v[104:107], a[96:99], a[48:51], 0
    v_fma_f32 v30, v30, s40, -v11
    v_fma_f32 v31, v31, s40, -v11
    v_mfma_f32_16x16x32_bf16 v[32:35], a[96:99], a[72:75], 0
    s_waitcnt lgkmcnt(3)
    v_max3_f32 v20, v30, v31, v20
    v_fma_f32 v44, v44, s40, -v12
    v_mfma_f32_16x16x32_bf16 v[48:51], a[96:99], a[108:111], 0
    s_waitcnt lgkmcnt(1)
    v_fma_f32 v45, v45, s40, -v12
    v_max3_f32 v20, v44, v45, v20
    v_mfma_f32_16x16x32_bf16 v[64:67], a[96:99], v[24:27], 0
    v_fma_f32 v46, v46, s40, -v12
    v_fma_f32 v47, v47, s40, -v12
    v_mfma_f32_16x16x32_bf16 v[72:75], a[100:103], v[24:27], 0
    ds_read_b128 a[96:99], v1 offset:14336
    ds_read_b128 v[24:27], v6 offset:7616
    v_mfma_f32_16x16x32_bf16 v[56:59], a[100:103], a[108:111], 0
    v_max3_f32 v20, v46, v47, v20
    v_fma_f32 v60, v60, s40, -v13
    v_mfma_f32_16x16x32_bf16 v[40:43], a[100:103], a[72:75], 0
    ds_read_b128 a[108:111], v6 offset:1088
    v_fma_f32 v61, v61, s40, -v13
    v_mfma_f32_16x16x32_bf16 v[108:111], a[100:103], a[48:51], 0
    v_max3_f32 v20, v60, v61, v20
    v_fma_f32 v62, v62, s40, -v13
    v_mfma_f32_16x16x32_bf16 v[96:99], a[100:103], a[24:27], 0
    v_fma_f32 v63, v63, s40, -v13
    v_max3_f32 v20, v62, v63, v20
    v_mfma_f32_16x16x32_bf16 v[84:87], a[100:103], a[0:3], 0
    s_waitcnt lgkmcnt(3)
    v_fma_f32 v36, v36, s40, -v11
    v_fma_f32 v37, v37, s40, -v11
    v_mfma_f32_16x16x32_bf16 v[80:83], a[104:107], a[4:7], v[80:83]
    ds_read_b128 a[100:103], v0 offset:16384
    v_max3_f32 v20, v36, v37, v20
    v_mfma_f32_16x16x32_bf16 v[92:95], a[104:107], a[28:31], v[92:95]
    v_fma_f32 v38, v38, s40, -v11
    v_fma_f32 v39, v39, s40, -v11
    v_mfma_f32_16x16x32_bf16 v[104:107], a[104:107], a[52:55], v[104:107]
    v_max3_f32 v20, v38, v39, v20
    v_fma_f32 v52, v52, s40, -v12
    v_mfma_f32_16x16x32_bf16 v[32:35], a[104:107], a[76:79], v[32:35]
    s_waitcnt lgkmcnt(1)
    v_fma_f32 v53, v53, s40, -v12
    v_max3_f32 v20, v52, v53, v20
    v_mfma_f32_16x16x32_bf16 v[48:51], a[104:107], a[108:111], v[48:51]
    v_fma_f32 v54, v54, s40, -v12
    v_fma_f32 v55, v55, s40, -v12
    v_mfma_f32_16x16x32_bf16 v[64:67], a[104:107], v[24:27], v[64:67]
    v_max3_f32 v20, v54, v55, v20
    v_fma_f32 v68, v68, s40, -v13
    v_mfma_f32_16x16x32_bf16 v[72:75], a[96:99], v[24:27], v[72:75]
    ds_read_b128 a[104:107], v0 offset:18432
    ds_read_b128 v[24:27], v6 offset:8704
    v_mfma_f32_16x16x32_bf16 v[56:59], a[96:99], a[108:111], v[56:59]
    v_fma_f32 v69, v69, s40, -v13
    v_max3_f32 v20, v68, v69, v20
    v_mfma_f32_16x16x32_bf16 v[40:43], a[96:99], a[76:79], v[40:43]
    ds_read_b128 a[108:111], v6 offset:2176
    v_fma_f32 v70, v70, s40, -v13
    v_mfma_f32_16x16x32_bf16 v[108:111], a[96:99], a[52:55], v[108:111]
    v_fma_f32 v71, v71, s40, -v13
    v_max3_f32 v20, v70, v71, v20
    v_mfma_f32_16x16x32_bf16 v[96:99], a[96:99], a[28:31], v[96:99]
    v_cmp_lt_f32 vcc, s41, v20
    v_xor_b32 v2, 0x1e000, v2
    v_mfma_f32_16x16x32_bf16 v[84:87], a[96:99], a[4:7], v[84:87]
    s_waitcnt lgkmcnt(3)
    v_xor_b32 v3, 0x1e000, v3
    v_xor_b32 v4, 0x1e000, v4
    v_mfma_f32_16x16x32_bf16 v[80:83], a[100:103], a[8:11], v[80:83]
    s_cbranch_vccnz S_rare_late0
S_back_late0:
    ds_read_b128 a[96:99], v1 offset:16384
    v_xor_b32 v5, 0x1e000, v5
    v_mfma_f32_16x16x32_bf16 v[92:95], a[100:103], a[32:35], v[92:95]
    v_exp_f32 v28, v28
    v_mfma_f32_16x16x32_bf16 v[104:107], a[100:103], a[56:59], v[104:107]
    v_exp_f32 v29, v29
    v_mfma_f32_16x16x32_bf16 v[32:35], a[100:103], a[80:83], v[32:35]
    s_waitcnt lgkmcnt(1)
    v_exp_f32 v30, v30
    v_mfma_f32_16x16x32_bf16 v[48:51], a[100:103], a[108:111], v[48:51]
    v_exp_f32 v31, v31
    v_mfma_f32_16x16x32_bf16 v[64:67], a[100:103], v[24:27], v[64:67]
    v_exp_f32 v36, v36
    v_mfma_f32_16x16x32_bf16 v[72:75], a[104:107], v[24:27], v[72:75]
    ds_read_b128 a[100:103], v1 offset:18432
    ds_read_b128 v[24:27], v6 offset:9792
    v_mfma_f32_16x16x32_bf16 v[56:59], a[104:107], a[108:111], v[56:59]
    v_exp_f32 v37, v37
    v_mfma_f32_16x16x32_bf16 v[40:43], a[104:107], a[80:83], v[40:43]
    ds_read_b128 a[108:111], v6 offset:3264
    v_add_f32 v17, v17, v28
    v_mfma_f32_16x16x32_bf16 v[108:111], a[104:107], a[56:59], v[108:111]
    v_exp_f32 v38, v38
    v_mfma_f32_16x16x32_bf16 v[96:99], a[104:107], a[32:35], v[96:99]
    v_exp_f32 v39, v39
    v_mfma_f32_16x16x32_bf16 v[84:87], a[104:107], a[8:11], v[84:87]
    s_waitcnt lgkmcnt(3)
    v_exp_f32 v44, v44
    v_mfma_f32_16x16x32_bf16 v[80:83], a[96:99], a[12:15], v[80:83]
    ds_read_b128 a[104:107], v0 offset:20480
    v_add_f32 v17, v17, v29
    v_mfma_f32_16x16x32_bf16 v[92:95], a[96:99], a[36:39], v[92:95]
    v_exp_f32 v45, v45
    v_mfma_f32_16x16x32_bf16 v[104:107], a[96:99], a[60:63], v[104:107]
    v_exp_f32 v46, v46
    v_mfma_f32_16x16x32_bf16 v[32:35], a[96:99], a[84:87], v[32:35]
    s_waitcnt lgkmcnt(1)
    v_exp_f32 v47, v47
    v_mfma_f32_16x16x32_bf16 v[48:51], a[96:99], a[108:111], v[48:51]
    v_exp_f32 v52, v52
    v_cvt_pk_bf16_f32 v28, v28, v29
    v_mfma_f32_16x16x32_bf16 v[64:67], a[96:99], v[24:27], v[64:67]
    v_exp_f32 v53, v53
    v_mfma_f32_16x16x32_bf16 v[72:75], a[100:103], v[24:27], v[72:75]
    ds_read_b128 a[96:99], v0 offset:22528
    ds_read_b128 v[24:27], v6 offset:10880
    v_mfma_f32_16x16x32_bf16 v[56:59], a[100:103], a[108:111], v[56:59]
    v_exp_f32 v54, v54
    v_mfma_f32_16x16x32_bf16 v[40:43], a[100:103], a[84:87], v[40:43]
    ds_read_b128 a[108:111], v6 offset:4352
    v_add_f32 v17, v17, v30
    v_mfma_f32_16x16x32_bf16 v[108:111], a[100:103], a[60:63], v[108:111]
    v_exp_f32 v55, v55
    v_mfma_f32_16x16x32_bf16 v[96:99], a[100:103], a[36:39], v[96:99]
    v_exp_f32 v60, v60
    v_mfma_f32_16x16x32_bf16 v[84:87], a[100:103], a[12:15], v[84:87]
    s_waitcnt lgkmcnt(3)
    v_exp_f32 v61, v61
    v_mfma_f32_16x16x32_bf16 v[80:83], a[104:107], a[16:19], v[80:83]
    ds_read_b128 a[100:103], v1 offset:20480
    v_add_f32 v17, v17, v31
    v_mfma_f32_16x16x32_bf16 v[92:95], a[104:107], a[40:43], v[92:95]
    v_cvt_pk_bf16_f32 v29, v30, v31
    v_add_f32 v17, v17, v36
    v_mfma_f32_16x16x32_bf16 v[104:107], a[104:107], a[64:67], v[104:107]
    v_add_f32 v17, v17, v37
    v_cvt_pk_bf16_f32 v30, v36, v37
    v_mfma_f32_16x16x32_bf16 v[32:35], a[104:107], a[88:91], v[32:35]
    s_waitcnt lgkmcnt(1)
    v_add_f32 v17, v17, v38
    v_add_f32 v17, v17, v39
    v_mfma_f32_16x16x32_bf16 v[48:51], a[104:107], a[108:111], v[48:51]
    v_exp_f32 v62, v62
    v_mfma_f32_16x16x32_bf16 v[64:67], a[104:107], v[24:27], v[64:67]
    v_exp_f32 v63, v63
    v_mfma_f32_16x16x32_bf16 v[72:75], a[96:99], v[24:27], v[72:75]
    ds_read_b128 a[104:107], v1 offset:22528
    ds_read_b128 v[24:27], v6 offset:11968
    v_mfma_f32_16x16x32_bf16 v[56:59], a[96:99], a[108:111], v[56:59]
    s_waitcnt vmcnt(9)
    v_exp_f32 v68, v68
    v_mfma_f32_16x16x32_bf16 v[40:43], a[96:99], a[88:91], v[40:43]
    s_barrier
    ds_read_b128 a[108:111], v6 offset:5440
    v_cvt_pk_bf16_f32 v31, v38, v39
    v_mfma_f32_16x16x32_bf16 v[108:111], a[96:99], a[64:67], v[108:111]
    v_exp_f32 v69, v69
    v_mfma_f32_16x16x32_bf16 v[96:99], a[96:99], a[40:43], v[96:99]
    v_exp_f32 v70, v70
    v_mfma_f32_16x16x32_bf16 v[84:87], a[96:99], a[16:19], v[84:87]
    s_waitcnt lgkmcnt(3)
    v_exp_f32 v71, v71
    v_mfma_f32_16x16x32_bf16 v[80:83], a[100:103], a[20:23], v[80:83]
    ds_read_b64_tr_b16 a[96:97], v2 offset:0
    ds_read_b64_tr_b16 a[98:99], v2 offset:2048
    v_mfma_f32_16x16x32_bf16 v[92:95], a[100:103], a[44:47], v[92:95]
    s_add_u32 m0, s45, 0
    v_add_f32 v18, v18, v44
    v_add_f32 v18, v18, v45
    v_mfma_f32_16x16x32_bf16 v[104:107], a[100:103], a[68:71], v[104:107]
    buffer_load_dwordx4 v7, s[24:27], s43 offen offset:0 nt lds
    v_cvt_pk_bf16_f32 v44, v44, v45
    v_mfma_f32_16x16x32_bf16 v[32:35], a[100:103], a[92:95], v[32:35]
    s_waitcnt lgkmcnt(2)
    v_add_f32 v18, v18, v46
    v_add_f32 v18, v18, v47
    v_mfma_f32_16x16x32_bf16 v[48:51], a[100:103], a[108:111], v[48:51]
    v_cvt_pk_bf16_f32 v45, v46, v47
    v_add_f32 v18, v18, v52
    v_mfma_f32_16x16x32_bf16 v[64:67], a[100:103], v[24:27], v[64:67]
    v_add_f32 v18, v18, v53
    v_cvt_pk_bf16_f32 v46, v52, v53
    v_mfma_f32_16x16x32_bf16 v[84:87], a[104:107], a[20:23], v[84:87]
    ds_read_b64_tr_b16 a[100:101], v3 offset:0
    ds_read_b64_tr_b16 a[102:103], v3 offset:2048
    v_mfma_f32_16x16x32_bf16 v[96:99], a[104:107], a[44:47], v[96:99]
    v_add_f32 v18, v18, v54
    v_add_f32 v18, v18, v55
    v_mfma_f32_16x16x32_bf16 v[108:111], a[104:107], a[68:71], v[108:111]
    v_cvt_pk_bf16_f32 v47, v54, v55
    v_add_f32 v19, v19, v60
    v_mfma_f32_16x16x32_bf16 v[40:43], a[104:107], a[92:95], v[40:43]
    v_add_f32 v19, v19, v61
    v_cvt_pk_bf16_f32 v60, v60, v61
    v_mfma_f32_16x16x32_bf16 v[56:59], a[104:107], a[108:111], v[56:59]
    v_add_f32 v19, v19, v62
    v_add_f32 v19, v19, v63
    v_mfma_f32_16x16x32_bf16 v[72:75], a[104:107], v[24:27], v[72:75]
    s_waitcnt lgkmcnt(2)
    v_cvt_pk_bf16_f32 v61, v62, v63
    v_add_f32 v19, v19, v68
    v_mfma_f32_16x16x32_bf16 v[112:115], a[96:99], v[76:79], v[112:115]
    ds_read_b64_tr_b16 a[104:105], v4 offset:0
    ds_read_b64_tr_b16 a[106:107], v4 offset:2048
    v_mfma_f32_16x16x32_bf16 v[160:163], a[96:99], v[88:91], v[160:163]
    s_add_u32 m0, s45, 3968
    v_add_f32 v19, v19, v69
    v_cvt_pk_bf16_f32 v62, v68, v69
    v_add_f32 v19, v19, v70
    v_mfma_f32_16x16x32_bf16 v[208:211], a[96:99], v[100:103], v[208:211]
    buffer_load_dwordx4 v7, s[24:27], s43 offen offset:128 nt lds
    v_add_f32 v19, v19, v71
    v_mfma_f32_16x16x32_bf16 a[112:115], a[96:99], v[28:31], a[112:115]
    v_cvt_pk_bf16_f32 v63, v70, v71
    v_fma_f32 v80, v80, s40, -v8
    v_mfma_f32_16x16x32_bf16 a[160:163], a[96:99], v[44:47], a[160:163]
    v_fma_f32 v81, v81, s40, -v8
    v_max_f32 v20, v80, v81
    v_mfma_f32_16x16x32_bf16 a[208:211], a[96:99], v[60:63], a[208:211]
    s_waitcnt lgkmcnt(2)
    v_fma_f32 v82, v82, s40, -v8
    v_fma_f32 v83, v83, s40, -v8
    v_max3_f32 v20, v82, v83, v20
    v_mfma_f32_16x16x32_bf16 v[116:119], a[100:103], v[76:79], v[116:119]
    ds_read_b64_tr_b16 a[96:97], v5 offset:0
    ds_read_b64_tr_b16 a[98:99], v5 offset:2048
    v_mfma_f32_16x16x32_bf16 v[164:167], a[100:103], v[88:91], v[164:167]
    v_fma_f32 v92, v92, s40, -v9
    v_fma_f32 v93, v93, s40, -v9
    v_mfma_f32_16x16x32_bf16 v[212:215], a[100:103], v[100:103], v[212:215]
    v_max3_f32 v20, v92, v93, v20
    v_fma_f32 v94, v94, s40, -v9
    v_mfma_f32_16x16x32_bf16 a[116:119], a[100:103], v[28:31], a[116:119]
    v_fma_f32 v95, v95, s40, -v9
    v_max3_f32 v20, v94, v95, v20
    v_mfma_f32_16x16x32_bf16 a[164:167], a[100:103], v[44:47], a[164:167]
    v_fma_f32 v104, v104, s40, -v10
    v_fma_f32 v105, v105, s40, -v10
    v_max3_f32 v20, v104, v105, v20
    v_mfma_f32_16x16x32_bf16 a[212:215], a[100:103], v[60:63], a[212:215]
    s_waitcnt lgkmcnt(2)
    v_fma_f32 v106, v106, s40, -v10
    v_fma_f32 v107, v107, s40, -v10
    v_mfma_f32_16x16x32_bf16 v[120:123], a[104:107], v[76:79], v[120:123]
    ds_read_b64_tr_b16 a[100:101], v2 offset:4096
    ds_read_b64_tr_b16 a[102:103], v2 offset:6144
    v_mfma_f32_16x16x32_bf16 v[168:171], a[104:107], v[88:91], v[168:171]
    s_add_u32 m0, s45, 7936
    v_max3_f32 v20, v106, v107, v20
    v_fma_f32 v84, v84, s40, -v8
    v_mfma_f32_16x16x32_bf16 v[216:219], a[104:107], v[100:103], v[216:219]
    buffer_load_dwordx4 v7, s[24:27], s43 offen offset:256 nt lds
    v_fma_f32 v85, v85, s40, -v8
    v_max3_f32 v20, v84, v85, v20
    v_mfma_f32_16x16x32_bf16 a[120:123], a[104:107], v[28:31], a[120:123]
    s_add_u32 s43, s43, 12288
    v_fma_f32 v86, v86, s40, -v8
    v_fma_f32 v87, v87, s40, -v8
    v_mfma_f32_16x16x32_bf16 a[168:171], a[104:107], v[44:47], a[168:171]
    s_add_u32 s45, s45, 12288
    v_max3_f32 v20, v86, v87, v20
    v_fma_f32 v96, v96, s40, -v9
    v_mfma_f32_16x16x32_bf16 a[216:219], a[104:107], v[60:63], a[216:219]
    s_waitcnt lgkmcnt(2)
    v_fma_f32 v97, v97, s40, -v9
    v_max3_f32 v20, v96, v97, v20
    v_mfma_f32_16x16x32_bf16 v[124:127], a[96:99], v[76:79], v[124:127]
    s_cmp_eq_u32 s45, s50
    ds_read_b64_tr_b16 a[104:105], v3 offset:4096
    ds_read_b64_tr_b16 a[106:107], v3 offset:6144
    v_mfma_f32_16x16x32_bf16 v[172:175], a[96:99], v[88:91], v[172:175]
    s_cselect_b32 s45, s52, s45
    v_fma_f32 v98, v98, s40, -v9
    v_fma_f32 v99, v99, s40, -v9
    v_max3_f32 v20, v98, v99, v20
    v_mfma_f32_16x16x32_bf16 v[220:223], a[96:99], v[100:103], v[220:223]
    v_fma_f32 v108, v108, s40, -v10
    v_fma_f32 v109, v109, s40, -v10
    v_mfma_f32_16x16x32_bf16 a[124:127], a[96:99], v[28:31], a[124:127]
    v_max3_f32 v20, v108, v109, v20
    v_fma_f32 v110, v110, s40, -v10
    v_mfma_f32_16x16x32_bf16 a[172:175], a[96:99], v[44:47], a[172:175]
    v_fma_f32 v111, v111, s40, -v10
    v_max3_f32 v20, v110, v111, v20
    v_cmp_lt_f32 vcc, s41, v20
    v_mfma_f32_16x16x32_bf16 a[220:223], a[96:99], v[60:63], a[220:223]
    s_waitcnt lgkmcnt(2)
    v_xor_b32 v0, 0x6000, v0
    v_xor_b32 v1, 0x6000, v1
    v_mfma_f32_16x16x32_bf16 v[128:131], a[100:103], v[76:79], v[128:131]
    s_cbranch_vccnz S_rare_early1
S_back_early1:
    ds_read_b64_tr_b16 a[96:97], v4 offset:4096
    ds_read_b64_tr_b16 a[98:99], v4 offset:6144
    v_mfma_f32_16x16x32_bf16 v[176:179], a[100:103], v[88:91], v[176:179]
    s_add_u32 m0, s46, 0
    v_exp_f32 v80, v80
    v_mfma_f32_16x16x32_bf16 v[224:227], a[100:103], v[100:103], v[224:227]
    buffer_load_dwordx4 v7, s[28:31], s44 offen offset:0 nt lds
    v_add_f32 v14, v14, v80
    v_mfma_f32_16x16x32_bf16 a[128:131], a[100:103], v[28:31], a[128:131]
    v_exp_f32 v81, v81
    v_mfma_f32_16x16x32_bf16 a[176:179], a[100:103], v[44:47], a[176:179]
    v_exp_f32 v82, v82
    v_mfma_f32_16x16x32_bf16 a[224:227], a[100:103], v[60:63], a[224:227]
    s_waitcnt lgkmcnt(2)
    v_exp_f32 v83, v83
    v_mfma_f32_16x16x32_bf16 v[132:135], a[104:107], v[76:79], v[132:135]
    ds_read_b64_tr_b16 a[100:101], v5 offset:4096
    ds_read_b64_tr_b16 a[102:103], v5 offset:6144
    v_mfma_f32_16x16x32_bf16 v[180:183], a[104:107], v[88:91], v[180:183]
    v_exp_f32 v84, v84
    v_mfma_f32_16x16x32_bf16 v[228:231], a[104:107], v[100:103], v[228:231]
    v_exp_f32 v85, v85
    v_add_f32 v14, v14, v81
    v_mfma_f32_16x16x32_bf16 a[132:135], a[104:107], v[28:31], a[132:135]
    v_exp_f32 v86, v86
    v_mfma_f32_16x16x32_bf16 a[180:183], a[104:107], v[44:47], a[180:183]
    v_exp_f32 v87, v87
    v_mfma_f32_16x16x32_bf16 a[228:231], a[104:107], v[60:63], a[228:231]
    s_waitcnt lgkmcnt(2)
    v_exp_f32 v92, v92
    v_mfma_f32_16x16x32_bf16 v[136:139], a[96:99], v[76:79], v[136:139]
    ds_read_b64_tr_b16 a[104:105], v2 offset:8192
    ds_read_b64_tr_b16 a[106:107], v2 offset:10240
    v_mfma_f32_16x16x32_bf16 v[184:187], a[96:99], v[88:91], v[184:187]
    s_add_u32 m0, s46, 3968
    v_exp_f32 v93, v93
    v_mfma_f32_16x16x32_bf16 v[232:235], a[96:99], v[100:103], v[232:235]
    buffer_load_dwordx4 v7, s[28:31], s44 offen offset:128 nt lds
    v_exp_f32 v94, v94
    v_mfma_f32_16x16x32_bf16 a[136:139], a[96:99], v[28:31], a[136:139]
    v_exp_f32 v95, v95
    v_mfma_f32_16x16x32_bf16 a[184:187], a[96:99], v[44:47], a[184:187]
    v_exp_f32 v96, v96
    v_mfma_f32_16x16x32_bf16 a[232:235], a[96:99], v[60:63], a[232:235]
    s_waitcnt lgkmcnt(2)
    v_exp_f32 v97, v97
    v_mfma_f32_16x16x32_bf16 v[140:143], a[100:103], v[76:79], v[140:143]
    ds_read_b64_tr_b16 a[96:97], v3 offset:8192
    ds_read_b64_tr_b16 a[98:99], v3 offset:10240
    v_mfma_f32_16x16x32_bf16 v[188:191], a[100:103], v[88:91], v[188:191]
    v_exp_f32 v98, v98
    v_mfma_f32_16x16x32_bf16 v[236:239], a[100:103], v[100:103], v[236:239]
    v_exp_f32 v99, v99
    v_mfma_f32_16x16x32_bf16 a[140:143], a[100:103], v[28:31], a[140:143]
    v_exp_f32 v104, v104
    v_cvt_pk_bf16_f32 v80, v80, v81
    v_mfma_f32_16x16x32_bf16 a[188:191], a[100:103], v[44:47], a[188:191]
    v_exp_f32 v105, v105
    v_mfma_f32_16x16x32_bf16 a[236:239], a[100:103], v[60:63], a[236:239]
    s_waitcnt lgkmcnt(2)
    v_add_f32 v14, v14, v82
    v_add_f32 v14, v14, v83
    v_mfma_f32_16x16x32_bf16 v[144:147], a[104:107], v[76:79], v[144:147]
    ds_read_b64_tr_b16 a[100:101], v4 offset:8192
    ds_read_b64_tr_b16 a[102:103], v4 offset:10240
    v_mfma_f32_16x16x32_bf16 v[192:195], a[104:107], v[88:91], v[192:195]
    s_add_u32 m0, s46, 7936
    v_cvt_pk_bf16_f32 v81, v82, v83
    v_add_f32 v14, v14, v84
    v_mfma_f32_16x16x32_bf16 v[240:243], a[104:107], v[100:103], v[240:243]
    buffer_load_dwordx4 v7, s[28:31], s44 offen offset:256 nt lds
    v_add_f32 v14, v14, v85
    v_mfma_f32_16x16x32_bf16 a[144:147], a[104:107], v[28:31], a[144:147]
    s_add_u32 s44, s44, 12288
    v_exp_f32 v106, v106
    v_cvt_pk_bf16_f32 v82, v84, v85
    v_mfma_f32_16x16x32_bf16 a[192:195], a[104:107], v[44:47], a[192:195]
    s_add_u32 s46, s46, 12288
    v_add_f32 v14, v14, v86
    v_add_f32 v14, v14, v87
    v_mfma_f32_16x16x32_bf16 a[240:243], a[104:107], v[60:63], a[240:243]
    s_waitcnt lgkmcnt(2)
    v_exp_f32 v107, v107
    v_mfma_f32_16x16x32_bf16 v[148:151], a[96:99], v[76:79], v[148:151]
    s_cmp_eq_u32 s46, s51
    ds_read_b64_tr_b16 a[104:105], v5 offset:8192
    ds_read_b64_tr_b16 a[106:107], v5 offset:10240
    v_mfma_f32_16x16x32_bf16 v[196:199], a[96:99], v[88:91], v[196:199]
    s_cselect_b32 s46, s53, s46
    v_exp_f32 v108, v108
    v_mfma_f32_16x16x32_bf16 v[244:247], a[96:99], v[100:103], v[244:247]
    v_exp_f32 v109, v109
    v_mfma_f32_16x16x32_bf16 a[148:151], a[96:99], v[28:31], a[148:151]
    v_exp_f32 v110, v110
    v_mfma_f32_16x16x32_bf16 a[196:199], a[96:99], v[44:47], a[196:199]
    v_exp_f32 v111, v111
    v_cvt_pk_bf16_f32 v83, v86, v87
    v_mfma_f32_16x16x32_bf16 a[244:247], a[96:99], v[60:63], a[244:247]
    s_waitcnt lgkmcnt(2)
    v_add_f32 v15, v15, v92
    v_add_f32 v15, v15, v93
    v_mfma_f32_16x16x32_bf16 v[152:155], a[100:103], v[76:79], v[152:155]
    ds_read_b128 a[96:99], v0 offset:0
    ds_read_b128 a[108:111], v6 offset:0
    v_mfma_f32_16x16x32_bf16 v[200:203], a[100:103], v[88:91], v[200:203]
    v_cvt_pk_bf16_f32 v92, v92, v93
    v_add_f32 v15, v15, v94
    v_mfma_f32_16x16x32_bf16 v[248:251], a[100:103], v[100:103], v[248:251]
    v_add_f32 v15, v15, v95
    v_cvt_pk_bf16_f32 v93, v94, v95
    v_mfma_f32_16x16x32_bf16 a[152:155], a[100:103], v[28:31], a[152:155]
    v_add_f32 v15, v15, v96
    v_add_f32 v15, v15, v97
    v_mfma_f32_16x16x32_bf16 a[200:203], a[100:103], v[44:47], a[200:203]
    v_cvt_pk_bf16_f32 v94, v96, v97
    v_add_f32 v15, v15, v98
    v_add_f32 v15, v15, v99
    v_mfma_f32_16x16x32_bf16 a[248:251], a[100:103], v[60:63], a[248:251]
    s_waitcnt lgkmcnt(2)
    v_cvt_pk_bf16_f32 v95, v98, v99
    v_add_f32 v16, v16, v104
    v_mfma_f32_16x16x32_bf16 v[156:159], a[104:107], v[76:79], v[156:159]
    s_add_u32 s42, s42, 1
    ds_read_b128 a[100:103], v0 offset:2048
    ds_read_b128 v[24:27], v6 offset:6528
    v_mfma_f32_16x16x32_bf16 v[204:207], a[104:107], v[88:91], v[204:207]
    s_cmp_eq_u32 s42, 8
    v_add_f32 v16, v16, v105
    v_cvt_pk_bf16_f32 v104, v104, v105
    v_mfma_f32_16x16x32_bf16 v[252:255], a[104:107], v[100:103], v[252:255]
    v_add_f32 v16, v16, v106
    v_add_f32 v16, v16, v107
    v_mfma_f32_16x16x32_bf16 a[156:159], a[104:107], v[28:31], a[156:159]
    v_cvt_pk_bf16_f32 v105, v106, v107
    v_add_f32 v16, v16, v108
    v_mfma_f32_16x16x32_bf16 a[204:207], a[104:107], v[44:47], a[204:207]
    v_add_f32 v16, v16, v109
    v_cvt_pk_bf16_f32 v106, v108, v109
    v_mfma_f32_16x16x32_bf16 a[252:255], a[104:107], v[60:63], a[252:255]
    s_waitcnt lgkmcnt(3)
    v_add_f32 v16, v16, v110
    v_add_f32 v16, v16, v111
    v_cvt_pk_bf16_f32 v107, v110, v111
    s_cbranch_scc1 S_tail
    v_mfma_f32_16x16x32_bf16 v[76:79], a[96:99], a[0:3], 0
    ds_read_b128 a[104:107], v1 offset:0
    v_fma_f32 v32, v32, s40, -v11
    v_mfma_f32_16x16x32_bf16 v[88:91], a[96:99], a[24:27], 0
    v_fma_f32 v33, v33, s40, -v11
    v_max_f32 v20, v32, v33
    v_mfma_f32_16x16x32_bf16 v[100:103], a[96:99], a[48:51], 0
    v_fma_f32 v34, v34, s40, -v11
    v_fma_f32 v35, v35, s40, -v11
    v_mfma_f32_16x16x32_bf16 v[28:31], a[96:99], a[72:75], 0
    s_waitcnt lgkmcnt(3)
    v_max3_f32 v20, v34, v35, v20
    v_fma_f32 v48, v48, s40, -v12
    v_mfma_f32_16x16x32_bf16 v[44:47], a[96:99], a[108:111], 0
    s_waitcnt lgkmcnt(1)
    v_fma_f32 v49, v49, s40, -v12
    v_max3_f32 v20, v48, v49, v20
    v_mfma_f32_16x16x32_bf16 v[60:63], a[96:99], v[24:27], 0
    v_fma_f32 v50, v50, s40, -v12
    v_fma_f32 v51, v51, s40, -v12
    v_mfma_f32_16x16x32_bf16 v[68:71], a[100:103], v[24:27], 0
    ds_read_b128 a[96:99], v1 offset:2048
    ds_read_b128 v[24:27], v6 offset:7616
    v_mfma_f32_16x16x32_bf16 v[52:55], a[100:103], a[108:111], 0
    v_max3_f32 v20, v50, v51, v20
    v_fma_f32 v64, v64, s40, -v13
    v_mfma_f32_16x16x32_bf16 v[36:39], a[100:103], a[72:75], 0
    ds_read_b128 a[108:111], v6 offset:1088
    v_fma_f32 v65, v65, s40, -v13
    v_mfma_f32_16x16x32_bf16 v[108:111], a[100:103], a[48:51], 0
    v_max3_f32 v20, v64, v65, v20
    v_fma_f32 v66, v66, s40, -v13
    v_mfma_f32_16x16x32_bf16 v[96:99], a[100:103], a[24:27], 0
    v_fma_f32 v67, v67, s40, -v13
    v_max3_f32 v20, v66, v67, v20
    v_mfma_f32_16x16x32_bf16 v[84:87], a[100:103], a[0:3], 0
    s_waitcnt lgkmcnt(3)
    v_fma_f32 v40, v40, s40, -v11
    v_fma_f32 v41, v41, s40, -v11
    v_mfma_f32_16x16x32_bf16 v[76:79], a[104:107], a[4:7], v[76:79]
    ds_read_b128 a[100:103], v0 offset:4096
    v_max3_f32 v20, v40, v41, v20
    v_mfma_f32_16x16x32_bf16 v[88:91], a[104:107], a[28:31], v[88:91]
    v_fma_f32 v42, v42, s40, -v11
    v_fma_f32 v43, v43, s40, -v11
    v_mfma_f32_16x16x32_bf16 v[100:103], a[104:107], a[52:55], v[100:103]
    v_max3_f32 v20, v42, v43, v20
    v_fma_f32 v56, v56, s40, -v12
    v_mfma_f32_16x16x32_bf16 v[28:31], a[104:107], a[76:79], v[28:31]
    s_waitcnt lgkmcnt(1)
    v_fma_f32 v57, v57, s40, -v12
    v_max3_f32 v20, v56, v57, v20
    v_mfma_f32_16x16x32_bf16 v[44:47], a[104:107], a[108:111], v[44:47]
    v_fma_f32 v58, v58, s40, -v12
    v_fma_f32 v59, v59, s40, -v12
    v_mfma_f32_16x16x32_bf16 v[60:63], a[104:107], v[24:27], v[60:63]
    v_max3_f32 v20, v58, v59, v20
    v_fma_f32 v72, v72, s40, -v13
    v_mfma_f32_16x16x32_bf16 v[68:71], a[96:99], v[24:27], v[68:71]
    ds_read_b128 a[104:107], v0 offset:6144
    ds_read_b128 v[24:27], v6 offset:8704
    v_mfma_f32_16x16x32_bf16 v[52:55], a[96:99], a[108:111], v[52:55]
    v_fma_f32 v73, v73, s40, -v13
    v_max3_f32 v20, v72, v73, v20
    v_mfma_f32_16x16x32_bf16 v[36:39], a[96:99], a[76:79], v[36:39]
    ds_read_b128 a[108:111], v6 offset:2176
    v_fma_f32 v74, v74, s40, -v13
    v_mfma_f32_16x16x32_bf16 v[108:111], a[96:99], a[52:55], v[108:111]
    v_fma_f32 v75, v75, s40, -v13
    v_max3_f32 v20, v74, v75, v20
    v_mfma_f32_16x16x32_bf16 v[96:99], a[96:99], a[28:31], v[96:99]
    v_cmp_lt_f32 vcc, s41, v20
    v_mfma_f32_16x16x32_bf16 v[84:87], a[96:99], a[4:7], v[84:87]
    s_waitcnt lgkmcnt(3)
    v_mfma_f32_16x16x32_bf16 v[76:79], a[100:103], a[8:11], v[76:79]
    s_cbranch_vccnz S_rare_late1
S_back_late1:
    ds_read_b128 a[96:99], v1 offset:4096
    v_mfma_f32_16x16x32_bf16 v[88:91], a[100:103], a[32:35], v[88:91]
    v_exp_f32 v32, v32
    v_mfma_f32_16x16x32_bf16 v[100:103], a[100:103], a[56:59], v[100:103]
    v_exp_f32 v33, v33
    v_mfma_f32_16x16x32_bf16 v[28:31], a[100:103], a[80:83], v[28:31]
    s_waitcnt lgkmcnt(1)
    v_exp_f32 v34, v34
    v_mfma_f32_16x16x32_bf16 v[44:47], a[100:103], a[108:111], v[44:47]
    v_exp_f32 v35, v35
    v_mfma_f32_16x16x32_bf16 v[60:63], a[100:103], v[24:27], v[60:63]
    v_exp_f32 v40, v40
    v_mfma_f32_16x16x32_bf16 v[68:71], a[104:107], v[24:27], v[68:71]
    ds_read_b128 a[100:103], v1 offset:6144
    ds_read_b128 v[24:27], v6 offset:9792
    v_mfma_f32_16x16x32_bf16 v[52:55], a[104:107], a[108:111], v[52:55]
    v_exp_f32 v41, v41
    v_mfma_f32_16x16x32_bf16 v[36:39], a[104:107], a[80:83], v[36:39]
    ds_read_b128 a[108:111], v6 offset:3264
    v_add_f32 v17, v17, v32
    v_mfma_f32_16x16x32_bf16 v[108:111], a[104:107], a[56:59], v[108:111]
    v_exp_f32 v42, v42
    v_mfma_f32_16x16x32_bf16 v[96:99], a[104:107], a[32:35], v[96:99]
    v_exp_f32 v43, v43
    v_mfma_f32_16x16x32_bf16 v[84:87], a[104:107], a[8:11], v[84:87]
    s_waitcnt lgkmcnt(3)
    v_exp_f32 v48, v48
    v_mfma_f32_16x16x32_bf16 v[76:79], a[96:99], a[12:15], v[76:79]
    ds_read_b128 a[104:107], v0 offset:8192
    v_add_f32 v17, v17, v33
    v_mfma_f32_16x16x32_bf16 v[88:91], a[96:99], a[36:39], v[88:91]
    v_exp_f32 v49, v49
    v_mfma_f32_16x16x32_bf16 v[100:103], a[96:99], a[60:63], v[100:103]
    v_exp_f32 v50, v50
    v_mfma_f32_16x16x32_bf16 v[28:31], a[96:99], a[84:87], v[28:31]
    s_waitcnt lgkmcnt(1)
    v_exp_f32 v51, v51
    v_mfma_f32_16x16x32_bf16 v[44:47], a[96:99], a[108:111], v[44:47]
    v_exp_f32 v56, v56
    v_cvt_pk_bf16_f32 v32, v32, v33
    v_mfma_f32_16x16x32_bf16 v[60:63], a[96:99], v[24:27], v[60:63]
    v_exp_f32 v57, v57
    v_mfma_f32_16x16x32_bf16 v[68:71], a[100:103], v[24:27], v[68:71]
    ds_read_b128 a[96:99], v0 offset:10240
    ds_read_b128 v[24:27], v6 offset:10880
    v_mfma_f32_16x16x32_bf16 v[52:55], a[100:103], a[108:111], v[52:55]
    v_exp_f32 v58, v58
    v_mfma_f32_16x16x32_bf16 v[36:39], a[100:103], a[84:87], v[36:39]
    ds_read_b128 a[108:111], v6 offset:4352
    v_add_f32 v17, v17, v34
    v_mfma_f32_16x16x32_bf16 v[108:111], a[100:103], a[60:63], v[108:111]
    v_exp_f32 v59, v59
    v_mfma_f32_16x16x32_bf16 v[96:99], a[100:103], a[36:39], v[96:99]
    v_exp_f32 v64, v64
    v_mfma_f32_16x16x32_bf16 v[84:87], a[100:103], a[12:15], v[84:87]
    s_waitcnt lgkmcnt(3)
    v_exp_f32 v65, v65
    v_mfma_f32_16x16x32_bf16 v[76:79], a[104:107], a[16:19], v[76:79]
    ds_read_b128 a[100:103], v1 offset:8192
    v_add_f32 v17, v17, v35
    v_mfma_f32_16x16x32_bf16 v[88:91], a[104:107], a[40:43], v[88:91]
    v_cvt_pk_bf16_f32 v33, v34, v35
    v_add_f32 v17, v17, v40
    v_mfma_f32_16x16x32_bf16 v[100:103], a[104:107], a[64:67], v[100:103]
    v_add_f32 v17, v17, v41
    v_cvt_pk_bf16_f32 v34, v40, v41
    v_mfma_f32_16x16x32_bf16 v[28:31], a[104:107], a[88:91], v[28:31]
    s_waitcnt lgkmcnt(1)
    v_add_f32 v17, v17, v42
    v_add_f32 v17, v17, v43
    v_mfma_f32_16x16x32_bf16 v[44:47], a[104:107], a[108:111], v[44:47]
    v_exp_f32 v66, v66
    v_mfma_f32_16x16x32_bf16 v[60:63], a[104:107], v[24:27], v[60:63]
    v_exp_f32 v67, v67
    v_mfma_f32_16x16x32_bf16 v[68:71], a[96:99], v[24:27], v[68:71]
    ds_read_b128 a[104:107], v1 offset:10240
    ds_read_b128 v[24:27], v6 offset:11968
    v_mfma_f32_16x16x32_bf16 v[52:55], a[96:99], a[108:111], v[52:55]
    s_waitcnt vmcnt(9)
    v_exp_f32 v72, v72
    v_mfma_f32_16x16x32_bf16 v[36:39], a[96:99], a[88:91], v[36:39]
    s_barrier
    ds_read_b128 a[108:111], v6 offset:5440
    v_cvt_pk_bf16_f32 v35, v42, v43
    v_mfma_f32_16x16x32_bf16 v[108:111], a[96:99], a[64:67], v[108:111]
    v_exp_f32 v73, v73
    v_mfma_f32_16x16x32_bf16 v[96:99], a[96:99], a[40:43], v[96:99]
    v_exp_f32 v74, v74
    v_mfma_f32_16x16x32_bf16 v[84:87], a[96:99], a[16:19], v[84:87]
    s_waitcnt lgkmcnt(3)
    v_exp_f32 v75, v75
    v_mfma_f32_16x16x32_bf16 v[76:79], a[100:103], a[20:23], v[76:79]
    ds_read_b64_tr_b16 a[96:97], v2 offset:12288
    ds_read_b64_tr_b16 a[98:99], v2 offset:14336
    v_mfma_f32_16x16x32_bf16 v[88:91], a[100:103], a[44:47], v[88:91]
    s_add_u32 m0, s45, 0
    v_add_f32 v18, v18, v48
    v_add_f32 v18, v18, v49
    v_mfma_f32_16x16x32_bf16 v[100:103], a[100:103], a[68:71], v[100:103]
    buffer_load_dwordx4 v7, s[24:27], s43 offen offset:0 nt lds
    v_cvt_pk_bf16_f32 v48, v48, v49
    v_mfma_f32_16x16x32_bf16 v[28:31], a[100:103], a[92:95], v[28:31]
    s_waitcnt lgkmcnt(2)
    v_add_f32 v18, v18, v50
    v_add_f32 v18, v18, v51
    v_mfma_f32_16x16x32_bf16 v[44:47], a[100:103], a[108:111], v[44:47]
    v_cvt_pk_bf16_f32 v49, v50, v51
    v_add_f32 v18, v18, v56
    v_mfma_f32_16x16x32_bf16 v[60:63], a[100:103], v[24:27], v[60:63]
    v_add_f32 v18, v18, v57
    v_cvt_pk_bf16_f32 v50, v56, v57
    v_mfma_f32_16x16x32_bf16 v[84:87], a[104:107], a[20:23], v[84:87]
    ds_read_b64_tr_b16 a[100:101], v3 offset:12288
    ds_read_b64_tr_b16 a[102:103], v3 offset:14336
    v_mfma_f32_16x16x32_bf16 v[96:99], a[104:107], a[44:47], v[96:99]
    v_add_f32 v18, v18, v58
    v_add_f32 v18, v18, v59
    v_mfma_f32_16x16x32_bf16 v[108:111], a[104:107], a[68:71], v[108:111]
    v_cvt_pk_bf16_f32 v51, v58, v59
    v_add_f32 v19, v19, v64
    v_mfma_f32_16x16x32_bf16 v[36:39], a[104:107], a[92:95], v[36:39]
    v_add_f32 v19, v19, v65
    v_cvt_pk_bf16_f32 v64, v64, v65
    v_mfma_f32_16x16x32_bf16 v[52:55], a[104:107], a[108:111], v[52:55]
    v_add_f32 v19, v19, v66
    v_add_f32 v19, v19, v67
    v_mfma_f32_16x16x32_bf16 v[68:71], a[104:107], v[24:27], v[68:71]
    s_waitcnt lgkmcnt(2)
    v_cvt_pk_bf16_f32 v65, v66, v67
    v_add_f32 v19, v19, v72
    v_mfma_f32_16x16x32_bf16 v[112:115], a[96:99], v[80:83], v[112:115]
    ds_read_b64_tr_b16 a[104:105], v4 offset:12288
    ds_read_b64_tr_b16 a[106:107], v4 offset:14336
    v_mfma_f32_16x16x32_bf16 v[160:163], a[96:99], v[92:95], v[160:163]
    s_add_u32 m0, s45, 3968
    v_add_f32 v19, v19, v73
    v_cvt_pk_bf16_f32 v66, v72, v73
    v_add_f32 v19, v19, v74
    v_mfma_f32_16x16x32_bf16 v[208:211], a[96:99], v[104:107], v[208:211]
    buffer_load_dwordx4 v7, s[24:27], s43 offen offset:128 nt lds
    v_add_f32 v19, v19, v75
    v_mfma_f32_16x16x32_bf16 a[112:115], a[96:99], v[32:35], a[112:115]
    v_cvt_pk_bf16_f32 v67, v74, v75
    v_fma_f32 v76, v76, s40, -v8
    v_mfma_f32_16x16x32_bf16 a[160:163], a[96:99], v[48:51], a[160:163]
    v_fma_f32 v77, v77, s40, -v8
    v_max_f32 v20, v76, v77
    v_mfma_f32_16x16x32_bf16 a[208:211], a[96:99], v[64:67], a[208:211]
    s_waitcnt lgkmcnt(2)
    v_fma_f32 v78, v78, s40, -v8
    v_fma_f32 v79, v79, s40, -v8
    v_max3_f32 v20, v78, v79, v20
    v_mfma_f32_16x16x32_bf16 v[116:119], a[100:103], v[80:83], v[116:119]
    ds_read_b64_tr_b16 a[96:97], v5 offset:12288
    ds_read_b64_tr_b16 a[98:99], v5 offset:14336
    v_mfma_f32_16x16x32_bf16 v[164:167], a[100:103], v[92:95], v[164:167]
    v_fma_f32 v88, v88, s40, -v9
    v_fma_f32 v89, v89, s40, -v9
    v_mfma_f32_16x16x32_bf16 v[212:215], a[100:103], v[104:107], v[212:215]
    v_max3_f32 v20, v88, v89, v20
    v_fma_f32 v90, v90, s40, -v9
    v_mfma_f32_16x16x32_bf16 a[116:119], a[100:103], v[32:35], a[116:119]
    v_fma_f32 v91, v91, s40, -v9
    v_max3_f32 v20, v90, v91, v20
    v_mfma_f32_16x16x32_bf16 a[164:167], a[100:103], v[48:51], a[164:167]
    v_fma_f32 v100, v100, s40, -v10
    v_fma_f32 v101, v101, s40, -v10
    v_max3_f32 v20, v100, v101, v20
    v_mfma_f32_16x16x32_bf16 a[212:215], a[100:103], v[64:67], a[212:215]
    s_waitcnt lgkmcnt(2)
    v_fma_f32 v102, v102, s40, -v10
    v_fma_f32 v103, v103, s40, -v10
    v_mfma_f32_16x16x32_bf16 v[120:123], a[104:107], v[80:83], v[120:123]
    ds_read_b64_tr_b16 a[100:101], v2 offset:16384
    ds_read_b64_tr_b16 a[102:103], v2 offset:18432
    v_mfma_f32_16x16x32_bf16 v[168:171], a[104:107], v[92:95], v[168:171]
    s_add_u32 m0, s45, 7936
    v_max3_f32 v20, v102, v103, v20
    v_fma_f32 v84, v84, s40, -v8
    v_mfma_f32_16x16x32_bf16 v[216:219], a[104:107], v[104:107], v[216:219]
    buffer_load_dwordx4 v7, s[24:27], s43 offen offset:256 nt lds
    v_fma_f32 v85, v85, s40, -v8
    v_max3_f32 v20, v84, v85, v20
    v_mfma_f32_16x16x32_bf16 a[120:123], a[104:107], v[32:35], a[120:123]
    s_add_u32 s43, s43, 12288
    v_fma_f32 v86, v86, s40, -v8
    v_fma_f32 v87, v87, s40, -v8
    v_mfma_f32_16x16x32_bf16 a[168:171], a[104:107], v[48:51], a[168:171]
    s_add_u32 s45, s45, 12288
    v_max3_f32 v20, v86, v87, v20
    v_fma_f32 v96, v96, s40, -v9
    v_mfma_f32_16x16x32_bf16 a[216:219], a[104:107], v[64:67], a[216:219]
    s_waitcnt lgkmcnt(2)
    v_fma_f32 v97, v97, s40, -v9
    v_max3_f32 v20, v96, v97, v20
    v_mfma_f32_16x16x32_bf16 v[124:127], a[96:99], v[80:83], v[124:127]
    s_cmp_eq_u32 s45, s50
    ds_read_b64_tr_b16 a[104:105], v3 offset:16384
    ds_read_b64_tr_b16 a[106:107], v3 offset:18432
    v_mfma_f32_16x16x32_bf16 v[172:175], a[96:99], v[92:95], v[172:175]
    s_cselect_b32 s45, s52, s45
    v_fma_f32 v98, v98, s40, -v9
    v_fma_f32 v99, v99, s40, -v9
    v_max3_f32 v20, v98, v99, v20
    v_mfma_f32_16x16x32_bf16 v[220:223], a[96:99], v[104:107], v[220:223]
    v_fma_f32 v108, v108, s40, -v10
    v_fma_f32 v109, v109, s40, -v10
    v_mfma_f32_16x16x32_bf16 a[124:127], a[96:99], v[32:35], a[124:127]
    v_max3_f32 v20, v108, v109, v20
    v_fma_f32 v110, v110, s40, -v10
    v_mfma_f32_16x16x32_bf16 a[172:175], a[96:99], v[48:51], a[172:175]
    v_fma_f32 v111, v111, s40, -v10
    v_max3_f32 v20, v110, v111, v20
    v_cmp_lt_f32 vcc, s41, v20
    v_mfma_f32_16x16x32_bf16 a[220:223], a[96:99], v[64:67], a[220:223]
    s_waitcnt lgkmcnt(2)
    v_mfma_f32_16x16x32_bf16 v[128:131], a[100:103], v[80:83], v[128:131]
    s_cbranch_vccnz S_rare_early0
S_back_early0:
    ds_read_b64_tr_b16 a[96:97], v4 offset:16384
    ds_read_b64_tr_b16 a[98:99], v4 offset:18432
    v_mfma_f32_16x16x32_bf16 v[176:179], a[100:103], v[92:95], v[176:179]
    s_add_u32 m0, s46, 0
    v_exp_f32 v76, v76
    v_mfma_f32_16x16x32_bf16 v[224:227], a[100:103], v[104:107], v[224:227]
    buffer_load_dwordx4 v7, s[28:31], s44 offen offset:0 nt lds
    v_add_f32 v14, v14, v76
    v_mfma_f32_16x16x32_bf16 a[128:131], a[100:103], v[32:35], a[128:131]
    v_exp_f32 v77, v77
    v_mfma_f32_16x16x32_bf16 a[176:179], a[100:103], v[48:51], a[176:179]
    v_exp_f32 v78, v78
    v_mfma_f32_16x16x32_bf16 a[224:227], a[100:103], v[64:67], a[224:227]
    s_waitcnt lgkmcnt(2)
    v_exp_f32 v79, v79
    v_mfma_f32_16x16x32_bf16 v[132:135], a[104:107], v[80:83], v[132:135]
    ds_read_b64_tr_b16 a[100:101], v5 offset:16384
    ds_read_b64_tr_b16 a[102:103], v5 offset:18432
    v_mfma_f32_16x16x32_bf16 v[180:183], a[104:107], v[92:95], v[180:183]
    v_exp_f32 v84, v84
    v_mfma_f32_16x16x32_bf16 v[228:231], a[104:107], v[104:107], v[228:231]
    v_exp_f32 v85, v85
    v_add_f32 v14, v14, v77
    v_mfma_f32_16x16x32_bf16 a[132:135], a[104:107], v[32:35], a[132:135]
    v_exp_f32 v86, v86
    v_mfma_f32_16x16x32_bf16 a[180:183], a[104:107], v[48:51], a[180:183]
    v_exp_f32 v87, v87
    v_mfma_f32_16x16x32_bf16 a[228:231], a[104:107], v[64:67], a[228:231]
    s_waitcnt lgkmcnt(2)
    v_exp_f32 v88, v88
    v_mfma_f32_16x16x32_bf16 v[136:139], a[96:99], v[80:83], v[136:139]
    ds_read_b64_tr_b16 a[104:105], v2 offset:20480
    ds_read_b64_tr_b16 a[106:107], v2 offset:22528
    v_mfma_f32_16x16x32_bf16 v[184:187], a[96:99], v[92:95], v[184:187]
    s_add_u32 m0, s46, 3968
    v_exp_f32 v89, v89
    v_mfma_f32_16x16x32_bf16 v[232:235], a[96:99], v[104:107], v[232:235]
    buffer_load_dwordx4 v7, s[28:31], s44 offen offset:128 nt lds
    v_exp_f32 v90, v90
    v_mfma_f32_16x16x32_bf16 a[136:139], a[96:99], v[32:35], a[136:139]
    v_exp_f32 v91, v91
    v_mfma_f32_16x16x32_bf16 a[184:187], a[96:99], v[48:51], a[184:187]
    v_exp_f32 v96, v96
    v_mfma_f32_16x16x32_bf16 a[232:235], a[96:99], v[64:67], a[232:235]
    s_waitcnt lgkmcnt(2)
    v_exp_f32 v97, v97
    v_mfma_f32_16x16x32_bf16 v[140:143], a[100:103], v[80:83], v[140:143]
    ds_read_b64_tr_b16 a[96:97], v3 offset:20480
    ds_read_b64_tr_b16 a[98:99], v3 offset:22528
    v_mfma_f32_16x16x32_bf16 v[188:191], a[100:103], v[92:95], v[188:191]
    v_exp_f32 v98, v98
    v_mfma_f32_16x16x32_bf16 v[236:239], a[100:103], v[104:107], v[236:239]
    v_exp_f32 v99, v99
    v_mfma_f32_16x16x32_bf16 a[140:143], a[100:103], v[32:35], a[140:143]
    v_exp_f32 v100, v100
    v_cvt_pk_bf16_f32 v76, v76, v77
    v_mfma_f32_16x16x32_bf16 a[188:191], a[100:103], v[48:51], a[188:191]
    v_exp_f32 v101, v101
    v_mfma_f32_16x16x32_bf16 a[236:239], a[100:103], v[64:67], a[236:239]
    s_waitcnt lgkmcnt(2)
    v_add_f32 v14, v14, v78
    v_add_f32 v14, v14, v79
    v_mfma_f32_16x16x32_bf16 v[144:147], a[104:107], v[80:83], v[144:147]
    ds_read_b64_tr_b16 a[100:101], v4 offset:20480
    ds_read_b64_tr_b16 a[102:103], v4 offset:22528
    v_mfma_f32_16x16x32_bf16 v[192:195], a[104:107], v[92:95], v[192:195]
    s_add_u32 m0, s46, 7936
    v_cvt_pk_bf16_f32 v77, v78, v79
    v_add_f32 v14, v14, v84
    v_mfma_f32_16x16x32_bf16 v[240:243], a[104:107], v[104:107], v[240:243]
    buffer_load_dwordx4 v7, s[28:31], s44 offen offset:256 nt lds
    v_add_f32 v14, v14, v85
    v_mfma_f32_16x16x32_bf16 a[144:147], a[104:107], v[32:35], a[144:147]
    s_add_u32 s44, s44, 12288
    v_exp_f32 v102, v102
    v_cvt_pk_bf16_f32 v78, v84, v85
    v_mfma_f32_16x16x32_bf16 a[192:195], a[104:107], v[48:51], a[192:195]
    s_add_u32 s46, s46, 12288
    v_add_f32 v14, v14, v86
    v_add_f32 v14, v14, v87
    v_mfma_f32_16x16x32_bf16 a[240:243], a[104:107], v[64:67], a[240:243]
    s_waitcnt lgkmcnt(2)
    v_exp_f32 v103, v103
    v_mfma_f32_16x16x32_bf16 v[148:151], a[96:99], v[80:83], v[148:151]
    s_cmp_eq_u32 s46, s51
    ds_read_b64_tr_b16 a[104:105], v5 offset:20480
    ds_read_b64_tr_b16 a[106:107], v5 offset:22528
    v_mfma_f32_16x16x32_bf16 v[196:199], a[96:99], v[92:95], v[196:199]
    s_cselect_b32 s46, s53, s46
    v_exp_f32 v108, v108
    v_mfma_f32_16x16x32_bf16 v[244:247], a[96:99], v[104:107], v[244:247]
    v_exp_f32 v109, v109
    v_mfma_f32_16x16x32_bf16 a[148:151], a[96:99], v[32:35], a[148:151]
    v_exp_f32 v110, v110
    v_mfma_f32_16x16x32_bf16 a[196:199], a[96:99], v[48:51], a[196:199]
    v_exp_f32 v111, v111
    v_cvt_pk_bf16_f32 v79, v86, v87
    v_mfma_f32_16x16x32_bf16 a[244:247], a[96:99], v[64:67], a[244:247]
    s_waitcnt lgkmcnt(2)
    v_add_f32 v15, v15, v88
    v_add_f32 v15, v15, v89
    v_mfma_f32_16x16x32_bf16 v[152:155], a[100:103], v[80:83], v[152:155]
    ds_read_b128 a[96:99], v0 offset:12288
    ds_read_b128 a[108:111], v6 offset:0
    v_mfma_f32_16x16x32_bf16 v[200:203], a[100:103], v[92:95], v[200:203]
    v_cvt_pk_bf16_f32 v88, v88, v89
    v_add_f32 v15, v15, v90
    v_mfma_f32_16x16x32_bf16 v[248:251], a[100:103], v[104:107], v[248:251]
    v_add_f32 v15, v15, v91
    v_cvt_pk_bf16_f32 v89, v90, v91
    v_mfma_f32_16x16x32_bf16 a[152:155], a[100:103], v[32:35], a[152:155]
    v_add_f32 v15, v15, v96
    v_add_f32 v15, v15, v97
    v_mfma_f32_16x16x32_bf16 a[200:203], a[100:103], v[48:51], a[200:203]
    v_cvt_pk_bf16_f32 v90, v96, v97
    v_add_f32 v15, v15, v98
    v_add_f32 v15, v15, v99
    v_mfma_f32_16x16x32_bf16 a[248:251], a[100:103], v[64:67], a[248:251]
    s_waitcnt lgkmcnt(2)
    v_cvt_pk_bf16_f32 v91, v98, v99
    v_add_f32 v16, v16, v100
    v_mfma_f32_16x16x32_bf16 v[156:159], a[104:107], v[80:83], v[156:159]
    ds_read_b128 a[100:103], v0 offset:14336
    ds_read_b128 v[24:27], v6 offset:6528
    v_mfma_f32_16x16x32_bf16 v[204:207], a[104:107], v[92:95], v[204:207]
    v_add_f32 v16, v16, v101
    v_cvt_pk_bf16_f32 v100, v100, v101
    v_mfma_f32_16x16x32_bf16 v[252:255], a[104:107], v[104:107], v[252:255]
    v_add_f32 v16, v16, v102
    v_add_f32 v16, v16, v103
    v_mfma_f32_16x16x32_bf16 a[156:159], a[104:107], v[32:35], a[156:159]
    v_cvt_pk_bf16_f32 v101, v102, v103
    v_add_f32 v16, v16, v108
    v_mfma_f32_16x16x32_bf16 a[204:207], a[104:107], v[48:51], a[204:207]
    v_add_f32 v16, v16, v109
    v_cvt_pk_bf16_f32 v102, v108, v109
    v_mfma_f32_16x16x32_bf16 a[252:255], a[104:107], v[64:67], a[252:255]
    s_waitcnt lgkmcnt(3)
    v_add_f32 v16, v16, v110
    v_add_f32 v16, v16, v111
    v_cvt_pk_bf16_f32 v103, v110, v111
    s_branch S_loop
S_tail:
    s_waitcnt vmcnt(0) lgkmcnt(0)
    s_barrier
    ds_read_b64_tr_b16 a[96:97], v2 offset:12288
    ds_read_b64_tr_b16 a[98:99], v2 offset:14336
    ds_read_b64_tr_b16 a[100:101], v3 offset:12288
    ds_read_b64_tr_b16 a[102:103], v3 offset:14336
    v_fma_f32 v32, v32, s40, -v11
    v_fma_f32 v33, v33, s40, -v11
    v_max_f32 v20, v32, v33
    v_fma_f32 v34, v34, s40, -v11
    v_fma_f32 v35, v35, s40, -v11
    v_max3_f32 v20, v34, v35, v20
    v_fma_f32 v48, v48, s40, -v12
    v_fma_f32 v49, v49, s40, -v12
    v_max3_f32 v20, v48, v49, v20
    v_fma_f32 v50, v50, s40, -v12
    v_fma_f32 v51, v51, s40, -v12
    v_max3_f32 v20, v50, v51, v20
    v_fma_f32 v64, v64, s40, -v13
    v_fma_f32 v65, v65, s40, -v13
    v_max3_f32 v20, v64, v65, v20
    v_fma_f32 v66, v66, s40, -v13
    v_fma_f32 v67, v67, s40, -v13
    v_max3_f32 v20, v66, v67, v20
    v_fma_f32 v40, v40, s40, -v11
    v_fma_f32 v41, v41, s40, -v11
    v_max3_f32 v20, v40, v41, v20
    v_fma_f32 v42, v42, s40, -v11
    v_fma_f32 v43, v43, s40, -v11
    v_max3_f32 v20, v42, v43, v20
    v_fma_f32 v56, v56, s40, -v12
    v_fma_f32 v57, v57, s40, -v12
    v_max3_f32 v20, v56, v57, v20
    v_fma_f32 v58, v58, s40, -v12
    v_fma_f32 v59, v59, s40, -v12
    v_max3_f32 v20, v58, v59, v20
    v_fma_f32 v72, v72, s40, -v13
    v_fma_f32 v73, v73, s40, -v13
    v_max3_f32 v20, v72, v73, v20
    v_fma_f32 v74, v74, s40, -v13
    v_fma_f32 v75, v75, s40, -v13
    v_max3_f32 v20, v74, v75, v20
    v_cmp_lt_f32 vcc, s41, v20
    s_cbranch_vccnz S_rare_tail
S_back_tail:
    v_exp_f32 v32, v32
    v_exp_f32 v33, v33
    v_exp_f32 v34, v34
    v_exp_f32 v35, v35
    v_exp_f32 v40, v40
    v_exp_f32 v41, v41
    v_exp_f32 v42, v42
    v_exp_f32 v43, v43
    v_exp_f32 v48, v48
    v_exp_f32 v49, v49
    v_exp_f32 v50, v50
    v_exp_f32 v51, v51
    v_exp_f32 v56, v56
    v_exp_f32 v57, v57
    v_exp_f32 v58, v58
    v_exp_f32 v59, v59
    v_exp_f32 v64, v64
    v_exp_f32 v65, v65
    v_exp_f32 v66, v66
    v_exp_f32 v67, v67
    v_exp_f32 v72, v72
    v_exp_f32 v73, v73
    v_exp_f32 v74, v74
    v_exp_f32 v75, v75
    s_nop 0
    v_add_f32 v17, v17, v32
    v_add_f32 v17, v17, v33
    v_cvt_pk_bf16_f32 v32, v32, v33
    v_add_f32 v17, v17, v34
    v_add_f32 v17, v17, v35
    v_cvt_pk_bf16_f32 v33, v34, v35
    v_add_f32 v17, v17, v40
    v_add_f32 v17, v17, v41
    v_cvt_pk_bf16_f32 v34, v40, v41
    v_add_f32 v17, v17, v42
    v_add_f32 v17, v17, v43
    v_cvt_pk_bf16_f32 v35, v42, v43
    v_add_f32 v18, v18, v48
    v_add_f32 v18, v18, v49
    v_cvt_pk_bf16_f32 v48, v48, v49
    v_add_f32 v18, v18, v50
    v_add_f32 v18, v18, v51
    v_cvt_pk_bf16_f32 v49, v50, v51
    v_add_f32 v18, v18, v56
    v_add_f32 v18, v18, v57
    v_cvt_pk_bf16_f32 v50, v56, v57
    v_add_f32 v18, v18, v58
    v_add_f32 v18, v18, v59
    v_cvt_pk_bf16_f32 v51, v58, v59
    v_add_f32 v19, v19, v64
    v_add_f32 v19, v19, v65
    v_cvt_pk_bf16_f32 v64, v64, v65
    v_add_f32 v19, v19, v66
    v_add_f32 v19, v19, v67
    v_cvt_pk_bf16_f32 v65, v66, v67
    v_add_f32 v19, v19, v72
    v_add_f32 v19, v19, v73
    v_cvt_pk_bf16_f32 v66, v72, v73
    v_add_f32 v19, v19, v74
    v_add_f32 v19, v19, v75
    v_cvt_pk_bf16_f32 v67, v74, v75
    s_nop 1
    s_waitcnt lgkmcnt(2)
    v_mfma_f32_16x16x32_bf16 v[112:115], a[96:99], v[80:83], v[112:115]
    ds_read_b64_tr_b16 a[104:105], v4 offset:12288
    ds_read_b64_tr_b16 a[106:107], v4 offset:14336
    v_mfma_f32_16x16x32_bf16 v[160:163], a[96:99], v[92:95], v[160:163]
    v_mov_b32 v76, v14
    v_mov_b32 v88, v15
    v_mfma_f32_16x16x32_bf16 v[208:211], a[96:99], v[104:107], v[208:211]
    v_mov_b32 v100, v16
    v_mov_b32 v28, v17
    v_mfma_f32_16x16x32_bf16 a[112:115], a[96:99], v[32:35], a[112:115]
    v_mov_b32 v44, v18
    v_mov_b32 v60, v19
    v_mfma_f32_16x16x32_bf16 a[160:163], a[96:99], v[48:51], a[160:163]
    v_mbcnt_lo_u32_b32 v20, -1, 0
    v_mbcnt_hi_u32_b32 v20, -1, v20
    v_mfma_f32_16x16x32_bf16 a[208:211], a[96:99], v[64:67], a[208:211]
    s_waitcnt lgkmcnt(2)
    v_permlane32_swap_b32 v14, v76
    v_permlane32_swap_b32 v15, v88
    v_mfma_f32_16x16x32_bf16 v[116:119], a[100:103], v[80:83], v[116:119]
    ds_read_b64_tr_b16 a[96:97], v5 offset:12288
    ds_read_b64_tr_b16 a[98:99], v5 offset:14336
    v_mfma_f32_16x16x32_bf16 v[164:167], a[100:103], v[92:95], v[164:167]
    v_permlane32_swap_b32 v16, v100
    v_permlane32_swap_b32 v17, v28
    v_mfma_f32_16x16x32_bf16 v[212:215], a[100:103], v[104:107], v[212:215]
    v_permlane32_swap_b32 v18, v44
    v_permlane32_swap_b32 v19, v60
    v_mfma_f32_16x16x32_bf16 a[116:119], a[100:103], v[32:35], a[116:119]
    v_add_f32 v14, v14, v76
    v_add_f32 v15, v15, v88
    v_mfma_f32_16x16x32_bf16 a[164:167], a[100:103], v[48:51], a[164:167]
    v_add_f32 v16, v16, v100
    v_add_f32 v17, v17, v28
    v_mfma_f32_16x16x32_bf16 a[212:215], a[100:103], v[64:67], a[212:215]
    s_waitcnt lgkmcnt(2)
    v_add_f32 v18, v18, v44
    v_add_f32 v19, v19, v60
    v_mfma_f32_16x16x32_bf16 v[120:123], a[104:107], v[80:83], v[120:123]
    ds_read_b64_tr_b16 a[100:101], v2 offset:16384
    ds_read_b64_tr_b16 a[102:103], v2 offset:18432
    v_mfma_f32_16x16x32_bf16 v[168:171], a[104:107], v[92:95], v[168:171]
    v_mov_b32 v76, v14
    v_mov_b32 v88, v15
    v_mfma_f32_16x16x32_bf16 v[216:219], a[104:107], v[104:107], v[216:219]
    v_mov_b32 v100, v16
    v_mov_b32 v28, v17
    v_mfma_f32_16x16x32_bf16 a[120:123], a[104:107], v[32:35], a[120:123]
    v_mov_b32 v44, v18
    v_mov_b32 v60, v19
    v_mfma_f32_16x16x32_bf16 a[168:171], a[104:107], v[48:51], a[168:171]
    v_and_b32 v21, 15, v20
    v_mul_u32_u24 v21, 384, v21
    v_mfma_f32_16x16x32_bf16 a[216:219], a[104:107], v[64:67], a[216:219]
    s_waitcnt lgkmcnt(2)
    v_permlane16_swap_b32 v14, v76
    v_permlane16_swap_b32 v15, v88
    v_mfma_f32_16x16x32_bf16 v[124:127], a[96:99], v[80:83], v[124:127]
    ds_read_b64_tr_b16 a[104:105], v3 offset:16384
    ds_read_b64_tr_b16 a[106:107], v3 offset:18432
    v_mfma_f32_16x16x32_bf16 v[172:175], a[96:99], v[92:95], v[172:175]
    v_permlane16_swap_b32 v16, v100
    v_permlane16_swap_b32 v17, v28
    v_mfma_f32_16x16x32_bf16 v[220:223], a[96:99], v[104:107], v[220:223]
    v_permlane16_swap_b32 v18, v44
    v_permlane16_swap_b32 v19, v60
    v_mfma_f32_16x16x32_bf16 a[124:127], a[96:99], v[32:35], a[124:127]
    v_add_f32 v14, v14, v76
    v_add_f32 v15, v15, v88
    v_mfma_f32_16x16x32_bf16 a[172:175], a[96:99], v[48:51], a[172:175]
    v_add_f32 v16, v16, v100
    v_add_f32 v17, v17, v28
    v_mfma_f32_16x16x32_bf16 a[220:223], a[96:99], v[64:67], a[220:223]
    s_waitcnt lgkmcnt(2)
    v_rcp_f32 v14, v14
    v_mfma_f32_16x16x32_bf16 v[128:131], a[100:103], v[80:83], v[128:131]
    ds_read_b64_tr_b16 a[96:97], v4 offset:16384
    ds_read_b64_tr_b16 a[98:99], v4 offset:18432
    v_mfma_f32_16x16x32_bf16 v[176:179], a[100:103], v[92:95], v[176:179]
    v_rcp_f32 v15, v15
    v_mfma_f32_16x16x32_bf16 v[224:227], a[100:103], v[104:107], v[224:227]
    v_rcp_f32 v16, v16
    v_mfma_f32_16x16x32_bf16 a[128:131], a[100:103], v[32:35], a[128:131]
    v_rcp_f32 v17, v17
    v_mfma_f32_16x16x32_bf16 a[176:179], a[100:103], v[48:51], a[176:179]
    v_add_f32 v18, v18, v44
    v_add_f32 v19, v19, v60
    v_mfma_f32_16x16x32_bf16 a[224:227], a[100:103], v[64:67], a[224:227]
    s_waitcnt lgkmcnt(2)
    v_rcp_f32 v18, v18
    v_mfma_f32_16x16x32_bf16 v[132:135], a[104:107], v[80:83], v[132:135]
    ds_read_b64_tr_b16 a[100:101], v5 offset:16384
    ds_read_b64_tr_b16 a[102:103], v5 offset:18432
    v_mfma_f32_16x16x32_bf16 v[180:183], a[104:107], v[92:95], v[180:183]
    v_rcp_f32 v19, v19
    v_mfma_f32_16x16x32_bf16 v[228:231], a[104:107], v[104:107], v[228:231]
    v_bfe_u32 v22, v20, 4, 1
    v_lshl_add_u32 v21, v22, 3, v21
    v_mfma_f32_16x16x32_bf16 a[132:135], a[104:107], v[32:35], a[132:135]
    v_lshrrev_b32 v22, 5, v20
    v_xor_b32 v22, v22, v20
    v_mfma_f32_16x16x32_bf16 a[180:183], a[104:107], v[48:51], a[180:183]
    v_and_b32 v22, 7, v22
    v_add_u32 v21, s16, v21
    v_mfma_f32_16x16x32_bf16 a[228:231], a[104:107], v[64:67], a[228:231]
    s_waitcnt lgkmcnt(2)
    v_xor_b32 v23, 0, v22
    v_lshl_add_u32 v8, v23, 4, v21
    v_mfma_f32_16x16x32_bf16 v[136:139], a[96:99], v[80:83], v[136:139]
    ds_read_b64_tr_b16 a[104:105], v2 offset:20480
    ds_read_b64_tr_b16 a[106:107], v2 offset:22528
    v_mfma_f32_16x16x32_bf16 v[184:187], a[96:99], v[92:95], v[184:187]
    v_xor_b32 v23, 2, v22
    v_lshl_add_u32 v9, v23, 4, v21
    v_mfma_f32_16x16x32_bf16 v[232:235], a[96:99], v[104:107], v[232:235]
    v_xor_b32 v23, 4, v22
    v_lshl_add_u32 v10, v23, 4, v21
    v_mfma_f32_16x16x32_bf16 a[136:139], a[96:99], v[32:35], a[136:139]
    v_xor_b32 v23, 6, v22
    v_lshl_add_u32 v11, v23, 4, v21
    v_mfma_f32_16x16x32_bf16 a[184:187], a[96:99], v[48:51], a[184:187]
    v_lshrrev_b32 v21, 3, v20
    v_xor_b32 v22, v21, v20
    v_mfma_f32_16x16x32_bf16 a[232:235], a[96:99], v[64:67], a[232:235]
    s_waitcnt lgkmcnt(2)
    v_and_b32 v22, 7, v22
    v_mul_u32_u24 v21, 384, v21
    v_mfma_f32_16x16x32_bf16 v[140:143], a[100:103], v[80:83], v[140:143]
    ds_read_b64_tr_b16 a[96:97], v3 offset:20480
    ds_read_b64_tr_b16 a[98:99], v3 offset:22528
    v_mfma_f32_16x16x32_bf16 v[188:191], a[100:103], v[92:95], v[188:191]
    v_lshl_add_u32 v12, v22, 4, v21
    v_add_u32 v12, s16, v12
    v_mfma_f32_16x16x32_bf16 v[236:239], a[100:103], v[104:107], v[236:239]
    v_and_b32 v22, 7, v20
    v_lshl_add_u32 v13, v22, 4, v21
    v_mfma_f32_16x16x32_bf16 a[140:143], a[100:103], v[32:35], a[140:143]
    v_add_u32 v13, s49, v13
    v_mfma_f32_16x16x32_bf16 a[188:191], a[100:103], v[48:51], a[188:191]
    v_mfma_f32_16x16x32_bf16 a[236:239], a[100:103], v[64:67], a[236:239]
    s_waitcnt lgkmcnt(2)
    v_mfma_f32_16x16x32_bf16 v[144:147], a[104:107], v[80:83], v[144:147]
    ds_read_b64_tr_b16 a[100:101], v4 offset:20480
    ds_read_b64_tr_b16 a[102:103], v4 offset:22528
    v_mfma_f32_16x16x32_bf16 v[192:195], a[104:107], v[92:95], v[192:195]
    v_mfma_f32_16x16x32_bf16 v[240:243], a[104:107], v[104:107], v[240:243]
    v_mfma_f32_16x16x32_bf16 a[144:147], a[104:107], v[32:35], a[144:147]
    v_mfma_f32_16x16x32_bf16 a[192:195], a[104:107], v[48:51], a[192:195]
    v_mfma_f32_16x16x32_bf16 a[240:243], a[104:107], v[64:67], a[240:243]
    s_waitcnt lgkmcnt(2)
    v_mfma_f32_16x16x32_bf16 v[148:151], a[96:99], v[80:83], v[148:151]
    ds_read_b64_tr_b16 a[104:105], v5 offset:20480
    ds_read_b64_tr_b16 a[106:107], v5 offset:22528
    v_mfma_f32_16x16x32_bf16 v[196:199], a[96:99], v[92:95], v[196:199]
    v_mfma_f32_16x16x32_bf16 v[244:247], a[96:99], v[104:107], v[244:247]
    v_mfma_f32_16x16x32_bf16 a[148:151], a[96:99], v[32:35], a[148:151]
    v_mfma_f32_16x16x32_bf16 a[196:199], a[96:99], v[48:51], a[196:199]
    v_mfma_f32_16x16x32_bf16 a[244:247], a[96:99], v[64:67], a[244:247]
    s_waitcnt lgkmcnt(2)
    v_mfma_f32_16x16x32_bf16 v[152:155], a[100:103], v[80:83], v[152:155]
    v_mfma_f32_16x16x32_bf16 v[200:203], a[100:103], v[92:95], v[200:203]
    v_mfma_f32_16x16x32_bf16 v[248:251], a[100:103], v[104:107], v[248:251]
    v_mfma_f32_16x16x32_bf16 a[152:155], a[100:103], v[32:35], a[152:155]
    v_mfma_f32_16x16x32_bf16 a[200:203], a[100:103], v[48:51], a[200:203]
    v_mfma_f32_16x16x32_bf16 a[248:251], a[100:103], v[64:67], a[248:251]
    s_waitcnt lgkmcnt(0)
    v_mfma_f32_16x16x32_bf16 v[156:159], a[104:107], v[80:83], v[156:159]
    v_mfma_f32_16x16x32_bf16 v[204:207], a[104:107], v[92:95], v[204:207]
    v_mfma_f32_16x16x32_bf16 v[252:255], a[104:107], v[104:107], v[252:255]
    v_mfma_f32_16x16x32_bf16 a[156:159], a[104:107], v[32:35], a[156:159]
    v_mfma_f32_16x16x32_bf16 a[204:207], a[104:107], v[48:51], a[204:207]
    v_mfma_f32_16x16x32_bf16 a[252:255], a[104:107], v[64:67], a[252:255]
    s_nop 7
    v_pk_mul_f32 v[28:29], v[112:113], v[14:15] op_sel:[0,0] op_sel_hi:[1,0]
    v_pk_mul_f32 v[30:31], v[114:115], v[14:15] op_sel:[0,0] op_sel_hi:[1,0]
    v_cvt_pk_bf16_f32 v32, v28, v29
    v_cvt_pk_bf16_f32 v33, v30, v31
    ds_write_b64 v8, v[32:33] offset:0
    v_pk_mul_f32 v[34:35], v[116:117], v[14:15] op_sel:[0,0] op_sel_hi:[1,0]
    v_pk_mul_f32 v[36:37], v[118:119], v[14:15] op_sel:[0,0] op_sel_hi:[1,0]
    v_cvt_pk_bf16_f32 v38, v34, v35
    v_cvt_pk_bf16_f32 v39, v36, v37
    ds_write_b64 v9, v[38:39] offset:0
    v_pk_mul_f32 v[40:41], v[120:121], v[14:15] op_sel:[0,0] op_sel_hi:[1,0]
    v_pk_mul_f32 v[42:43], v[122:123], v[14:15] op_sel:[0,0] op_sel_hi:[1,0]
    v_cvt_pk_bf16_f32 v44, v40, v41
    v_cvt_pk_bf16_f32 v45, v42, v43
    ds_write_b64 v10, v[44:45] offset:0
    v_pk_mul_f32 v[46:47], v[124:125], v[14:15] op_sel:[0,0] op_sel_hi:[1,0]
    v_pk_mul_f32 v[48:49], v[126:127], v[14:15] op_sel:[0,0] op_sel_hi:[1,0]
    v_cvt_pk_bf16_f32 v50, v46, v47
    v_cvt_pk_bf16_f32 v51, v48, v49
    ds_write_b64 v11, v[50:51] offset:0
    v_pk_mul_f32 v[52:53], v[128:129], v[14:15] op_sel:[0,0] op_sel_hi:[1,0]
    v_pk_mul_f32 v[54:55], v[130:131], v[14:15] op_sel:[0,0] op_sel_hi:[1,0]
    v_cvt_pk_bf16_f32 v56, v52, v53
    v_cvt_pk_bf16_f32 v57, v54, v55
    ds_write_b64 v8, v[56:57] offset:128
    v_pk_mul_f32 v[58:59], v[132:133], v[14:15] op_sel:[0,0] op_sel_hi:[1,0]
    v_pk_mul_f32 v[60:61], v[134:135], v[14:15] op_sel:[0,0] op_sel_hi:[1,0]
    v_cvt_pk_bf16_f32 v62, v58, v59
    v_cvt_pk_bf16_f32 v63, v60, v61
    ds_write_b64 v9, v[62:63] offset:128
    v_pk_mul_f32 v[28:29], v[136:137], v[14:15] op_sel:[0,0] op_sel_hi:[1,0]
    v_pk_mul_f32 v[30:31], v[138:139], v[14:15] op_sel:[0,0] op_sel_hi:[1,0]
    v_cvt_pk_bf16_f32 v32, v28, v29
    v_cvt_pk_bf16_f32 v33, v30, v31
    ds_write_b64 v10, v[32:33] offset:128
    v_pk_mul_f32 v[34:35], v[140:141], v[14:15] op_sel:[0,0] op_sel_hi:[1,0]
    v_pk_mul_f32 v[36:37], v[142:143], v[14:15] op_sel:[0,0] op_sel_hi:[1,0]
    v_cvt_pk_bf16_f32 v38, v34, v35
    v_cvt_pk_bf16_f32 v39, v36, v37
    ds_write_b64 v11, v[38:39] offset:128
    v_pk_mul_f32 v[40:41], v[144:145], v[14:15] op_sel:[0,0] op_sel_hi:[1,0]
    v_pk_mul_f32 v[42:43], v[146:147], v[14:15] op_sel:[0,0] op_sel_hi:[1,0]
    v_cvt_pk_bf16_f32 v44, v40, v41
    v_cvt_pk_bf16_f32 v45, v42, v43
    ds_write_b64 v8, v[44:45] offset:256
    v_pk_mul_f32 v[46:47], v[148:149], v[14:15] op_sel:[0,0] op_sel_hi:[1,0]
    v_pk_mul_f32 v[48:49], v[150:151], v[14:15] op_sel:[0,0] op_sel_hi:[1,0]
    v_cvt_pk_bf16_f32 v50, v46, v47
    v_cvt_pk_bf16_f32 v51, v48, v49
    ds_write_b64 v9, v[50:51] offset:256
    v_pk_mul_f32 v[52:53], v[152:153], v[14:15] op_sel:[0,0] op_sel_hi:[1,0]
    v_pk_mul_f32 v[54:55], v[154:155], v[14:15] op_sel:[0,0] op_sel_hi:[1,0]
    v_cvt_pk_bf16_f32 v56, v52, v53
    v_cvt_pk_bf16_f32 v57, v54, v55
    ds_write_b64 v10, v[56:57] offset:256
    v_pk_mul_f32 v[58:59], v[156:157], v[14:15] op_sel:[0,0] op_sel_hi:[1,0]
    v_pk_mul_f32 v[60:61], v[158:159], v[14:15] op_sel:[0,0] op_sel_hi:[1,0]
    v_cvt_pk_bf16_f32 v62, v58, v59
    v_cvt_pk_bf16_f32 v63, v60, v61
    ds_write_b64 v11, v[62:63] offset:256
    ds_read_b128 v[64:67], v12 offset:0
    ds_read_b128 v[68:71], v12 offset:128
    ds_read_b128 v[72:75], v12 offset:256
    ds_read_b128 v[76:79], v12 offset:3072
    ds_read_b128 v[80:83], v12 offset:3200
    ds_read_b128 v[84:87], v12 offset:3328
    v_pk_mul_f32 v[28:29], v[160:161], v[14:15] op_sel:[0,1] op_sel_hi:[1,1]
    v_pk_mul_f32 v[30:31], v[162:163], v[14:15] op_sel:[0,1] op_sel_hi:[1,1]
    v_cvt_pk_bf16_f32 v32, v28, v29
    v_cvt_pk_bf16_f32 v33, v30, v31
    ds_write_b64 v8, v[32:33] offset:6528
    v_pk_mul_f32 v[34:35], v[164:165], v[14:15] op_sel:[0,1] op_sel_hi:[1,1]
    v_pk_mul_f32 v[36:37], v[166:167], v[14:15] op_sel:[0,1] op_sel_hi:[1,1]
    v_cvt_pk_bf16_f32 v38, v34, v35
    v_cvt_pk_bf16_f32 v39, v36, v37
    ds_write_b64 v9, v[38:39] offset:6528
    v_pk_mul_f32 v[40:41], v[168:169], v[14:15] op_sel:[0,1] op_sel_hi:[1,1]
    v_pk_mul_f32 v[42:43], v[170:171], v[14:15] op_sel:[0,1] op_sel_hi:[1,1]
    v_cvt_pk_bf16_f32 v44, v40, v41
    v_cvt_pk_bf16_f32 v45, v42, v43
    ds_write_b64 v10, v[44:45] offset:6528
    v_pk_mul_f32 v[46:47], v[172:173], v[14:15] op_sel:[0,1] op_sel_hi:[1,1]
    v_pk_mul_f32 v[48:49], v[174:175], v[14:15] op_sel:[0,1] op_sel_hi:[1,1]
    v_cvt_pk_bf16_f32 v50, v46, v47
    v_cvt_pk_bf16_f32 v51, v48, v49
    ds_write_b64 v11, v[50:51] offset:6528
    v_pk_mul_f32 v[52:53], v[176:177], v[14:15] op_sel:[0,1] op_sel_hi:[1,1]
    v_pk_mul_f32 v[54:55], v[178:179], v[14:15] op_sel:[0,1] op_sel_hi:[1,1]
    v_cvt_pk_bf16_f32 v56, v52, v53
    v_cvt_pk_bf16_f32 v57, v54, v55
    ds_write_b64 v8, v[56:57] offset:6656
    v_pk_mul_f32 v[58:59], v[180:181], v[14:15] op_sel:[0,1] op_sel_hi:[1,1]
    v_pk_mul_f32 v[60:61], v[182:183], v[14:15] op_sel:[0,1] op_sel_hi:[1,1]
    v_cvt_pk_bf16_f32 v62, v58, v59
    v_cvt_pk_bf16_f32 v63, v60, v61
    ds_write_b64 v9, v[62:63] offset:6656
    v_pk_mul_f32 v[28:29], v[184:185], v[14:15] op_sel:[0,1] op_sel_hi:[1,1]
    v_pk_mul_f32 v[30:31], v[186:187], v[14:15] op_sel:[0,1] op_sel_hi:[1,1]
    v_cvt_pk_bf16_f32 v32, v28, v29
    v_cvt_pk_bf16_f32 v33, v30, v31
    ds_write_b64 v10, v[32:33] offset:6656
    v_pk_mul_f32 v[34:35], v[188:189], v[14:15] op_sel:[0,1] op_sel_hi:[1,1]
    v_pk_mul_f32 v[36:37], v[190:191], v[14:15] op_sel:[0,1] op_sel_hi:[1,1]
    v_cvt_pk_bf16_f32 v38, v34, v35
    v_cvt_pk_bf16_f32 v39, v36, v37
    ds_write_b64 v11, v[38:39] offset:6656
    v_pk_mul_f32 v[40:41], v[192:193], v[14:15] op_sel:[0,1] op_sel_hi:[1,1]
    v_pk_mul_f32 v[42:43], v[194:195], v[14:15] op_sel:[0,1] op_sel_hi:[1,1]
    v_cvt_pk_bf16_f32 v44, v40, v41
    v_cvt_pk_bf16_f32 v45, v42, v43
    ds_write_b64 v8, v[44:45] offset:6784
    v_pk_mul_f32 v[46:47], v[196:197], v[14:15] op_sel:[0,1] op_sel_hi:[1,1]
    v_pk_mul_f32 v[48:49], v[198:199], v[14:15] op_sel:[0,1] op_sel_hi:[1,1]
    v_cvt_pk_bf16_f32 v50, v46, v47
    v_cvt_pk_bf16_f32 v51, v48, v49
    ds_write_b64 v9, v[50:51] offset:6784
    v_pk_mul_f32 v[52:53], v[200:201], v[14:15] op_sel:[0,1] op_sel_hi:[1,1]
    v_pk_mul_f32 v[54:55], v[202:203], v[14:15] op_sel:[0,1] op_sel_hi:[1,1]
    v_cvt_pk_bf16_f32 v56, v52, v53
    v_cvt_pk_bf16_f32 v57, v54, v55
    ds_write_b64 v10, v[56:57] offset:6784
    v_pk_mul_f32 v[58:59], v[204:205], v[14:15] op_sel:[0,1] op_sel_hi:[1,1]
    v_pk_mul_f32 v[60:61], v[206:207], v[14:15] op_sel:[0,1] op_sel_hi:[1,1]
    v_cvt_pk_bf16_f32 v62, v58, v59
    v_cvt_pk_bf16_f32 v63, v60, v61
    ds_write_b64 v11, v[62:63] offset:6784
    s_waitcnt lgkmcnt(12)
    buffer_store_dwordx4 v[64:67], v13, s[32:35], 0 offen offset:0 sc1
    buffer_store_dwordx4 v[68:71], v13, s[32:35], 0 offen offset:128 sc1
    buffer_store_dwordx4 v[72:75], v13, s[32:35], 0 offen offset:256 sc1
    buffer_store_dwordx4 v[76:79], v13, s[32:35], 0 offen offset:3072 sc1
    buffer_store_dwordx4 v[80:83], v13, s[32:35], 0 offen offset:3200 sc1
    buffer_store_dwordx4 v[84:87], v13, s[32:35], 0 offen offset:3328 sc1
    ds_read_b128 v[88:91], v12 offset:6528
    ds_read_b128 v[92:95], v12 offset:6656
    ds_read_b128 v[96:99], v12 offset:6784
    ds_read_b128 v[100:103], v12 offset:9600
    ds_read_b128 v[104:107], v12 offset:9728
    ds_read_b128 v[108:111], v12 offset:9856
    v_pk_mul_f32 v[28:29], v[208:209], v[16:17] op_sel:[0,0] op_sel_hi:[1,0]
    v_pk_mul_f32 v[30:31], v[210:211], v[16:17] op_sel:[0,0] op_sel_hi:[1,0]
    v_cvt_pk_bf16_f32 v32, v28, v29
    v_cvt_pk_bf16_f32 v33, v30, v31
    ds_write_b64 v8, v[32:33] offset:0
    v_pk_mul_f32 v[34:35], v[212:213], v[16:17] op_sel:[0,0] op_sel_hi:[1,0]
    v_pk_mul_f32 v[36:37], v[214:215], v[16:17] op_sel:[0,0] op_sel_hi:[1,0]
    v_cvt_pk_bf16_f32 v38, v34, v35
    v_cvt_pk_bf16_f32 v39, v36, v37
    ds_write_b64 v9, v[38:39] offset:0
    v_pk_mul_f32 v[40:41], v[216:217], v[16:17] op_sel:[0,0] op_sel_hi:[1,0]
    v_pk_mul_f32 v[42:43], v[218:219], v[16:17] op_sel:[0,0] op_sel_hi:[1,0]
    v_cvt_pk_bf16_f32 v44, v40, v41
    v_cvt_pk_bf16_f32 v45, v42, v43
    ds_write_b64 v10, v[44:45] offset:0
    v_pk_mul_f32 v[46:47], v[220:221], v[16:17] op_sel:[0,0] op_sel_hi:[1,0]
    v_pk_mul_f32 v[48:49], v[222:223], v[16:17] op_sel:[0,0] op_sel_hi:[1,0]
    v_cvt_pk_bf16_f32 v50, v46, v47
    v_cvt_pk_bf16_f32 v51, v48, v49
    ds_write_b64 v11, v[50:51] offset:0
    v_pk_mul_f32 v[52:53], v[224:225], v[16:17] op_sel:[0,0] op_sel_hi:[1,0]
    v_pk_mul_f32 v[54:55], v[226:227], v[16:17] op_sel:[0,0] op_sel_hi:[1,0]
    v_cvt_pk_bf16_f32 v56, v52, v53
    v_cvt_pk_bf16_f32 v57, v54, v55
    ds_write_b64 v8, v[56:57] offset:128
    v_pk_mul_f32 v[58:59], v[228:229], v[16:17] op_sel:[0,0] op_sel_hi:[1,0]
    v_pk_mul_f32 v[60:61], v[230:231], v[16:17] op_sel:[0,0] op_sel_hi:[1,0]
    v_cvt_pk_bf16_f32 v62, v58, v59
    v_cvt_pk_bf16_f32 v63, v60, v61
    ds_write_b64 v9, v[62:63] offset:128
    v_pk_mul_f32 v[28:29], v[232:233], v[16:17] op_sel:[0,0] op_sel_hi:[1,0]
    v_pk_mul_f32 v[30:31], v[234:235], v[16:17] op_sel:[0,0] op_sel_hi:[1,0]
    v_cvt_pk_bf16_f32 v32, v28, v29
    v_cvt_pk_bf16_f32 v33, v30, v31
    ds_write_b64 v10, v[32:33] offset:128
    v_pk_mul_f32 v[34:35], v[236:237], v[16:17] op_sel:[0,0] op_sel_hi:[1,0]
    v_pk_mul_f32 v[36:37], v[238:239], v[16:17] op_sel:[0,0] op_sel_hi:[1,0]
    v_cvt_pk_bf16_f32 v38, v34, v35
    v_cvt_pk_bf16_f32 v39, v36, v37
    ds_write_b64 v11, v[38:39] offset:128
    v_pk_mul_f32 v[40:41], v[240:241], v[16:17] op_sel:[0,0] op_sel_hi:[1,0]
    v_pk_mul_f32 v[42:43], v[242:243], v[16:17] op_sel:[0,0] op_sel_hi:[1,0]
    v_cvt_pk_bf16_f32 v44, v40, v41
    v_cvt_pk_bf16_f32 v45, v42, v43
    ds_write_b64 v8, v[44:45] offset:256
    v_pk_mul_f32 v[46:47], v[244:245], v[16:17] op_sel:[0,0] op_sel_hi:[1,0]
    v_pk_mul_f32 v[48:49], v[246:247], v[16:17] op_sel:[0,0] op_sel_hi:[1,0]
    v_cvt_pk_bf16_f32 v50, v46, v47
    v_cvt_pk_bf16_f32 v51, v48, v49
    ds_write_b64 v9, v[50:51] offset:256
    v_pk_mul_f32 v[52:53], v[248:249], v[16:17] op_sel:[0,0] op_sel_hi:[1,0]
    v_pk_mul_f32 v[54:55], v[250:251], v[16:17] op_sel:[0,0] op_sel_hi:[1,0]
    v_cvt_pk_bf16_f32 v56, v52, v53
    v_cvt_pk_bf16_f32 v57, v54, v55
    ds_write_b64 v10, v[56:57] offset:256
    v_pk_mul_f32 v[58:59], v[252:253], v[16:17] op_sel:[0,0] op_sel_hi:[1,0]
    v_pk_mul_f32 v[60:61], v[254:255], v[16:17] op_sel:[0,0] op_sel_hi:[1,0]
    v_cvt_pk_bf16_f32 v62, v58, v59
    v_cvt_pk_bf16_f32 v63, v60, v61
    ds_write_b64 v11, v[62:63] offset:256
    s_waitcnt lgkmcnt(12)
    buffer_store_dwordx4 v[88:91], v13, s[32:35], s55 offen offset:0 sc1
    buffer_store_dwordx4 v[92:95], v13, s[32:35], s55 offen offset:128 sc1
    buffer_store_dwordx4 v[96:99], v13, s[32:35], s55 offen offset:256 sc1
    buffer_store_dwordx4 v[100:103], v13, s[32:35], s55 offen offset:3072 sc1
    buffer_store_dwordx4 v[104:107], v13, s[32:35], s55 offen offset:3200 sc1
    buffer_store_dwordx4 v[108:111], v13, s[32:35], s55 offen offset:3328 sc1
    ds_read_b128 v[64:67], v12 offset:0
    ds_read_b128 v[68:71], v12 offset:128
    ds_read_b128 v[72:75], v12 offset:256
    ds_read_b128 v[76:79], v12 offset:3072
    ds_read_b128 v[80:83], v12 offset:3200
    ds_read_b128 v[84:87], v12 offset:3328
    v_accvgpr_read_b32 v28, a112
    v_accvgpr_read_b32 v29, a113
    v_accvgpr_read_b32 v30, a114
    v_accvgpr_read_b32 v31, a115
    v_pk_mul_f32 v[28:29], v[28:29], v[16:17] op_sel:[0,1] op_sel_hi:[1,1]
    v_pk_mul_f32 v[30:31], v[30:31], v[16:17] op_sel:[0,1] op_sel_hi:[1,1]
    v_cvt_pk_bf16_f32 v32, v28, v29
    v_cvt_pk_bf16_f32 v33, v30, v31
    ds_write_b64 v8, v[32:33] offset:6528
    v_accvgpr_read_b32 v34, a116
    v_accvgpr_read_b32 v35, a117
    v_accvgpr_read_b32 v36, a118
    v_accvgpr_read_b32 v37, a119
    v_pk_mul_f32 v[34:35], v[34:35], v[16:17] op_sel:[0,1] op_sel_hi:[1,1]
    v_pk_mul_f32 v[36:37], v[36:37], v[16:17] op_sel:[0,1] op_sel_hi:[1,1]
    v_cvt_pk_bf16_f32 v38, v34, v35
    v_cvt_pk_bf16_f32 v39, v36, v37
    ds_write_b64 v9, v[38:39] offset:6528
    v_accvgpr_read_b32 v40, a120
    v_accvgpr_read_b32 v41, a121
    v_accvgpr_read_b32 v42, a122
    v_accvgpr_read_b32 v43, a123
    v_pk_mul_f32 v[40:41], v[40:41], v[16:17] op_sel:[0,1] op_sel_hi:[1,1]
    v_pk_mul_f32 v[42:43], v[42:43], v[16:17] op_sel:[0,1] op_sel_hi:[1,1]
    v_cvt_pk_bf16_f32 v44, v40, v41
    v_cvt_pk_bf16_f32 v45, v42, v43
    ds_write_b64 v10, v[44:45] offset:6528
    v_accvgpr_read_b32 v46, a124
    v_accvgpr_read_b32 v47, a125
    v_accvgpr_read_b32 v48, a126
    v_accvgpr_read_b32 v49, a127
    v_pk_mul_f32 v[46:47], v[46:47], v[16:17] op_sel:[0,1] op_sel_hi:[1,1]
    v_pk_mul_f32 v[48:49], v[48:49], v[16:17] op_sel:[0,1] op_sel_hi:[1,1]
    v_cvt_pk_bf16_f32 v50, v46, v47
    v_cvt_pk_bf16_f32 v51, v48, v49
    ds_write_b64 v11, v[50:51] offset:6528
    v_accvgpr_read_b32 v52, a128
    v_accvgpr_read_b32 v53, a129
    v_accvgpr_read_b32 v54, a130
    v_accvgpr_read_b32 v55, a131
    v_pk_mul_f32 v[52:53], v[52:53], v[16:17] op_sel:[0,1] op_sel_hi:[1,1]
    v_pk_mul_f32 v[54:55], v[54:55], v[16:17] op_sel:[0,1] op_sel_hi:[1,1]
    v_cvt_pk_bf16_f32 v56, v52, v53
    v_cvt_pk_bf16_f32 v57, v54, v55
    ds_write_b64 v8, v[56:57] offset:6656
    v_accvgpr_read_b32 v58, a132
    v_accvgpr_read_b32 v59, a133
    v_accvgpr_read_b32 v60, a134
    v_accvgpr_read_b32 v61, a135
    v_pk_mul_f32 v[58:59], v[58:59], v[16:17] op_sel:[0,1] op_sel_hi:[1,1]
    v_pk_mul_f32 v[60:61], v[60:61], v[16:17] op_sel:[0,1] op_sel_hi:[1,1]
    v_cvt_pk_bf16_f32 v62, v58, v59
    v_cvt_pk_bf16_f32 v63, v60, v61
    ds_write_b64 v9, v[62:63] offset:6656
    v_accvgpr_read_b32 v28, a136
    v_accvgpr_read_b32 v29, a137
    v_accvgpr_read_b32 v30, a138
    v_accvgpr_read_b32 v31, a139
    v_pk_mul_f32 v[28:29], v[28:29], v[16:17] op_sel:[0,1] op_sel_hi:[1,1]
    v_pk_mul_f32 v[30:31], v[30:31], v[16:17] op_sel:[0,1] op_sel_hi:[1,1]
    v_cvt_pk_bf16_f32 v32, v28, v29
    v_cvt_pk_bf16_f32 v33, v30, v31
    ds_write_b64 v10, v[32:33] offset:6656
    v_accvgpr_read_b32 v34, a140
    v_accvgpr_read_b32 v35, a141
    v_accvgpr_read_b32 v36, a142
    v_accvgpr_read_b32 v37, a143
    v_pk_mul_f32 v[34:35], v[34:35], v[16:17] op_sel:[0,1] op_sel_hi:[1,1]
    v_pk_mul_f32 v[36:37], v[36:37], v[16:17] op_sel:[0,1] op_sel_hi:[1,1]
    v_cvt_pk_bf16_f32 v38, v34, v35
    v_cvt_pk_bf16_f32 v39, v36, v37
    ds_write_b64 v11, v[38:39] offset:6656
    v_accvgpr_read_b32 v40, a144
    v_accvgpr_read_b32 v41, a145
    v_accvgpr_read_b32 v42, a146
    v_accvgpr_read_b32 v43, a147
    v_pk_mul_f32 v[40:41], v[40:41], v[16:17] op_sel:[0,1] op_sel_hi:[1,1]
    v_pk_mul_f32 v[42:43], v[42:43], v[16:17] op_sel:[0,1] op_sel_hi:[1,1]
    v_cvt_pk_bf16_f32 v44, v40, v41
    v_cvt_pk_bf16_f32 v45, v42, v43
    ds_write_b64 v8, v[44:45] offset:6784
    v_accvgpr_read_b32 v46, a148
    v_accvgpr_read_b32 v47, a149
    v_accvgpr_read_b32 v48, a150
    v_accvgpr_read_b32 v49, a151
    v_pk_mul_f32 v[46:47], v[46:47], v[16:17] op_sel:[0,1] op_sel_hi:[1,1]
    v_pk_mul_f32 v[48:49], v[48:49], v[16:17] op_sel:[0,1] op_sel_hi:[1,1]
    v_cvt_pk_bf16_f32 v50, v46, v47
    v_cvt_pk_bf16_f32 v51, v48, v49
    ds_write_b64 v9, v[50:51] offset:6784
    v_accvgpr_read_b32 v52, a152
    v_accvgpr_read_b32 v53, a153
    v_accvgpr_read_b32 v54, a154
    v_accvgpr_read_b32 v55, a155
    v_pk_mul_f32 v[52:53], v[52:53], v[16:17] op_sel:[0,1] op_sel_hi:[1,1]
    v_pk_mul_f32 v[54:55], v[54:55], v[16:17] op_sel:[0,1] op_sel_hi:[1,1]
    v_cvt_pk_bf16_f32 v56, v52, v53
    v_cvt_pk_bf16_f32 v57, v54, v55
    ds_write_b64 v10, v[56:57] offset:6784
    v_accvgpr_read_b32 v58, a156
    v_accvgpr_read_b32 v59, a157
    v_accvgpr_read_b32 v60, a158
    v_accvgpr_read_b32 v61, a159
    v_pk_mul_f32 v[58:59], v[58:59], v[16:17] op_sel:[0,1] op_sel_hi:[1,1]
    v_pk_mul_f32 v[60:61], v[60:61], v[16:17] op_sel:[0,1] op_sel_hi:[1,1]
    v_cvt_pk_bf16_f32 v62, v58, v59
    v_cvt_pk_bf16_f32 v63, v60, v61
    ds_write_b64 v11, v[62:63] offset:6784
    s_waitcnt lgkmcnt(12)
    buffer_store_dwordx4 v[64:67], v13, s[32:35], s56 offen offset:0 sc1
    buffer_store_dwordx4 v[68:71], v13, s[32:35], s56 offen offset:128 sc1
    buffer_store_dwordx4 v[72:75], v13, s[32:35], s56 offen offset:256 sc1
    buffer_store_dwordx4 v[76:79], v13, s[32:35], s56 offen offset:3072 sc1
    buffer_store_dwordx4 v[80:83], v13, s[32:35], s56 offen offset:3200 sc1
    buffer_store_dwordx4 v[84:87], v13, s[32:35], s56 offen offset:3328 sc1
    ds_read_b128 v[88:91], v12 offset:6528
    ds_read_b128 v[92:95], v12 offset:6656
    ds_read_b128 v[96:99], v12 offset:6784
    ds_read_b128 v[100:103], v12 offset:9600
    ds_read_b128 v[104:107], v12 offset:9728
    ds_read_b128 v[108:111], v12 offset:9856
    v_accvgpr_read_b32 v28, a160
    v_accvgpr_read_b32 v29, a161
    v_accvgpr_read_b32 v30, a162
    v_accvgpr_read_b32 v31, a163
    v_pk_mul_f32 v[28:29], v[28:29], v[18:19] op_sel:[0,0] op_sel_hi:[1,0]
    v_pk_mul_f32 v[30:31], v[30:31], v[18:19] op_sel:[0,0] op_sel_hi:[1,0]
    v_cvt_pk_bf16_f32 v32, v28, v29
    v_cvt_pk_bf16_f32 v33, v30, v31
    ds_write_b64 v8, v[32:33] offset:0
    v_accvgpr_read_b32 v34, a164
    v_accvgpr_read_b32 v35, a165
    v_accvgpr_read_b32 v36, a166
    v_accvgpr_read_b32 v37, a167
    v_pk_mul_f32 v[34:35], v[34:35], v[18:19] op_sel:[0,0] op_sel_hi:[1,0]
    v_pk_mul_f32 v[36:37], v[36:37], v[18:19] op_sel:[0,0] op_sel_hi:[1,0]
    v_cvt_pk_bf16_f32 v38, v34, v35
    v_cvt_pk_bf16_f32 v39, v36, v37
    ds_write_b64 v9, v[38:39] offset:0
    v_accvgpr_read_b32 v40, a168
    v_accvgpr_read_b32 v41, a169
    v_accvgpr_read_b32 v42, a170
    v_accvgpr_read_b32 v43, a171
    v_pk_mul_f32 v[40:41], v[40:41], v[18:19] op_sel:[0,0] op_sel_hi:[1,0]
    v_pk_mul_f32 v[42:43], v[42:43], v[18:19] op_sel:[0,0] op_sel_hi:[1,0]
    v_cvt_pk_bf16_f32 v44, v40, v41
    v_cvt_pk_bf16_f32 v45, v42, v43
    ds_write_b64 v10, v[44:45] offset:0
    v_accvgpr_read_b32 v46, a172
    v_accvgpr_read_b32 v47, a173
    v_accvgpr_read_b32 v48, a174
    v_accvgpr_read_b32 v49, a175
    v_pk_mul_f32 v[46:47], v[46:47], v[18:19] op_sel:[0,0] op_sel_hi:[1,0]
    v_pk_mul_f32 v[48:49], v[48:49], v[18:19] op_sel:[0,0] op_sel_hi:[1,0]
    v_cvt_pk_bf16_f32 v50, v46, v47
    v_cvt_pk_bf16_f32 v51, v48, v49
    ds_write_b64 v11, v[50:51] offset:0
    v_accvgpr_read_b32 v52, a176
    v_accvgpr_read_b32 v53, a177
    v_accvgpr_read_b32 v54, a178
    v_accvgpr_read_b32 v55, a179
    v_pk_mul_f32 v[52:53], v[52:53], v[18:19] op_sel:[0,0] op_sel_hi:[1,0]
    v_pk_mul_f32 v[54:55], v[54:55], v[18:19] op_sel:[0,0] op_sel_hi:[1,0]
    v_cvt_pk_bf16_f32 v56, v52, v53
    v_cvt_pk_bf16_f32 v57, v54, v55
    ds_write_b64 v8, v[56:57] offset:128
    v_accvgpr_read_b32 v58, a180
    v_accvgpr_read_b32 v59, a181
    v_accvgpr_read_b32 v60, a182
    v_accvgpr_read_b32 v61, a183
    v_pk_mul_f32 v[58:59], v[58:59], v[18:19] op_sel:[0,0] op_sel_hi:[1,0]
    v_pk_mul_f32 v[60:61], v[60:61], v[18:19] op_sel:[0,0] op_sel_hi:[1,0]
    v_cvt_pk_bf16_f32 v62, v58, v59
    v_cvt_pk_bf16_f32 v63, v60, v61
    ds_write_b64 v9, v[62:63] offset:128
    v_accvgpr_read_b32 v28, a184
    v_accvgpr_read_b32 v29, a185
    v_accvgpr_read_b32 v30, a186
    v_accvgpr_read_b32 v31, a187
    v_pk_mul_f32 v[28:29], v[28:29], v[18:19] op_sel:[0,0] op_sel_hi:[1,0]
    v_pk_mul_f32 v[30:31], v[30:31], v[18:19] op_sel:[0,0] op_sel_hi:[1,0]
    v_cvt_pk_bf16_f32 v32, v28, v29
    v_cvt_pk_bf16_f32 v33, v30, v31
    ds_write_b64 v10, v[32:33] offset:128
    v_accvgpr_read_b32 v34, a188
    v_accvgpr_read_b32 v35, a189
    v_accvgpr_read_b32 v36, a190
    v_accvgpr_read_b32 v37, a191
    v_pk_mul_f32 v[34:35], v[34:35], v[18:19] op_sel:[0,0] op_sel_hi:[1,0]
    v_pk_mul_f32 v[36:37], v[36:37], v[18:19] op_sel:[0,0] op_sel_hi:[1,0]
    v_cvt_pk_bf16_f32 v38, v34, v35
    v_cvt_pk_bf16_f32 v39, v36, v37
    ds_write_b64 v11, v[38:39] offset:128
    v_accvgpr_read_b32 v40, a192
    v_accvgpr_read_b32 v41, a193
    v_accvgpr_read_b32 v42, a194
    v_accvgpr_read_b32 v43, a195
    v_pk_mul_f32 v[40:41], v[40:41], v[18:19] op_sel:[0,0] op_sel_hi:[1,0]
    v_pk_mul_f32 v[42:43], v[42:43], v[18:19] op_sel:[0,0] op_sel_hi:[1,0]
    v_cvt_pk_bf16_f32 v44, v40, v41
    v_cvt_pk_bf16_f32 v45, v42, v43
    ds_write_b64 v8, v[44:45] offset:256
    v_accvgpr_read_b32 v46, a196
    v_accvgpr_read_b32 v47, a197
    v_accvgpr_read_b32 v48, a198
    v_accvgpr_read_b32 v49, a199
    v_pk_mul_f32 v[46:47], v[46:47], v[18:19] op_sel:[0,0] op_sel_hi:[1,0]
    v_pk_mul_f32 v[48:49], v[48:49], v[18:19] op_sel:[0,0] op_sel_hi:[1,0]
    v_cvt_pk_bf16_f32 v50, v46, v47
    v_cvt_pk_bf16_f32 v51, v48, v49
    ds_write_b64 v9, v[50:51] offset:256
    v_accvgpr_read_b32 v52, a200
    v_accvgpr_read_b32 v53, a201
    v_accvgpr_read_b32 v54, a202
    v_accvgpr_read_b32 v55, a203
    v_pk_mul_f32 v[52:53], v[52:53], v[18:19] op_sel:[0,0] op_sel_hi:[1,0]
    v_pk_mul_f32 v[54:55], v[54:55], v[18:19] op_sel:[0,0] op_sel_hi:[1,0]
    v_cvt_pk_bf16_f32 v56, v52, v53
    v_cvt_pk_bf16_f32 v57, v54, v55
    ds_write_b64 v10, v[56:57] offset:256
    v_accvgpr_read_b32 v58, a204
    v_accvgpr_read_b32 v59, a205
    v_accvgpr_read_b32 v60, a206
    v_accvgpr_read_b32 v61, a207
    v_pk_mul_f32 v[58:59], v[58:59], v[18:19] op_sel:[0,0] op_sel_hi:[1,0]
    v_pk_mul_f32 v[60:61], v[60:61], v[18:19] op_sel:[0,0] op_sel_hi:[1,0]
    v_cvt_pk_bf16_f32 v62, v58, v59
    v_cvt_pk_bf16_f32 v63, v60, v61
    ds_write_b64 v11, v[62:63] offset:256
    s_waitcnt lgkmcnt(12)
    buffer_store_dwordx4 v[88:91], v13, s[32:35], s57 offen offset:0 sc1
    buffer_store_dwordx4 v[92:95], v13, s[32:35], s57 offen offset:128 sc1
    buffer_store_dwordx4 v[96:99], v13, s[32:35], s57 offen offset:256 sc1
    buffer_store_dwordx4 v[100:103], v13, s[32:35], s57 offen offset:3072 sc1
    buffer_store_dwordx4 v[104:107], v13, s[32:35], s57 offen offset:3200 sc1
    buffer_store_dwordx4 v[108:111], v13, s[32:35], s57 offen offset:3328 sc1
    ds_read_b128 v[64:67], v12 offset:0
    ds_read_b128 v[68:71], v12 offset:128
    ds_read_b128 v[72:75], v12 offset:256
    ds_read_b128 v[76:79], v12 offset:3072
    ds_read_b128 v[80:83], v12 offset:3200
    ds_read_b128 v[84:87], v12 offset:3328
    v_accvgpr_read_b32 v28, a208
    v_accvgpr_read_b32 v29, a209
    v_accvgpr_read_b32 v30, a210
    v_accvgpr_read_b32 v31, a211
    v_pk_mul_f32 v[28:29], v[28:29], v[18:19] op_sel:[0,1] op_sel_hi:[1,1]
    v_pk_mul_f32 v[30:31], v[30:31], v[18:19] op_sel:[0,1] op_sel_hi:[1,1]
    v_cvt_pk_bf16_f32 v32, v28, v29
    v_cvt_pk_bf16_f32 v33, v30, v31
    ds_write_b64 v8, v[32:33] offset:6528
    v_accvgpr_read_b32 v34, a212
    v_accvgpr_read_b32 v35, a213
    v_accvgpr_read_b32 v36, a214
    v_accvgpr_read_b32 v37, a215
    v_pk_mul_f32 v[34:35], v[34:35], v[18:19] op_sel:[0,1] op_sel_hi:[1,1]
    v_pk_mul_f32 v[36:37], v[36:37], v[18:19] op_sel:[0,1] op_sel_hi:[1,1]
    v_cvt_pk_bf16_f32 v38, v34, v35
    v_cvt_pk_bf16_f32 v39, v36, v37
    ds_write_b64 v9, v[38:39] offset:6528
    v_accvgpr_read_b32 v40, a216
    v_accvgpr_read_b32 v41, a217
    v_accvgpr_read_b32 v42, a218
    v_accvgpr_read_b32 v43, a219
    v_pk_mul_f32 v[40:41], v[40:41], v[18:19] op_sel:[0,1] op_sel_hi:[1,1]
    v_pk_mul_f32 v[42:43], v[42:43], v[18:19] op_sel:[0,1] op_sel_hi:[1,1]
    v_cvt_pk_bf16_f32 v44, v40, v41
    v_cvt_pk_bf16_f32 v45, v42, v43
    ds_write_b64 v10, v[44:45] offset:6528
    v_accvgpr_read_b32 v46, a220
    v_accvgpr_read_b32 v47, a221
    v_accvgpr_read_b32 v48, a222
    v_accvgpr_read_b32 v49, a223
    v_pk_mul_f32 v[46:47], v[46:47], v[18:19] op_sel:[0,1] op_sel_hi:[1,1]
    v_pk_mul_f32 v[48:49], v[48:49], v[18:19] op_sel:[0,1] op_sel_hi:[1,1]
    v_cvt_pk_bf16_f32 v50, v46, v47
    v_cvt_pk_bf16_f32 v51, v48, v49
    ds_write_b64 v11, v[50:51] offset:6528
    v_accvgpr_read_b32 v52, a224
    v_accvgpr_read_b32 v53, a225
    v_accvgpr_read_b32 v54, a226
    v_accvgpr_read_b32 v55, a227
    v_pk_mul_f32 v[52:53], v[52:53], v[18:19] op_sel:[0,1] op_sel_hi:[1,1]
    v_pk_mul_f32 v[54:55], v[54:55], v[18:19] op_sel:[0,1] op_sel_hi:[1,1]
    v_cvt_pk_bf16_f32 v56, v52, v53
    v_cvt_pk_bf16_f32 v57, v54, v55
    ds_write_b64 v8, v[56:57] offset:6656
    v_accvgpr_read_b32 v58, a228
    v_accvgpr_read_b32 v59, a229
    v_accvgpr_read_b32 v60, a230
    v_accvgpr_read_b32 v61, a231
    v_pk_mul_f32 v[58:59], v[58:59], v[18:19] op_sel:[0,1] op_sel_hi:[1,1]
    v_pk_mul_f32 v[60:61], v[60:61], v[18:19] op_sel:[0,1] op_sel_hi:[1,1]
    v_cvt_pk_bf16_f32 v62, v58, v59
    v_cvt_pk_bf16_f32 v63, v60, v61
    ds_write_b64 v9, v[62:63] offset:6656
    v_accvgpr_read_b32 v28, a232
    v_accvgpr_read_b32 v29, a233
    v_accvgpr_read_b32 v30, a234
    v_accvgpr_read_b32 v31, a235
    v_pk_mul_f32 v[28:29], v[28:29], v[18:19] op_sel:[0,1] op_sel_hi:[1,1]
    v_pk_mul_f32 v[30:31], v[30:31], v[18:19] op_sel:[0,1] op_sel_hi:[1,1]
    v_cvt_pk_bf16_f32 v32, v28, v29
    v_cvt_pk_bf16_f32 v33, v30, v31
    ds_write_b64 v10, v[32:33] offset:6656
    v_accvgpr_read_b32 v34, a236
    v_accvgpr_read_b32 v35, a237
    v_accvgpr_read_b32 v36, a238
    v_accvgpr_read_b32 v37, a239
    v_pk_mul_f32 v[34:35], v[34:35], v[18:19] op_sel:[0,1] op_sel_hi:[1,1]
    v_pk_mul_f32 v[36:37], v[36:37], v[18:19] op_sel:[0,1] op_sel_hi:[1,1]
    v_cvt_pk_bf16_f32 v38, v34, v35
    v_cvt_pk_bf16_f32 v39, v36, v37
    ds_write_b64 v11, v[38:39] offset:6656
    v_accvgpr_read_b32 v40, a240
    v_accvgpr_read_b32 v41, a241
    v_accvgpr_read_b32 v42, a242
    v_accvgpr_read_b32 v43, a243
    v_pk_mul_f32 v[40:41], v[40:41], v[18:19] op_sel:[0,1] op_sel_hi:[1,1]
    v_pk_mul_f32 v[42:43], v[42:43], v[18:19] op_sel:[0,1] op_sel_hi:[1,1]
    v_cvt_pk_bf16_f32 v44, v40, v41
    v_cvt_pk_bf16_f32 v45, v42, v43
    ds_write_b64 v8, v[44:45] offset:6784
    v_accvgpr_read_b32 v46, a244
    v_accvgpr_read_b32 v47, a245
    v_accvgpr_read_b32 v48, a246
    v_accvgpr_read_b32 v49, a247
    v_pk_mul_f32 v[46:47], v[46:47], v[18:19] op_sel:[0,1] op_sel_hi:[1,1]
    v_pk_mul_f32 v[48:49], v[48:49], v[18:19] op_sel:[0,1] op_sel_hi:[1,1]
    v_cvt_pk_bf16_f32 v50, v46, v47
    v_cvt_pk_bf16_f32 v51, v48, v49
    ds_write_b64 v9, v[50:51] offset:6784
    v_accvgpr_read_b32 v52, a248
    v_accvgpr_read_b32 v53, a249
    v_accvgpr_read_b32 v54, a250
    v_accvgpr_read_b32 v55, a251
    v_pk_mul_f32 v[52:53], v[52:53], v[18:19] op_sel:[0,1] op_sel_hi:[1,1]
    v_pk_mul_f32 v[54:55], v[54:55], v[18:19] op_sel:[0,1] op_sel_hi:[1,1]
    v_cvt_pk_bf16_f32 v56, v52, v53
    v_cvt_pk_bf16_f32 v57, v54, v55
    ds_write_b64 v10, v[56:57] offset:6784
    v_accvgpr_read_b32 v58, a252
    v_accvgpr_read_b32 v59, a253
    v_accvgpr_read_b32 v60, a254
    v_accvgpr_read_b32 v61, a255
    v_pk_mul_f32 v[58:59], v[58:59], v[18:19] op_sel:[0,1] op_sel_hi:[1,1]
    v_pk_mul_f32 v[60:61], v[60:61], v[18:19] op_sel:[0,1] op_sel_hi:[1,1]
    v_cvt_pk_bf16_f32 v62, v58, v59
    v_cvt_pk_bf16_f32 v63, v60, v61
    ds_write_b64 v11, v[62:63] offset:6784
    s_waitcnt lgkmcnt(12)
    buffer_store_dwordx4 v[64:67], v13, s[32:35], s58 offen offset:0 sc1
    buffer_store_dwordx4 v[68:71], v13, s[32:35], s58 offen offset:128 sc1
    buffer_store_dwordx4 v[72:75], v13, s[32:35], s58 offen offset:256 sc1
    buffer_store_dwordx4 v[76:79], v13, s[32:35], s58 offen offset:3072 sc1
    buffer_store_dwordx4 v[80:83], v13, s[32:35], s58 offen offset:3200 sc1
    buffer_store_dwordx4 v[84:87], v13, s[32:35], s58 offen offset:3328 sc1
    ds_read_b128 v[88:91], v12 offset:6528
    ds_read_b128 v[92:95], v12 offset:6656
    ds_read_b128 v[96:99], v12 offset:6784
    ds_read_b128 v[100:103], v12 offset:9600
    ds_read_b128 v[104:107], v12 offset:9728
    ds_read_b128 v[108:111], v12 offset:9856
    s_waitcnt lgkmcnt(0)
    buffer_store_dwordx4 v[88:91], v13, s[32:35], s59 offen offset:0 sc1
    buffer_store_dwordx4 v[92:95], v13, s[32:35], s59 offen offset:128 sc1
    buffer_store_dwordx4 v[96:99], v13, s[32:35], s59 offen offset:256 sc1
    buffer_store_dwordx4 v[100:103], v13, s[32:35], s59 offen offset:3072 sc1
    buffer_store_dwordx4 v[104:107], v13, s[32:35], s59 offen offset:3200 sc1
    buffer_store_dwordx4 v[108:111], v13, s[32:35], s59 offen offset:3328 sc1
S_end:
    s_endpgm
S_rare_late0:
    s_nop 15
    v_max3_f32 v20, v28, v29, v30
    v_max3_f32 v20, v31, v36, v20
    v_max3_f32 v20, v37, v38, v20
    v_max_f32 v20, v39, v20
    v_mov_b32 v21, v20
    s_nop 1
    v_permlane32_swap_b32 v20, v21
    v_max_f32 v20, v20, v21
    v_mov_b32 v21, v20
    s_nop 1
    v_permlane16_swap_b32 v20, v21
    v_max_f32 v20, v20, v21
    v_ceil_f32 v20, v20
    v_max_f32 v20, 0, v20
    v_sub_f32 v21, 0, v20
    v_exp_f32 v21, v21
    v_add_f32 v11, v11, v20
    v_sub_f32 v28, v28, v20
    v_sub_f32 v29, v29, v20
    v_sub_f32 v30, v30, v20
    v_sub_f32 v31, v31, v20
    v_sub_f32 v36, v36, v20
    v_sub_f32 v37, v37, v20
    v_sub_f32 v38, v38, v20
    v_sub_f32 v39, v39, v20
    v_mul_f32 v17, v17, v21
    v_accvgpr_read_b32 v22, a112
    v_mul_f32 v22, v22, v21
    v_accvgpr_write_b32 a112, v22
    v_accvgpr_read_b32 v22, a113
    v_mul_f32 v22, v22, v21
    v_accvgpr_write_b32 a113, v22
    v_accvgpr_read_b32 v22, a114
    v_mul_f32 v22, v22, v21
    v_accvgpr_write_b32 a114, v22
    v_accvgpr_read_b32 v22, a115
    v_mul_f32 v22, v22, v21
    v_accvgpr_write_b32 a115, v22
    v_accvgpr_read_b32 v22, a116
    v_mul_f32 v22, v22, v21
    v_accvgpr_write_b32 a116, v22
    v_accvgpr_read_b32 v22, a117
    v_mul_f32 v22, v22, v21
    v_accvgpr_write_b32 a117, v22
    v_accvgpr_read_b32 v22, a118
    v_mul_f32 v22, v22, v21
    v_accvgpr_write_b32 a118, v22
    v_accvgpr_read_b32 v22, a119
    v_mul_f32 v22, v22, v21
    v_accvgpr_write_b32 a119, v22
    v_accvgpr_read_b32 v22, a120
    v_mul_f32 v22, v22, v21
    v_accvgpr_write_b32 a120, v22
    v_accvgpr_read_b32 v22, a121
    v_mul_f32 v22, v22, v21
    v_accvgpr_write_b32 a121, v22
    v_accvgpr_read_b32 v22, a122
    v_mul_f32 v22, v22, v21
    v_accvgpr_write_b32 a122, v22
    v_accvgpr_read_b32 v22, a123
    v_mul_f32 v22, v22, v21
    v_accvgpr_write_b32 a123, v22
    v_accvgpr_read_b32 v22, a124
    v_mul_f32 v22, v22, v21
    v_accvgpr_write_b32 a124, v22
    v_accvgpr_read_b32 v22, a125
    v_mul_f32 v22, v22, v21
    v_accvgpr_write_b32 a125, v22
    v_accvgpr_read_b32 v22, a126
    v_mul_f32 v22, v22, v21
    v_accvgpr_write_b32 a126, v22
    v_accvgpr_read_b32 v22, a127
    v_mul_f32 v22, v22, v21
    v_accvgpr_write_b32 a127, v22
    v_accvgpr_read_b32 v22, a128
    v_mul_f32 v22, v22, v21
    v_accvgpr_write_b32 a128, v22
    v_accvgpr_read_b32 v22, a129
    v_mul_f32 v22, v22, v21
    v_accvgpr_write_b32 a129, v22
    v_accvgpr_read_b32 v22, a130
    v_mul_f32 v22, v22, v21
    v_accvgpr_write_b32 a130, v22
    v_accvgpr_read_b32 v22, a131
    v_mul_f32 v22, v22, v21
    v_accvgpr_write_b32 a131, v22
    v_accvgpr_read_b32 v22, a132
    v_mul_f32 v22, v22, v21
    v_accvgpr_write_b32 a132, v22
    v_accvgpr_read_b32 v22, a133
    v_mul_f32 v22, v22, v21
    v_accvgpr_write_b32 a133, v22
    v_accvgpr_read_b32 v22, a134
    v_mul_f32 v22, v22, v21
    v_accvgpr_write_b32 a134, v22
    v_accvgpr_read_b32 v22, a135
    v_mul_f32 v22, v22, v21
    v_accvgpr_write_b32 a135, v22
    v_accvgpr_read_b32 v22, a136
    v_mul_f32 v22, v22, v21
    v_accvgpr_write_b32 a136, v22
    v_accvgpr_read_b32 v22, a137
    v_mul_f32 v22, v22, v21
    v_accvgpr_write_b32 a137, v22
    v_accvgpr_read_b32 v22, a138
    v_mul_f32 v22, v22, v21
    v_accvgpr_write_b32 a138, v22
    v_accvgpr_read_b32 v22, a139
    v_mul_f32 v22, v22, v21
    v_accvgpr_write_b32 a139, v22
    v_accvgpr_read_b32 v22, a140
    v_mul_f32 v22, v22, v21
    v_accvgpr_write_b32 a140, v22
    v_accvgpr_read_b32 v22, a141
    v_mul_f32 v22, v22, v21
    v_accvgpr_write_b32 a141, v22
    v_accvgpr_read_b32 v22, a142
    v_mul_f32 v22, v22, v21
    v_accvgpr_write_b32 a142, v22
    v_accvgpr_read_b32 v22, a143
    v_mul_f32 v22, v22, v21
    v_accvgpr_write_b32 a143, v22
    v_accvgpr_read_b32 v22, a144
    v_mul_f32 v22, v22, v21
    v_accvgpr_write_b32 a144, v22
    v_accvgpr_read_b32 v22, a145
    v_mul_f32 v22, v22, v21
    v_accvgpr_write_b32 a145, v22
    v_accvgpr_read_b32 v22, a146
    v_mul_f32 v22, v22, v21
    v_accvgpr_write_b32 a146, v22
    v_accvgpr_read_b32 v22, a147
    v_mul_f32 v22, v22, v21
    v_accvgpr_write_b32 a147, v22
    v_accvgpr_read_b32 v22, a148
    v_mul_f32 v22, v22, v21
    v_accvgpr_write_b32 a148, v22
    v_accvgpr_read_b32 v22, a149
    v_mul_f32 v22, v22, v21
    v_accvgpr_write_b32 a149, v22
    v_accvgpr_read_b32 v22, a150
    v_mul_f32 v22, v22, v21
    v_accvgpr_write_b32 a150, v22
    v_accvgpr_read_b32 v22, a151
    v_mul_f32 v22, v22, v21
    v_accvgpr_write_b32 a151, v22
    v_accvgpr_read_b32 v22, a152
    v_mul_f32 v22, v22, v21
    v_accvgpr_write_b32 a152, v22
    v_accvgpr_read_b32 v22, a153
    v_mul_f32 v22, v22, v21
    v_accvgpr_write_b32 a153, v22
    v_accvgpr_read_b32 v22, a154
    v_mul_f32 v22, v22, v21
    v_accvgpr_write_b32 a154, v22
    v_accvgpr_read_b32 v22, a155
    v_mul_f32 v22, v22, v21
    v_accvgpr_write_b32 a155, v22
    v_accvgpr_read_b32 v22, a156
    v_mul_f32 v22, v22, v21
    v_accvgpr_write_b32 a156, v22
    v_accvgpr_read_b32 v22, a157
    v_mul_f32 v22, v22, v21
    v_accvgpr_write_b32 a157, v22
    v_accvgpr_read_b32 v22, a158
    v_mul_f32 v22, v22, v21
    v_accvgpr_write_b32 a158, v22
    v_accvgpr_read_b32 v22, a159
    v_mul_f32 v22, v22, v21
    v_accvgpr_write_b32 a159, v22
    v_max3_f32 v20, v44, v45, v46
    v_max3_f32 v20, v47, v52, v20
    v_max3_f32 v20, v53, v54, v20
    v_max_f32 v20, v55, v20
    v_mov_b32 v21, v20
    s_nop 1
    v_permlane32_swap_b32 v20, v21
    v_max_f32 v20, v20, v21
    v_mov_b32 v21, v20
    s_nop 1
    v_permlane16_swap_b32 v20, v21
    v_max_f32 v20, v20, v21
    v_ceil_f32 v20, v20
    v_max_f32 v20, 0, v20
    v_sub_f32 v21, 0, v20
    v_exp_f32 v21, v21
    v_add_f32 v12, v12, v20
    v_sub_f32 v44, v44, v20
    v_sub_f32 v45, v45, v20
    v_sub_f32 v46, v46, v20
    v_sub_f32 v47, v47, v20
    v_sub_f32 v52, v52, v20
    v_sub_f32 v53, v53, v20
    v_sub_f32 v54, v54, v20
    v_sub_f32 v55, v55, v20
    v_mul_f32 v18, v18, v21
    v_accvgpr_read_b32 v22, a160
    v_mul_f32 v22, v22, v21
    v_accvgpr_write_b32 a160, v22
    v_accvgpr_read_b32 v22, a161
    v_mul_f32 v22, v22, v21
    v_accvgpr_write_b32 a161, v22
    v_accvgpr_read_b32 v22, a162
    v_mul_f32 v22, v22, v21
    v_accvgpr_write_b32 a162, v22
    v_accvgpr_read_b32 v22, a163
    v_mul_f32 v22, v22, v21
    v_accvgpr_write_b32 a163, v22
    v_accvgpr_read_b32 v22, a164
    v_mul_f32 v22, v22, v21
    v_accvgpr_write_b32 a164, v22
    v_accvgpr_read_b32 v22, a165
    v_mul_f32 v22, v22, v21
    v_accvgpr_write_b32 a165, v22
    v_accvgpr_read_b32 v22, a166
    v_mul_f32 v22, v22, v21
    v_accvgpr_write_b32 a166, v22
    v_accvgpr_read_b32 v22, a167
    v_mul_f32 v22, v22, v21
    v_accvgpr_write_b32 a167, v22
    v_accvgpr_read_b32 v22, a168
    v_mul_f32 v22, v22, v21
    v_accvgpr_write_b32 a168, v22
    v_accvgpr_read_b32 v22, a169
    v_mul_f32 v22, v22, v21
    v_accvgpr_write_b32 a169, v22
    v_accvgpr_read_b32 v22, a170
    v_mul_f32 v22, v22, v21
    v_accvgpr_write_b32 a170, v22
    v_accvgpr_read_b32 v22, a171
    v_mul_f32 v22, v22, v21
    v_accvgpr_write_b32 a171, v22
    v_accvgpr_read_b32 v22, a172
    v_mul_f32 v22, v22, v21
    v_accvgpr_write_b32 a172, v22
    v_accvgpr_read_b32 v22, a173
    v_mul_f32 v22, v22, v21
    v_accvgpr_write_b32 a173, v22
    v_accvgpr_read_b32 v22, a174
    v_mul_f32 v22, v22, v21
    v_accvgpr_write_b32 a174, v22
    v_accvgpr_read_b32 v22, a175
    v_mul_f32 v22, v22, v21
    v_accvgpr_write_b32 a175, v22
    v_accvgpr_read_b32 v22, a176
    v_mul_f32 v22, v22, v21
    v_accvgpr_write_b32 a176, v22
    v_accvgpr_read_b32 v22, a177
    v_mul_f32 v22, v22, v21
    v_accvgpr_write_b32 a177, v22
    v_accvgpr_read_b32 v22, a178
    v_mul_f32 v22, v22, v21
    v_accvgpr_write_b32 a178, v22
    v_accvgpr_read_b32 v22, a179
    v_mul_f32 v22, v22, v21
    v_accvgpr_write_b32 a179, v22
    v_accvgpr_read_b32 v22, a180
    v_mul_f32 v22, v22, v21
    v_accvgpr_write_b32 a180, v22
    v_accvgpr_read_b32 v22, a181
    v_mul_f32 v22, v22, v21
    v_accvgpr_write_b32 a181, v22
    v_accvgpr_read_b32 v22, a182
    v_mul_f32 v22, v22, v21
    v_accvgpr_write_b32 a182, v22
    v_accvgpr_read_b32 v22, a183
    v_mul_f32 v22, v22, v21
    v_accvgpr_write_b32 a183, v22
    v_accvgpr_read_b32 v22, a184
    v_mul_f32 v22, v22, v21
    v_accvgpr_write_b32 a184, v22
    v_accvgpr_read_b32 v22, a185
    v_mul_f32 v22, v22, v21
    v_accvgpr_write_b32 a185, v22
    v_accvgpr_read_b32 v22, a186
    v_mul_f32 v22, v22, v21
    v_accvgpr_write_b32 a186, v22
    v_accvgpr_read_b32 v22, a187
    v_mul_f32 v22, v22, v21
    v_accvgpr_write_b32 a187, v22
    v_accvgpr_read_b32 v22, a188
    v_mul_f32 v22, v22, v21
    v_accvgpr_write_b32 a188, v22
    v_accvgpr_read_b32 v22, a189
    v_mul_f32 v22, v22, v21
    v_accvgpr_write_b32 a189, v22
    v_accvgpr_read_b32 v22, a190
    v_mul_f32 v22, v22, v21
    v_accvgpr_write_b32 a190, v22
    v_accvgpr_read_b32 v22, a191
    v_mul_f32 v22, v22, v21
    v_accvgpr_write_b32 a191, v22
    v_accvgpr_read_b32 v22, a192
    v_mul_f32 v22, v22, v21
    v_accvgpr_write_b32 a192, v22
    v_accvgpr_read_b32 v22, a193
    v_mul_f32 v22, v22, v21
    v_accvgpr_write_b32 a193, v22
    v_accvgpr_read_b32 v22, a194
    v_mul_f32 v22, v22, v21
    v_accvgpr_write_b32 a194, v22
    v_accvgpr_read_b32 v22, a195
    v_mul_f32 v22, v22, v21
    v_accvgpr_write_b32 a195, v22
    v_accvgpr_read_b32 v22, a196
    v_mul_f32 v22, v22, v21
    v_accvgpr_write_b32 a196, v22
    v_accvgpr_read_b32 v22, a197
    v_mul_f32 v22, v22, v21
    v_accvgpr_write_b32 a197, v22
    v_accvgpr_read_b32 v22, a198
    v_mul_f32 v22, v22, v21
    v_accvgpr_write_b32 a198, v22
    v_accvgpr_read_b32 v22, a199
    v_mul_f32 v22, v22, v21
    v_accvgpr_write_b32 a199, v22
    v_accvgpr_read_b32 v22, a200
    v_mul_f32 v22, v22, v21
    v_accvgpr_write_b32 a200, v22
    v_accvgpr_read_b32 v22, a201
    v_mul_f32 v22, v22, v21
    v_accvgpr_write_b32 a201, v22
    v_accvgpr_read_b32 v22, a202
    v_mul_f32 v22, v22, v21
    v_accvgpr_write_b32 a202, v22
    v_accvgpr_read_b32 v22, a203
    v_mul_f32 v22, v22, v21
    v_accvgpr_write_b32 a203, v22
    v_accvgpr_read_b32 v22, a204
    v_mul_f32 v22, v22, v21
    v_accvgpr_write_b32 a204, v22
    v_accvgpr_read_b32 v22, a205
    v_mul_f32 v22, v22, v21
    v_accvgpr_write_b32 a205, v22
    v_accvgpr_read_b32 v22, a206
    v_mul_f32 v22, v22, v21
    v_accvgpr_write_b32 a206, v22
    v_accvgpr_read_b32 v22, a207
    v_mul_f32 v22, v22, v21
    v_accvgpr_write_b32 a207, v22
    v_max3_f32 v20, v60, v61, v62
    v_max3_f32 v20, v63, v68, v20
    v_max3_f32 v20, v69, v70, v20
    v_max_f32 v20, v71, v20
    v_mov_b32 v21, v20
    s_nop 1
    v_permlane32_swap_b32 v20, v21
    v_max_f32 v20, v20, v21
    v_mov_b32 v21, v20
    s_nop 1
    v_permlane16_swap_b32 v20, v21
    v_max_f32 v20, v20, v21
    v_ceil_f32 v20, v20
    v_max_f32 v20, 0, v20
    v_sub_f32 v21, 0, v20
    v_exp_f32 v21, v21
    v_add_f32 v13, v13, v20
    v_sub_f32 v60, v60, v20
    v_sub_f32 v61, v61, v20
    v_sub_f32 v62, v62, v20
    v_sub_f32 v63, v63, v20
    v_sub_f32 v68, v68, v20
    v_sub_f32 v69, v69, v20
    v_sub_f32 v70, v70, v20
    v_sub_f32 v71, v71, v20
    v_mul_f32 v19, v19, v21
    v_accvgpr_read_b32 v22, a208
    v_mul_f32 v22, v22, v21
    v_accvgpr_write_b32 a208, v22
    v_accvgpr_read_b32 v22, a209
    v_mul_f32 v22, v22, v21
    v_accvgpr_write_b32 a209, v22
    v_accvgpr_read_b32 v22, a210
    v_mul_f32 v22, v22, v21
    v_accvgpr_write_b32 a210, v22
    v_accvgpr_read_b32 v22, a211
    v_mul_f32 v22, v22, v21
    v_accvgpr_write_b32 a211, v22
    v_accvgpr_read_b32 v22, a212
    v_mul_f32 v22, v22, v21
    v_accvgpr_write_b32 a212, v22
    v_accvgpr_read_b32 v22, a213
    v_mul_f32 v22, v22, v21
    v_accvgpr_write_b32 a213, v22
    v_accvgpr_read_b32 v22, a214
    v_mul_f32 v22, v22, v21
    v_accvgpr_write_b32 a214, v22
    v_accvgpr_read_b32 v22, a215
    v_mul_f32 v22, v22, v21
    v_accvgpr_write_b32 a215, v22
    v_accvgpr_read_b32 v22, a216
    v_mul_f32 v22, v22, v21
    v_accvgpr_write_b32 a216, v22
    v_accvgpr_read_b32 v22, a217
    v_mul_f32 v22, v22, v21
    v_accvgpr_write_b32 a217, v22
    v_accvgpr_read_b32 v22, a218
    v_mul_f32 v22, v22, v21
    v_accvgpr_write_b32 a218, v22
    v_accvgpr_read_b32 v22, a219
    v_mul_f32 v22, v22, v21
    v_accvgpr_write_b32 a219, v22
    v_accvgpr_read_b32 v22, a220
    v_mul_f32 v22, v22, v21
    v_accvgpr_write_b32 a220, v22
    v_accvgpr_read_b32 v22, a221
    v_mul_f32 v22, v22, v21
    v_accvgpr_write_b32 a221, v22
    v_accvgpr_read_b32 v22, a222
    v_mul_f32 v22, v22, v21
    v_accvgpr_write_b32 a222, v22
    v_accvgpr_read_b32 v22, a223
    v_mul_f32 v22, v22, v21
    v_accvgpr_write_b32 a223, v22
    v_accvgpr_read_b32 v22, a224
    v_mul_f32 v22, v22, v21
    v_accvgpr_write_b32 a224, v22
    v_accvgpr_read_b32 v22, a225
    v_mul_f32 v22, v22, v21
    v_accvgpr_write_b32 a225, v22
    v_accvgpr_read_b32 v22, a226
    v_mul_f32 v22, v22, v21
    v_accvgpr_write_b32 a226, v22
    v_accvgpr_read_b32 v22, a227
    v_mul_f32 v22, v22, v21
    v_accvgpr_write_b32 a227, v22
    v_accvgpr_read_b32 v22, a228
    v_mul_f32 v22, v22, v21
    v_accvgpr_write_b32 a228, v22
    v_accvgpr_read_b32 v22, a229
    v_mul_f32 v22, v22, v21
    v_accvgpr_write_b32 a229, v22
    v_accvgpr_read_b32 v22, a230
    v_mul_f32 v22, v22, v21
    v_accvgpr_write_b32 a230, v22
    v_accvgpr_read_b32 v22, a231
    v_mul_f32 v22, v22, v21
    v_accvgpr_write_b32 a231, v22
    v_accvgpr_read_b32 v22, a232
    v_mul_f32 v22, v22, v21
    v_accvgpr_write_b32 a232, v22
    v_accvgpr_read_b32 v22, a233
    v_mul_f32 v22, v22, v21
    v_accvgpr_write_b32 a233, v22
    v_accvgpr_read_b32 v22, a234
    v_mul_f32 v22, v22, v21
    v_accvgpr_write_b32 a234, v22
    v_accvgpr_read_b32 v22, a235
    v_mul_f32 v22, v22, v21
    v_accvgpr_write_b32 a235, v22
    v_accvgpr_read_b32 v22, a236
    v_mul_f32 v22, v22, v21
    v_accvgpr_write_b32 a236, v22
    v_accvgpr_read_b32 v22, a237
    v_mul_f32 v22, v22, v21
    v_accvgpr_write_b32 a237, v22
    v_accvgpr_read_b32 v22, a238
    v_mul_f32 v22, v22, v21
    v_accvgpr_write_b32 a238, v22
    v_accvgpr_read_b32 v22, a239
    v_mul_f32 v22, v22, v21
    v_accvgpr_write_b32 a239, v22
    v_accvgpr_read_b32 v22, a240
    v_mul_f32 v22, v22, v21
    v_accvgpr_write_b32 a240, v22
    v_accvgpr_read_b32 v22, a241
    v_mul_f32 v22, v22, v21
    v_accvgpr_write_b32 a241, v22
    v_accvgpr_read_b32 v22, a242
    v_mul_f32 v22, v22, v21
    v_accvgpr_write_b32 a242, v22
    v_accvgpr_read_b32 v22, a243
    v_mul_f32 v22, v22, v21
    v_accvgpr_write_b32 a243, v22
    v_accvgpr_read_b32 v22, a244
    v_mul_f32 v22, v22, v21
    v_accvgpr_write_b32 a244, v22
    v_accvgpr_read_b32 v22, a245
    v_mul_f32 v22, v22, v21
    v_accvgpr_write_b32 a245, v22
    v_accvgpr_read_b32 v22, a246
    v_mul_f32 v22, v22, v21
    v_accvgpr_write_b32 a246, v22
    v_accvgpr_read_b32 v22, a247
    v_mul_f32 v22, v22, v21
    v_accvgpr_write_b32 a247, v22
    v_accvgpr_read_b32 v22, a248
    v_mul_f32 v22, v22, v21
    v_accvgpr_write_b32 a248, v22
    v_accvgpr_read_b32 v22, a249
    v_mul_f32 v22, v22, v21
    v_accvgpr_write_b32 a249, v22
    v_accvgpr_read_b32 v22, a250
    v_mul_f32 v22, v22, v21
    v_accvgpr_write_b32 a250, v22
    v_accvgpr_read_b32 v22, a251
    v_mul_f32 v22, v22, v21
    v_accvgpr_write_b32 a251, v22
    v_accvgpr_read_b32 v22, a252
    v_mul_f32 v22, v22, v21
    v_accvgpr_write_b32 a252, v22
    v_accvgpr_read_b32 v22, a253
    v_mul_f32 v22, v22, v21
    v_accvgpr_write_b32 a253, v22
    v_accvgpr_read_b32 v22, a254
    v_mul_f32 v22, v22, v21
    v_accvgpr_write_b32 a254, v22
    v_accvgpr_read_b32 v22, a255
    v_mul_f32 v22, v22, v21
    v_accvgpr_write_b32 a255, v22
    s_nop 1
    s_branch S_back_late0
S_rare_late1:
    s_nop 15
    v_max3_f32 v20, v32, v33, v34
    v_max3_f32 v20, v35, v40, v20
    v_max3_f32 v20, v41, v42, v20
    v_max_f32 v20, v43, v20
    v_mov_b32 v21, v20
    s_nop 1
    v_permlane32_swap_b32 v20, v21
    v_max_f32 v20, v20, v21
    v_mov_b32 v21, v20
    s_nop 1
    v_permlane16_swap_b32 v20, v21
    v_max_f32 v20, v20, v21
    v_ceil_f32 v20, v20
    v_max_f32 v20, 0, v20
    v_sub_f32 v21, 0, v20
    v_exp_f32 v21, v21
    v_add_f32 v11, v11, v20
    v_sub_f32 v32, v32, v20
    v_sub_f32 v33, v33, v20
    v_sub_f32 v34, v34, v20
    v_sub_f32 v35, v35, v20
    v_sub_f32 v40, v40, v20
    v_sub_f32 v41, v41, v20
    v_sub_f32 v42, v42, v20
    v_sub_f32 v43, v43, v20
    v_mul_f32 v17, v17, v21
    v_accvgpr_read_b32 v22, a112
    v_mul_f32 v22, v22, v21
    v_accvgpr_write_b32 a112, v22
    v_accvgpr_read_b32 v22, a113
    v_mul_f32 v22, v22, v21
    v_accvgpr_write_b32 a113, v22
    v_accvgpr_read_b32 v22, a114
    v_mul_f32 v22, v22, v21
    v_accvgpr_write_b32 a114, v22
    v_accvgpr_read_b32 v22, a115
    v_mul_f32 v22, v22, v21
    v_accvgpr_write_b32 a115, v22
    v_accvgpr_read_b32 v22, a116
    v_mul_f32 v22, v22, v21
    v_accvgpr_write_b32 a116, v22
    v_accvgpr_read_b32 v22, a117
    v_mul_f32 v22, v22, v21
    v_accvgpr_write_b32 a117, v22
    v_accvgpr_read_b32 v22, a118
    v_mul_f32 v22, v22, v21
    v_accvgpr_write_b32 a118, v22
    v_accvgpr_read_b32 v22, a119
    v_mul_f32 v22, v22, v21
    v_accvgpr_write_b32 a119, v22
    v_accvgpr_read_b32 v22, a120
    v_mul_f32 v22, v22, v21
    v_accvgpr_write_b32 a120, v22
    v_accvgpr_read_b32 v22, a121
    v_mul_f32 v22, v22, v21
    v_accvgpr_write_b32 a121, v22
    v_accvgpr_read_b32 v22, a122
    v_mul_f32 v22, v22, v21
    v_accvgpr_write_b32 a122, v22
    v_accvgpr_read_b32 v22, a123
    v_mul_f32 v22, v22, v21
    v_accvgpr_write_b32 a123, v22
    v_accvgpr_read_b32 v22, a124
    v_mul_f32 v22, v22, v21
    v_accvgpr_write_b32 a124, v22
    v_accvgpr_read_b32 v22, a125
    v_mul_f32 v22, v22, v21
    v_accvgpr_write_b32 a125, v22
    v_accvgpr_read_b32 v22, a126
    v_mul_f32 v22, v22, v21
    v_accvgpr_write_b32 a126, v22
    v_accvgpr_read_b32 v22, a127
    v_mul_f32 v22, v22, v21
    v_accvgpr_write_b32 a127, v22
    v_accvgpr_read_b32 v22, a128
    v_mul_f32 v22, v22, v21
    v_accvgpr_write_b32 a128, v22
    v_accvgpr_read_b32 v22, a129
    v_mul_f32 v22, v22, v21
    v_accvgpr_write_b32 a129, v22
    v_accvgpr_read_b32 v22, a130
    v_mul_f32 v22, v22, v21
    v_accvgpr_write_b32 a130, v22
    v_accvgpr_read_b32 v22, a131
    v_mul_f32 v22, v22, v21
    v_accvgpr_write_b32 a131, v22
    v_accvgpr_read_b32 v22, a132
    v_mul_f32 v22, v22, v21
    v_accvgpr_write_b32 a132, v22
    v_accvgpr_read_b32 v22, a133
    v_mul_f32 v22, v22, v21
    v_accvgpr_write_b32 a133, v22
    v_accvgpr_read_b32 v22, a134
    v_mul_f32 v22, v22, v21
    v_accvgpr_write_b32 a134, v22
    v_accvgpr_read_b32 v22, a135
    v_mul_f32 v22, v22, v21
    v_accvgpr_write_b32 a135, v22
    v_accvgpr_read_b32 v22, a136
    v_mul_f32 v22, v22, v21
    v_accvgpr_write_b32 a136, v22
    v_accvgpr_read_b32 v22, a137
    v_mul_f32 v22, v22, v21
    v_accvgpr_write_b32 a137, v22
    v_accvgpr_read_b32 v22, a138
    v_mul_f32 v22, v22, v21
    v_accvgpr_write_b32 a138, v22
    v_accvgpr_read_b32 v22, a139
    v_mul_f32 v22, v22, v21
    v_accvgpr_write_b32 a139, v22
    v_accvgpr_read_b32 v22, a140
    v_mul_f32 v22, v22, v21
    v_accvgpr_write_b32 a140, v22
    v_accvgpr_read_b32 v22, a141
    v_mul_f32 v22, v22, v21
    v_accvgpr_write_b32 a141, v22
    v_accvgpr_read_b32 v22, a142
    v_mul_f32 v22, v22, v21
    v_accvgpr_write_b32 a142, v22
    v_accvgpr_read_b32 v22, a143
    v_mul_f32 v22, v22, v21
    v_accvgpr_write_b32 a143, v22
    v_accvgpr_read_b32 v22, a144
    v_mul_f32 v22, v22, v21
    v_accvgpr_write_b32 a144, v22
    v_accvgpr_read_b32 v22, a145
    v_mul_f32 v22, v22, v21
    v_accvgpr_write_b32 a145, v22
    v_accvgpr_read_b32 v22, a146
    v_mul_f32 v22, v22, v21
    v_accvgpr_write_b32 a146, v22
    v_accvgpr_read_b32 v22, a147
    v_mul_f32 v22, v22, v21
    v_accvgpr_write_b32 a147, v22
    v_accvgpr_read_b32 v22, a148
    v_mul_f32 v22, v22, v21
    v_accvgpr_write_b32 a148, v22
    v_accvgpr_read_b32 v22, a149
    v_mul_f32 v22, v22, v21
    v_accvgpr_write_b32 a149, v22
    v_accvgpr_read_b32 v22, a150
    v_mul_f32 v22, v22, v21
    v_accvgpr_write_b32 a150, v22
    v_accvgpr_read_b32 v22, a151
    v_mul_f32 v22, v22, v21
    v_accvgpr_write_b32 a151, v22
    v_accvgpr_read_b32 v22, a152
    v_mul_f32 v22, v22, v21
    v_accvgpr_write_b32 a152, v22
    v_accvgpr_read_b32 v22, a153
    v_mul_f32 v22, v22, v21
    v_accvgpr_write_b32 a153, v22
    v_accvgpr_read_b32 v22, a154
    v_mul_f32 v22, v22, v21
    v_accvgpr_write_b32 a154, v22
    v_accvgpr_read_b32 v22, a155
    v_mul_f32 v22, v22, v21
    v_accvgpr_write_b32 a155, v22
    v_accvgpr_read_b32 v22, a156
    v_mul_f32 v22, v22, v21
    v_accvgpr_write_b32 a156, v22
    v_accvgpr_read_b32 v22, a157
    v_mul_f32 v22, v22, v21
    v_accvgpr_write_b32 a157, v22
    v_accvgpr_read_b32 v22, a158
    v_mul_f32 v22, v22, v21
    v_accvgpr_write_b32 a158, v22
    v_accvgpr_read_b32 v22, a159
    v_mul_f32 v22, v22, v21
    v_accvgpr_write_b32 a159, v22
    v_max3_f32 v20, v48, v49, v50
    v_max3_f32 v20, v51, v56, v20
    v_max3_f32 v20, v57, v58, v20
    v_max_f32 v20, v59, v20
    v_mov_b32 v21, v20
    s_nop 1
    v_permlane32_swap_b32 v20, v21
    v_max_f32 v20, v20, v21
    v_mov_b32 v21, v20
    s_nop 1
    v_permlane16_swap_b32 v20, v21
    v_max_f32 v20, v20, v21
    v_ceil_f32 v20, v20
    v_max_f32 v20, 0, v20
    v_sub_f32 v21, 0, v20
    v_exp_f32 v21, v21
    v_add_f32 v12, v12, v20
    v_sub_f32 v48, v48, v20
    v_sub_f32 v49, v49, v20
    v_sub_f32 v50, v50, v20
    v_sub_f32 v51, v51, v20
    v_sub_f32 v56, v56, v20
    v_sub_f32 v57, v57, v20
    v_sub_f32 v58, v58, v20
    v_sub_f32 v59, v59, v20
    v_mul_f32 v18, v18, v21
    v_accvgpr_read_b32 v22, a160
    v_mul_f32 v22, v22, v21
    v_accvgpr_write_b32 a160, v22
    v_accvgpr_read_b32 v22, a161
    v_mul_f32 v22, v22, v21
    v_accvgpr_write_b32 a161, v22
    v_accvgpr_read_b32 v22, a162
    v_mul_f32 v22, v22, v21
    v_accvgpr_write_b32 a162, v22
    v_accvgpr_read_b32 v22, a163
    v_mul_f32 v22, v22, v21
    v_accvgpr_write_b32 a163, v22
    v_accvgpr_read_b32 v22, a164
    v_mul_f32 v22, v22, v21
    v_accvgpr_write_b32 a164, v22
    v_accvgpr_read_b32 v22, a165
    v_mul_f32 v22, v22, v21
    v_accvgpr_write_b32 a165, v22
    v_accvgpr_read_b32 v22, a166
    v_mul_f32 v22, v22, v21
    v_accvgpr_write_b32 a166, v22
    v_accvgpr_read_b32 v22, a167
    v_mul_f32 v22, v22, v21
    v_accvgpr_write_b32 a167, v22
    v_accvgpr_read_b32 v22, a168
    v_mul_f32 v22, v22, v21
    v_accvgpr_write_b32 a168, v22
    v_accvgpr_read_b32 v22, a169
    v_mul_f32 v22, v22, v21
    v_accvgpr_write_b32 a169, v22
    v_accvgpr_read_b32 v22, a170
    v_mul_f32 v22, v22, v21
    v_accvgpr_write_b32 a170, v22
    v_accvgpr_read_b32 v22, a171
    v_mul_f32 v22, v22, v21
    v_accvgpr_write_b32 a171, v22
    v_accvgpr_read_b32 v22, a172
    v_mul_f32 v22, v22, v21
    v_accvgpr_write_b32 a172, v22
    v_accvgpr_read_b32 v22, a173
    v_mul_f32 v22, v22, v21
    v_accvgpr_write_b32 a173, v22
    v_accvgpr_read_b32 v22, a174
    v_mul_f32 v22, v22, v21
    v_accvgpr_write_b32 a174, v22
    v_accvgpr_read_b32 v22, a175
    v_mul_f32 v22, v22, v21
    v_accvgpr_write_b32 a175, v22
    v_accvgpr_read_b32 v22, a176
    v_mul_f32 v22, v22, v21
    v_accvgpr_write_b32 a176, v22
    v_accvgpr_read_b32 v22, a177
    v_mul_f32 v22, v22, v21
    v_accvgpr_write_b32 a177, v22
    v_accvgpr_read_b32 v22, a178
    v_mul_f32 v22, v22, v21
    v_accvgpr_write_b32 a178, v22
    v_accvgpr_read_b32 v22, a179
    v_mul_f32 v22, v22, v21
    v_accvgpr_write_b32 a179, v22
    v_accvgpr_read_b32 v22, a180
    v_mul_f32 v22, v22, v21
    v_accvgpr_write_b32 a180, v22
    v_accvgpr_read_b32 v22, a181
    v_mul_f32 v22, v22, v21
    v_accvgpr_write_b32 a181, v22
    v_accvgpr_read_b32 v22, a182
    v_mul_f32 v22, v22, v21
    v_accvgpr_write_b32 a182, v22
    v_accvgpr_read_b32 v22, a183
    v_mul_f32 v22, v22, v21
    v_accvgpr_write_b32 a183, v22
    v_accvgpr_read_b32 v22, a184
    v_mul_f32 v22, v22, v21
    v_accvgpr_write_b32 a184, v22
    v_accvgpr_read_b32 v22, a185
    v_mul_f32 v22, v22, v21
    v_accvgpr_write_b32 a185, v22
    v_accvgpr_read_b32 v22, a186
    v_mul_f32 v22, v22, v21
    v_accvgpr_write_b32 a186, v22
    v_accvgpr_read_b32 v22, a187
    v_mul_f32 v22, v22, v21
    v_accvgpr_write_b32 a187, v22
    v_accvgpr_read_b32 v22, a188
    v_mul_f32 v22, v22, v21
    v_accvgpr_write_b32 a188, v22
    v_accvgpr_read_b32 v22, a189
    v_mul_f32 v22, v22, v21
    v_accvgpr_write_b32 a189, v22
    v_accvgpr_read_b32 v22, a190
    v_mul_f32 v22, v22, v21
    v_accvgpr_write_b32 a190, v22
    v_accvgpr_read_b32 v22, a191
    v_mul_f32 v22, v22, v21
    v_accvgpr_write_b32 a191, v22
    v_accvgpr_read_b32 v22, a192
    v_mul_f32 v22, v22, v21
    v_accvgpr_write_b32 a192, v22
    v_accvgpr_read_b32 v22, a193
    v_mul_f32 v22, v22, v21
    v_accvgpr_write_b32 a193, v22
    v_accvgpr_read_b32 v22, a194
    v_mul_f32 v22, v22, v21
    v_accvgpr_write_b32 a194, v22
    v_accvgpr_read_b32 v22, a195
    v_mul_f32 v22, v22, v21
    v_accvgpr_write_b32 a195, v22
    v_accvgpr_read_b32 v22, a196
    v_mul_f32 v22, v22, v21
    v_accvgpr_write_b32 a196, v22
    v_accvgpr_read_b32 v22, a197
    v_mul_f32 v22, v22, v21
    v_accvgpr_write_b32 a197, v22
    v_accvgpr_read_b32 v22, a198
    v_mul_f32 v22, v22, v21
    v_accvgpr_write_b32 a198, v22
    v_accvgpr_read_b32 v22, a199
    v_mul_f32 v22, v22, v21
    v_accvgpr_write_b32 a199, v22
    v_accvgpr_read_b32 v22, a200
    v_mul_f32 v22, v22, v21
    v_accvgpr_write_b32 a200, v22
    v_accvgpr_read_b32 v22, a201
    v_mul_f32 v22, v22, v21
    v_accvgpr_write_b32 a201, v22
    v_accvgpr_read_b32 v22, a202
    v_mul_f32 v22, v22, v21
    v_accvgpr_write_b32 a202, v22
    v_accvgpr_read_b32 v22, a203
    v_mul_f32 v22, v22, v21
    v_accvgpr_write_b32 a203, v22
    v_accvgpr_read_b32 v22, a204
    v_mul_f32 v22, v22, v21
    v_accvgpr_write_b32 a204, v22
    v_accvgpr_read_b32 v22, a205
    v_mul_f32 v22, v22, v21
    v_accvgpr_write_b32 a205, v22
    v_accvgpr_read_b32 v22, a206
    v_mul_f32 v22, v22, v21
    v_accvgpr_write_b32 a206, v22
    v_accvgpr_read_b32 v22, a207
    v_mul_f32 v22, v22, v21
    v_accvgpr_write_b32 a207, v22
    v_max3_f32 v20, v64, v65, v66
    v_max3_f32 v20, v67, v72, v20
    v_max3_f32 v20, v73, v74, v20
    v_max_f32 v20, v75, v20
    v_mov_b32 v21, v20
    s_nop 1
    v_permlane32_swap_b32 v20, v21
    v_max_f32 v20, v20, v21
    v_mov_b32 v21, v20
    s_nop 1
    v_permlane16_swap_b32 v20, v21
    v_max_f32 v20, v20, v21
    v_ceil_f32 v20, v20
    v_max_f32 v20, 0, v20
    v_sub_f32 v21, 0, v20
    v_exp_f32 v21, v21
    v_add_f32 v13, v13, v20
    v_sub_f32 v64, v64, v20
    v_sub_f32 v65, v65, v20
    v_sub_f32 v66, v66, v20
    v_sub_f32 v67, v67, v20
    v_sub_f32 v72, v72, v20
    v_sub_f32 v73, v73, v20
    v_sub_f32 v74, v74, v20
    v_sub_f32 v75, v75, v20
    v_mul_f32 v19, v19, v21
    v_accvgpr_read_b32 v22, a208
    v_mul_f32 v22, v22, v21
    v_accvgpr_write_b32 a208, v22
    v_accvgpr_read_b32 v22, a209
    v_mul_f32 v22, v22, v21
    v_accvgpr_write_b32 a209, v22
    v_accvgpr_read_b32 v22, a210
    v_mul_f32 v22, v22, v21
    v_accvgpr_write_b32 a210, v22
    v_accvgpr_read_b32 v22, a211
    v_mul_f32 v22, v22, v21
    v_accvgpr_write_b32 a211, v22
    v_accvgpr_read_b32 v22, a212
    v_mul_f32 v22, v22, v21
    v_accvgpr_write_b32 a212, v22
    v_accvgpr_read_b32 v22, a213
    v_mul_f32 v22, v22, v21
    v_accvgpr_write_b32 a213, v22
    v_accvgpr_read_b32 v22, a214
    v_mul_f32 v22, v22, v21
    v_accvgpr_write_b32 a214, v22
    v_accvgpr_read_b32 v22, a215
    v_mul_f32 v22, v22, v21
    v_accvgpr_write_b32 a215, v22
    v_accvgpr_read_b32 v22, a216
    v_mul_f32 v22, v22, v21
    v_accvgpr_write_b32 a216, v22
    v_accvgpr_read_b32 v22, a217
    v_mul_f32 v22, v22, v21
    v_accvgpr_write_b32 a217, v22
    v_accvgpr_read_b32 v22, a218
    v_mul_f32 v22, v22, v21
    v_accvgpr_write_b32 a218, v22
    v_accvgpr_read_b32 v22, a219
    v_mul_f32 v22, v22, v21
    v_accvgpr_write_b32 a219, v22
    v_accvgpr_read_b32 v22, a220
    v_mul_f32 v22, v22, v21
    v_accvgpr_write_b32 a220, v22
    v_accvgpr_read_b32 v22, a221
    v_mul_f32 v22, v22, v21
    v_accvgpr_write_b32 a221, v22
    v_accvgpr_read_b32 v22, a222
    v_mul_f32 v22, v22, v21
    v_accvgpr_write_b32 a222, v22
    v_accvgpr_read_b32 v22, a223
    v_mul_f32 v22, v22, v21
    v_accvgpr_write_b32 a223, v22
    v_accvgpr_read_b32 v22, a224
    v_mul_f32 v22, v22, v21
    v_accvgpr_write_b32 a224, v22
    v_accvgpr_read_b32 v22, a225
    v_mul_f32 v22, v22, v21
    v_accvgpr_write_b32 a225, v22
    v_accvgpr_read_b32 v22, a226
    v_mul_f32 v22, v22, v21
    v_accvgpr_write_b32 a226, v22
    v_accvgpr_read_b32 v22, a227
    v_mul_f32 v22, v22, v21
    v_accvgpr_write_b32 a227, v22
    v_accvgpr_read_b32 v22, a228
    v_mul_f32 v22, v22, v21
    v_accvgpr_write_b32 a228, v22
    v_accvgpr_read_b32 v22, a229
    v_mul_f32 v22, v22, v21
    v_accvgpr_write_b32 a229, v22
    v_accvgpr_read_b32 v22, a230
    v_mul_f32 v22, v22, v21
    v_accvgpr_write_b32 a230, v22
    v_accvgpr_read_b32 v22, a231
    v_mul_f32 v22, v22, v21
    v_accvgpr_write_b32 a231, v22
    v_accvgpr_read_b32 v22, a232
    v_mul_f32 v22, v22, v21
    v_accvgpr_write_b32 a232, v22
    v_accvgpr_read_b32 v22, a233
    v_mul_f32 v22, v22, v21
    v_accvgpr_write_b32 a233, v22
    v_accvgpr_read_b32 v22, a234
    v_mul_f32 v22, v22, v21
    v_accvgpr_write_b32 a234, v22
    v_accvgpr_read_b32 v22, a235
    v_mul_f32 v22, v22, v21
    v_accvgpr_write_b32 a235, v22
    v_accvgpr_read_b32 v22, a236
    v_mul_f32 v22, v22, v21
    v_accvgpr_write_b32 a236, v22
    v_accvgpr_read_b32 v22, a237
    v_mul_f32 v22, v22, v21
    v_accvgpr_write_b32 a237, v22
    v_accvgpr_read_b32 v22, a238
    v_mul_f32 v22, v22, v21
    v_accvgpr_write_b32 a238, v22
    v_accvgpr_read_b32 v22, a239
    v_mul_f32 v22, v22, v21
    v_accvgpr_write_b32 a239, v22
    v_accvgpr_read_b32 v22, a240
    v_mul_f32 v22, v22, v21
    v_accvgpr_write_b32 a240, v22
    v_accvgpr_read_b32 v22, a241
    v_mul_f32 v22, v22, v21
    v_accvgpr_write_b32 a241, v22
    v_accvgpr_read_b32 v22, a242
    v_mul_f32 v22, v22, v21
    v_accvgpr_write_b32 a242, v22
    v_accvgpr_read_b32 v22, a243
    v_mul_f32 v22, v22, v21
    v_accvgpr_write_b32 a243, v22
    v_accvgpr_read_b32 v22, a244
    v_mul_f32 v22, v22, v21
    v_accvgpr_write_b32 a244, v22
    v_accvgpr_read_b32 v22, a245
    v_mul_f32 v22, v22, v21
    v_accvgpr_write_b32 a245, v22
    v_accvgpr_read_b32 v22, a246
    v_mul_f32 v22, v22, v21
    v_accvgpr_write_b32 a246, v22
    v_accvgpr_read_b32 v22, a247
    v_mul_f32 v22, v22, v21
    v_accvgpr_write_b32 a247, v22
    v_accvgpr_read_b32 v22, a248
    v_mul_f32 v22, v22, v21
    v_accvgpr_write_b32 a248, v22
    v_accvgpr_read_b32 v22, a249
    v_mul_f32 v22, v22, v21
    v_accvgpr_write_b32 a249, v22
    v_accvgpr_read_b32 v22, a250
    v_mul_f32 v22, v22, v21
    v_accvgpr_write_b32 a250, v22
    v_accvgpr_read_b32 v22, a251
    v_mul_f32 v22, v22, v21
    v_accvgpr_write_b32 a251, v22
    v_accvgpr_read_b32 v22, a252
    v_mul_f32 v22, v22, v21
    v_accvgpr_write_b32 a252, v22
    v_accvgpr_read_b32 v22, a253
    v_mul_f32 v22, v22, v21
    v_accvgpr_write_b32 a253, v22
    v_accvgpr_read_b32 v22, a254
    v_mul_f32 v22, v22, v21
    v_accvgpr_write_b32 a254, v22
    v_accvgpr_read_b32 v22, a255
    v_mul_f32 v22, v22, v21
    v_accvgpr_write_b32 a255, v22
    s_nop 1
    s_branch S_back_late1
S_rare_early0:
    s_nop 15
    v_max3_f32 v20, v76, v77, v78
    v_max3_f32 v20, v79, v84, v20
    v_max3_f32 v20, v85, v86, v20
    v_max_f32 v20, v87, v20
    v_mov_b32 v21, v20
    s_nop 1
    v_permlane32_swap_b32 v20, v21
    v_max_f32 v20, v20, v21
    v_mov_b32 v21, v20
    s_nop 1
    v_permlane16_swap_b32 v20, v21
    v_max_f32 v20, v20, v21
    v_ceil_f32 v20, v20
    v_max_f32 v20, 0, v20
    v_sub_f32 v21, 0, v20
    v_exp_f32 v21, v21
    v_add_f32 v8, v8, v20
    v_sub_f32 v76, v76, v20
    v_sub_f32 v77, v77, v20
    v_sub_f32 v78, v78, v20
    v_sub_f32 v79, v79, v20
    v_sub_f32 v84, v84, v20
    v_sub_f32 v85, v85, v20
    v_sub_f32 v86, v86, v20
    v_sub_f32 v87, v87, v20
    v_mul_f32 v14, v14, v21
    v_mul_f32 v112, v112, v21
    v_mul_f32 v113, v113, v21
    v_mul_f32 v114, v114, v21
    v_mul_f32 v115, v115, v21
    v_mul_f32 v116, v116, v21
    v_mul_f32 v117, v117, v21
    v_mul_f32 v118, v118, v21
    v_mul_f32 v119, v119, v21
    v_mul_f32 v120, v120, v21
    v_mul_f32 v121, v121, v21
    v_mul_f32 v122, v122, v21
    v_mul_f32 v123, v123, v21
    v_mul_f32 v124, v124, v21
    v_mul_f32 v125, v125, v21
    v_mul_f32 v126, v126, v21
    v_mul_f32 v127, v127, v21
    v_mul_f32 v128, v128, v21
    v_mul_f32 v129, v129, v21
    v_mul_f32 v130, v130, v21
    v_mul_f32 v131, v131, v21
    v_mul_f32 v132, v132, v21
    v_mul_f32 v133, v133, v21
    v_mul_f32 v134, v134, v21
    v_mul_f32 v135, v135, v21
    v_mul_f32 v136, v136, v21
    v_mul_f32 v137, v137, v21
    v_mul_f32 v138, v138, v21
    v_mul_f32 v139, v139, v21
    v_mul_f32 v140, v140, v21
    v_mul_f32 v141, v141, v21
    v_mul_f32 v142, v142, v21
    v_mul_f32 v143, v143, v21
    v_mul_f32 v144, v144, v21
    v_mul_f32 v145, v145, v21
    v_mul_f32 v146, v146, v21
    v_mul_f32 v147, v147, v21
    v_mul_f32 v148, v148, v21
    v_mul_f32 v149, v149, v21
    v_mul_f32 v150, v150, v21
    v_mul_f32 v151, v151, v21
    v_mul_f32 v152, v152, v21
    v_mul_f32 v153, v153, v21
    v_mul_f32 v154, v154, v21
    v_mul_f32 v155, v155, v21
    v_mul_f32 v156, v156, v21
    v_mul_f32 v157, v157, v21
    v_mul_f32 v158, v158, v21
    v_mul_f32 v159, v159, v21
    v_lshlrev_b32 v22, 16, v80
    v_and_b32 v23, 0xffff0000, v80
    v_mul_f32 v22, v22, v21
    v_mul_f32 v23, v23, v21
    v_cvt_pk_bf16_f32 v80, v22, v23
    v_lshlrev_b32 v22, 16, v81
    v_and_b32 v23, 0xffff0000, v81
    v_mul_f32 v22, v22, v21
    v_mul_f32 v23, v23, v21
    v_cvt_pk_bf16_f32 v81, v22, v23
    v_lshlrev_b32 v22, 16, v82
    v_and_b32 v23, 0xffff0000, v82
    v_mul_f32 v22, v22, v21
    v_mul_f32 v23, v23, v21
    v_cvt_pk_bf16_f32 v82, v22, v23
    v_lshlrev_b32 v22, 16, v83
    v_and_b32 v23, 0xffff0000, v83
    v_mul_f32 v22, v22, v21
    v_mul_f32 v23, v23, v21
    v_cvt_pk_bf16_f32 v83, v22, v23
    v_max3_f32 v20, v88, v89, v90
    v_max3_f32 v20, v91, v96, v20
    v_max3_f32 v20, v97, v98, v20
    v_max_f32 v20, v99, v20
    v_mov_b32 v21, v20
    s_nop 1
    v_permlane32_swap_b32 v20, v21
    v_max_f32 v20, v20, v21
    v_mov_b32 v21, v20
    s_nop 1
    v_permlane16_swap_b32 v20, v21
    v_max_f32 v20, v20, v21
    v_ceil_f32 v20, v20
    v_max_f32 v20, 0, v20
    v_sub_f32 v21, 0, v20
    v_exp_f32 v21, v21
    v_add_f32 v9, v9, v20
    v_sub_f32 v88, v88, v20
    v_sub_f32 v89, v89, v20
    v_sub_f32 v90, v90, v20
    v_sub_f32 v91, v91, v20
    v_sub_f32 v96, v96, v20
    v_sub_f32 v97, v97, v20
    v_sub_f32 v98, v98, v20
    v_sub_f32 v99, v99, v20
    v_mul_f32 v15, v15, v21
    v_mul_f32 v160, v160, v21
    v_mul_f32 v161, v161, v21
    v_mul_f32 v162, v162, v21
    v_mul_f32 v163, v163, v21
    v_mul_f32 v164, v164, v21
    v_mul_f32 v165, v165, v21
    v_mul_f32 v166, v166, v21
    v_mul_f32 v167, v167, v21
    v_mul_f32 v168, v168, v21
    v_mul_f32 v169, v169, v21
    v_mul_f32 v170, v170, v21
    v_mul_f32 v171, v171, v21
    v_mul_f32 v172, v172, v21
    v_mul_f32 v173, v173, v21
    v_mul_f32 v174, v174, v21
    v_mul_f32 v175, v175, v21
    v_mul_f32 v176, v176, v21
    v_mul_f32 v177, v177, v21
    v_mul_f32 v178, v178, v21
    v_mul_f32 v179, v179, v21
    v_mul_f32 v180, v180, v21
    v_mul_f32 v181, v181, v21
    v_mul_f32 v182, v182, v21
    v_mul_f32 v183, v183, v21
    v_mul_f32 v184, v184, v21
    v_mul_f32 v185, v185, v21
    v_mul_f32 v186, v186, v21
    v_mul_f32 v187, v187, v21
    v_mul_f32 v188, v188, v21
    v_mul_f32 v189, v189, v21
    v_mul_f32 v190, v190, v21
    v_mul_f32 v191, v191, v21
    v_mul_f32 v192, v192, v21
    v_mul_f32 v193, v193, v21
    v_mul_f32 v194, v194, v21
    v_mul_f32 v195, v195, v21
    v_mul_f32 v196, v196, v21
    v_mul_f32 v197, v197, v21
    v_mul_f32 v198, v198, v21
    v_mul_f32 v199, v199, v21
    v_mul_f32 v200, v200, v21
    v_mul_f32 v201, v201, v21
    v_mul_f32 v202, v202, v21
    v_mul_f32 v203, v203, v21
    v_mul_f32 v204, v204, v21
    v_mul_f32 v205, v205, v21
    v_mul_f32 v206, v206, v21
    v_mul_f32 v207, v207, v21
    v_lshlrev_b32 v22, 16, v92
    v_and_b32 v23, 0xffff0000, v92
    v_mul_f32 v22, v22, v21
    v_mul_f32 v23, v23, v21
    v_cvt_pk_bf16_f32 v92, v22, v23
    v_lshlrev_b32 v22, 16, v93
    v_and_b32 v23, 0xffff0000, v93
    v_mul_f32 v22, v22, v21
    v_mul_f32 v23, v23, v21
    v_cvt_pk_bf16_f32 v93, v22, v23
    v_lshlrev_b32 v22, 16, v94
    v_and_b32 v23, 0xffff0000, v94
    v_mul_f32 v22, v22, v21
    v_mul_f32 v23, v23, v21
    v_cvt_pk_bf16_f32 v94, v22, v23
    v_lshlrev_b32 v22, 16, v95
    v_and_b32 v23, 0xffff0000, v95
    v_mul_f32 v22, v22, v21
    v_mul_f32 v23, v23, v21
    v_cvt_pk_bf16_f32 v95, v22, v23
    v_max3_f32 v20, v100, v101, v102
    v_max3_f32 v20, v103, v108, v20
    v_max3_f32 v20, v109, v110, v20
    v_max_f32 v20, v111, v20
    v_mov_b32 v21, v20
    s_nop 1
    v_permlane32_swap_b32 v20, v21
    v_max_f32 v20, v20, v21
    v_mov_b32 v21, v20
    s_nop 1
    v_permlane16_swap_b32 v20, v21
    v_max_f32 v20, v20, v21
    v_ceil_f32 v20, v20
    v_max_f32 v20, 0, v20
    v_sub_f32 v21, 0, v20
    v_exp_f32 v21, v21
    v_add_f32 v10, v10, v20
    v_sub_f32 v100, v100, v20
    v_sub_f32 v101, v101, v20
    v_sub_f32 v102, v102, v20
    v_sub_f32 v103, v103, v20
    v_sub_f32 v108, v108, v20
    v_sub_f32 v109, v109, v20
    v_sub_f32 v110, v110, v20
    v_sub_f32 v111, v111, v20
    v_mul_f32 v16, v16, v21
    v_mul_f32 v208, v208, v21
    v_mul_f32 v209, v209, v21
    v_mul_f32 v210, v210, v21
    v_mul_f32 v211, v211, v21
    v_mul_f32 v212, v212, v21
    v_mul_f32 v213, v213, v21
    v_mul_f32 v214, v214, v21
    v_mul_f32 v215, v215, v21
    v_mul_f32 v216, v216, v21
    v_mul_f32 v217, v217, v21
    v_mul_f32 v218, v218, v21
    v_mul_f32 v219, v219, v21
    v_mul_f32 v220, v220, v21
    v_mul_f32 v221, v221, v21
    v_mul_f32 v222, v222, v21
    v_mul_f32 v223, v223, v21
    v_mul_f32 v224, v224, v21
    v_mul_f32 v225, v225, v21
    v_mul_f32 v226, v226, v21
    v_mul_f32 v227, v227, v21
    v_mul_f32 v228, v228, v21
    v_mul_f32 v229, v229, v21
    v_mul_f32 v230, v230, v21
    v_mul_f32 v231, v231, v21
    v_mul_f32 v232, v232, v21
    v_mul_f32 v233, v233, v21
    v_mul_f32 v234, v234, v21
    v_mul_f32 v235, v235, v21
    v_mul_f32 v236, v236, v21
    v_mul_f32 v237, v237, v21
    v_mul_f32 v238, v238, v21
    v_mul_f32 v239, v239, v21
    v_mul_f32 v240, v240, v21
    v_mul_f32 v241, v241, v21
    v_mul_f32 v242, v242, v21
    v_mul_f32 v243, v243, v21
    v_mul_f32 v244, v244, v21
    v_mul_f32 v245, v245, v21
    v_mul_f32 v246, v246, v21
    v_mul_f32 v247, v247, v21
    v_mul_f32 v248, v248, v21
    v_mul_f32 v249, v249, v21
    v_mul_f32 v250, v250, v21
    v_mul_f32 v251, v251, v21
    v_mul_f32 v252, v252, v21
    v_mul_f32 v253, v253, v21
    v_mul_f32 v254, v254, v21
    v_mul_f32 v255, v255, v21
    v_lshlrev_b32 v22, 16, v104
    v_and_b32 v23, 0xffff0000, v104
    v_mul_f32 v22, v22, v21
    v_mul_f32 v23, v23, v21
    v_cvt_pk_bf16_f32 v104, v22, v23
    v_lshlrev_b32 v22, 16, v105
    v_and_b32 v23, 0xffff0000, v105
    v_mul_f32 v22, v22, v21
    v_mul_f32 v23, v23, v21
    v_cvt_pk_bf16_f32 v105, v22, v23
    v_lshlrev_b32 v22, 16, v106
    v_and_b32 v23, 0xffff0000, v106
    v_mul_f32 v22, v22, v21
    v_mul_f32 v23, v23, v21
    v_cvt_pk_bf16_f32 v106, v22, v23
    v_lshlrev_b32 v22, 16, v107
    v_and_b32 v23, 0xffff0000, v107
    v_mul_f32 v22, v22, v21
    v_mul_f32 v23, v23, v21
    v_cvt_pk_bf16_f32 v107, v22, v23
    s_nop 1
    s_branch S_back_early0
S_rare_early1:
    s_nop 15
    v_max3_f32 v20, v80, v81, v82
    v_max3_f32 v20, v83, v84, v20
    v_max3_f32 v20, v85, v86, v20
    v_max_f32 v20, v87, v20
    v_mov_b32 v21, v20
    s_nop 1
    v_permlane32_swap_b32 v20, v21
    v_max_f32 v20, v20, v21
    v_mov_b32 v21, v20
    s_nop 1
    v_permlane16_swap_b32 v20, v21
    v_max_f32 v20, v20, v21
    v_ceil_f32 v20, v20
    v_max_f32 v20, 0, v20
    v_sub_f32 v21, 0, v20
    v_exp_f32 v21, v21
    v_add_f32 v8, v8, v20
    v_sub_f32 v80, v80, v20
    v_sub_f32 v81, v81, v20
    v_sub_f32 v82, v82, v20
    v_sub_f32 v83, v83, v20
    v_sub_f32 v84, v84, v20
    v_sub_f32 v85, v85, v20
    v_sub_f32 v86, v86, v20
    v_sub_f32 v87, v87, v20
    v_mul_f32 v14, v14, v21
    v_mul_f32 v112, v112, v21
    v_mul_f32 v113, v113, v21
    v_mul_f32 v114, v114, v21
    v_mul_f32 v115, v115, v21
    v_mul_f32 v116, v116, v21
    v_mul_f32 v117, v117, v21
    v_mul_f32 v118, v118, v21
    v_mul_f32 v119, v119, v21
    v_mul_f32 v120, v120, v21
    v_mul_f32 v121, v121, v21
    v_mul_f32 v122, v122, v21
    v_mul_f32 v123, v123, v21
    v_mul_f32 v124, v124, v21
    v_mul_f32 v125, v125, v21
    v_mul_f32 v126, v126, v21
    v_mul_f32 v127, v127, v21
    v_mul_f32 v128, v128, v21
    v_mul_f32 v129, v129, v21
    v_mul_f32 v130, v130, v21
    v_mul_f32 v131, v131, v21
    v_mul_f32 v132, v132, v21
    v_mul_f32 v133, v133, v21
    v_mul_f32 v134, v134, v21
    v_mul_f32 v135, v135, v21
    v_mul_f32 v136, v136, v21
    v_mul_f32 v137, v137, v21
    v_mul_f32 v138, v138, v21
    v_mul_f32 v139, v139, v21
    v_mul_f32 v140, v140, v21
    v_mul_f32 v141, v141, v21
    v_mul_f32 v142, v142, v21
    v_mul_f32 v143, v143, v21
    v_mul_f32 v144, v144, v21
    v_mul_f32 v145, v145, v21
    v_mul_f32 v146, v146, v21
    v_mul_f32 v147, v147, v21
    v_mul_f32 v148, v148, v21
    v_mul_f32 v149, v149, v21
    v_mul_f32 v150, v150, v21
    v_mul_f32 v151, v151, v21
    v_mul_f32 v152, v152, v21
    v_mul_f32 v153, v153, v21
    v_mul_f32 v154, v154, v21
    v_mul_f32 v155, v155, v21
    v_mul_f32 v156, v156, v21
    v_mul_f32 v157, v157, v21
    v_mul_f32 v158, v158, v21
    v_mul_f32 v159, v159, v21
    v_lshlrev_b32 v22, 16, v76
    v_and_b32 v23, 0xffff0000, v76
    v_mul_f32 v22, v22, v21
    v_mul_f32 v23, v23, v21
    v_cvt_pk_bf16_f32 v76, v22, v23
    v_lshlrev_b32 v22, 16, v77
    v_and_b32 v23, 0xffff0000, v77
    v_mul_f32 v22, v22, v21
    v_mul_f32 v23, v23, v21
    v_cvt_pk_bf16_f32 v77, v22, v23
    v_lshlrev_b32 v22, 16, v78
    v_and_b32 v23, 0xffff0000, v78
    v_mul_f32 v22, v22, v21
    v_mul_f32 v23, v23, v21
    v_cvt_pk_bf16_f32 v78, v22, v23
    v_lshlrev_b32 v22, 16, v79
    v_and_b32 v23, 0xffff0000, v79
    v_mul_f32 v22, v22, v21
    v_mul_f32 v23, v23, v21
    v_cvt_pk_bf16_f32 v79, v22, v23
    v_max3_f32 v20, v92, v93, v94
    v_max3_f32 v20, v95, v96, v20
    v_max3_f32 v20, v97, v98, v20
    v_max_f32 v20, v99, v20
    v_mov_b32 v21, v20
    s_nop 1
    v_permlane32_swap_b32 v20, v21
    v_max_f32 v20, v20, v21
    v_mov_b32 v21, v20
    s_nop 1
    v_permlane16_swap_b32 v20, v21
    v_max_f32 v20, v20, v21
    v_ceil_f32 v20, v20
    v_max_f32 v20, 0, v20
    v_sub_f32 v21, 0, v20
    v_exp_f32 v21, v21
    v_add_f32 v9, v9, v20
    v_sub_f32 v92, v92, v20
    v_sub_f32 v93, v93, v20
    v_sub_f32 v94, v94, v20
    v_sub_f32 v95, v95, v20
    v_sub_f32 v96, v96, v20
    v_sub_f32 v97, v97, v20
    v_sub_f32 v98, v98, v20
    v_sub_f32 v99, v99, v20
    v_mul_f32 v15, v15, v21
    v_mul_f32 v160, v160, v21
    v_mul_f32 v161, v161, v21
    v_mul_f32 v162, v162, v21
    v_mul_f32 v163, v163, v21
    v_mul_f32 v164, v164, v21
    v_mul_f32 v165, v165, v21
    v_mul_f32 v166, v166, v21
    v_mul_f32 v167, v167, v21
    v_mul_f32 v168, v168, v21
    v_mul_f32 v169, v169, v21
    v_mul_f32 v170, v170, v21
    v_mul_f32 v171, v171, v21
    v_mul_f32 v172, v172, v21
    v_mul_f32 v173, v173, v21
    v_mul_f32 v174, v174, v21
    v_mul_f32 v175, v175, v21
    v_mul_f32 v176, v176, v21
    v_mul_f32 v177, v177, v21
    v_mul_f32 v178, v178, v21
    v_mul_f32 v179, v179, v21
    v_mul_f32 v180, v180, v21
    v_mul_f32 v181, v181, v21
    v_mul_f32 v182, v182, v21
    v_mul_f32 v183, v183, v21
    v_mul_f32 v184, v184, v21
    v_mul_f32 v185, v185, v21
    v_mul_f32 v186, v186, v21
    v_mul_f32 v187, v187, v21
    v_mul_f32 v188, v188, v21
    v_mul_f32 v189, v189, v21
    v_mul_f32 v190, v190, v21
    v_mul_f32 v191, v191, v21
    v_mul_f32 v192, v192, v21
    v_mul_f32 v193, v193, v21
    v_mul_f32 v194, v194, v21
    v_mul_f32 v195, v195, v21
    v_mul_f32 v196, v196, v21
    v_mul_f32 v197, v197, v21
    v_mul_f32 v198, v198, v21
    v_mul_f32 v199, v199, v21
    v_mul_f32 v200, v200, v21
    v_mul_f32 v201, v201, v21
    v_mul_f32 v202, v202, v21
    v_mul_f32 v203, v203, v21
    v_mul_f32 v204, v204, v21
    v_mul_f32 v205, v205, v21
    v_mul_f32 v206, v206, v21
    v_mul_f32 v207, v207, v21
    v_lshlrev_b32 v22, 16, v88
    v_and_b32 v23, 0xffff0000, v88
    v_mul_f32 v22, v22, v21
    v_mul_f32 v23, v23, v21
    v_cvt_pk_bf16_f32 v88, v22, v23
    v_lshlrev_b32 v22, 16, v89
    v_and_b32 v23, 0xffff0000, v89
    v_mul_f32 v22, v22, v21
    v_mul_f32 v23, v23, v21
    v_cvt_pk_bf16_f32 v89, v22, v23
    v_lshlrev_b32 v22, 16, v90
    v_and_b32 v23, 0xffff0000, v90
    v_mul_f32 v22, v22, v21
    v_mul_f32 v23, v23, v21
    v_cvt_pk_bf16_f32 v90, v22, v23
    v_lshlrev_b32 v22, 16, v91
    v_and_b32 v23, 0xffff0000, v91
    v_mul_f32 v22, v22, v21
    v_mul_f32 v23, v23, v21
    v_cvt_pk_bf16_f32 v91, v22, v23
    v_max3_f32 v20, v104, v105, v106
    v_max3_f32 v20, v107, v108, v20
    v_max3_f32 v20, v109, v110, v20
    v_max_f32 v20, v111, v20
    v_mov_b32 v21, v20
    s_nop 1
    v_permlane32_swap_b32 v20, v21
    v_max_f32 v20, v20, v21
    v_mov_b32 v21, v20
    s_nop 1
    v_permlane16_swap_b32 v20, v21
    v_max_f32 v20, v20, v21
    v_ceil_f32 v20, v20
    v_max_f32 v20, 0, v20
    v_sub_f32 v21, 0, v20
    v_exp_f32 v21, v21
    v_add_f32 v10, v10, v20
    v_sub_f32 v104, v104, v20
    v_sub_f32 v105, v105, v20
    v_sub_f32 v106, v106, v20
    v_sub_f32 v107, v107, v20
    v_sub_f32 v108, v108, v20
    v_sub_f32 v109, v109, v20
    v_sub_f32 v110, v110, v20
    v_sub_f32 v111, v111, v20
    v_mul_f32 v16, v16, v21
    v_mul_f32 v208, v208, v21
    v_mul_f32 v209, v209, v21
    v_mul_f32 v210, v210, v21
    v_mul_f32 v211, v211, v21
    v_mul_f32 v212, v212, v21
    v_mul_f32 v213, v213, v21
    v_mul_f32 v214, v214, v21
    v_mul_f32 v215, v215, v21
    v_mul_f32 v216, v216, v21
    v_mul_f32 v217, v217, v21
    v_mul_f32 v218, v218, v21
    v_mul_f32 v219, v219, v21
    v_mul_f32 v220, v220, v21
    v_mul_f32 v221, v221, v21
    v_mul_f32 v222, v222, v21
    v_mul_f32 v223, v223, v21
    v_mul_f32 v224, v224, v21
    v_mul_f32 v225, v225, v21
    v_mul_f32 v226, v226, v21
    v_mul_f32 v227, v227, v21
    v_mul_f32 v228, v228, v21
    v_mul_f32 v229, v229, v21
    v_mul_f32 v230, v230, v21
    v_mul_f32 v231, v231, v21
    v_mul_f32 v232, v232, v21
    v_mul_f32 v233, v233, v21
    v_mul_f32 v234, v234, v21
    v_mul_f32 v235, v235, v21
    v_mul_f32 v236, v236, v21
    v_mul_f32 v237, v237, v21
    v_mul_f32 v238, v238, v21
    v_mul_f32 v239, v239, v21
    v_mul_f32 v240, v240, v21
    v_mul_f32 v241, v241, v21
    v_mul_f32 v242, v242, v21
    v_mul_f32 v243, v243, v21
    v_mul_f32 v244, v244, v21
    v_mul_f32 v245, v245, v21
    v_mul_f32 v246, v246, v21
    v_mul_f32 v247, v247, v21
    v_mul_f32 v248, v248, v21
    v_mul_f32 v249, v249, v21
    v_mul_f32 v250, v250, v21
    v_mul_f32 v251, v251, v21
    v_mul_f32 v252, v252, v21
    v_mul_f32 v253, v253, v21
    v_mul_f32 v254, v254, v21
    v_mul_f32 v255, v255, v21
    v_lshlrev_b32 v22, 16, v100
    v_and_b32 v23, 0xffff0000, v100
    v_mul_f32 v22, v22, v21
    v_mul_f32 v23, v23, v21
    v_cvt_pk_bf16_f32 v100, v22, v23
    v_lshlrev_b32 v22, 16, v101
    v_and_b32 v23, 0xffff0000, v101
    v_mul_f32 v22, v22, v21
    v_mul_f32 v23, v23, v21
    v_cvt_pk_bf16_f32 v101, v22, v23
    v_lshlrev_b32 v22, 16, v102
    v_and_b32 v23, 0xffff0000, v102
    v_mul_f32 v22, v22, v21
    v_mul_f32 v23, v23, v21
    v_cvt_pk_bf16_f32 v102, v22, v23
    v_lshlrev_b32 v22, 16, v103
    v_and_b32 v23, 0xffff0000, v103
    v_mul_f32 v22, v22, v21
    v_mul_f32 v23, v23, v21
    v_cvt_pk_bf16_f32 v103, v22, v23
    s_nop 1
    s_branch S_back_early1
S_rare_tail:
    s_nop 15
    v_max3_f32 v20, v32, v33, v34
    v_max3_f32 v20, v35, v40, v20
    v_max3_f32 v20, v41, v42, v20
    v_max_f32 v20, v43, v20
    v_mov_b32 v21, v20
    s_nop 1
    v_permlane32_swap_b32 v20, v21
    v_max_f32 v20, v20, v21
    v_mov_b32 v21, v20
    s_nop 1
    v_permlane16_swap_b32 v20, v21
    v_max_f32 v20, v20, v21
    v_ceil_f32 v20, v20
    v_max_f32 v20, 0, v20
    v_sub_f32 v21, 0, v20
    v_exp_f32 v21, v21
    v_add_f32 v11, v11, v20
    v_sub_f32 v32, v32, v20
    v_sub_f32 v33, v33, v20
    v_sub_f32 v34, v34, v20
    v_sub_f32 v35, v35, v20
    v_sub_f32 v40, v40, v20
    v_sub_f32 v41, v41, v20
    v_sub_f32 v42, v42, v20
    v_sub_f32 v43, v43, v20
    v_mul_f32 v17, v17, v21
    v_accvgpr_read_b32 v22, a112
    v_mul_f32 v22, v22, v21
    v_accvgpr_write_b32 a112, v22
    v_accvgpr_read_b32 v22, a113
    v_mul_f32 v22, v22, v21
    v_accvgpr_write_b32 a113, v22
    v_accvgpr_read_b32 v22, a114
    v_mul_f32 v22, v22, v21
    v_accvgpr_write_b32 a114, v22
    v_accvgpr_read_b32 v22, a115
    v_mul_f32 v22, v22, v21
    v_accvgpr_write_b32 a115, v22
    v_accvgpr_read_b32 v22, a116
    v_mul_f32 v22, v22, v21
    v_accvgpr_write_b32 a116, v22
    v_accvgpr_read_b32 v22, a117
    v_mul_f32 v22, v22, v21
    v_accvgpr_write_b32 a117, v22
    v_accvgpr_read_b32 v22, a118
    v_mul_f32 v22, v22, v21
    v_accvgpr_write_b32 a118, v22
    v_accvgpr_read_b32 v22, a119
    v_mul_f32 v22, v22, v21
    v_accvgpr_write_b32 a119, v22
    v_accvgpr_read_b32 v22, a120
    v_mul_f32 v22, v22, v21
    v_accvgpr_write_b32 a120, v22
    v_accvgpr_read_b32 v22, a121
    v_mul_f32 v22, v22, v21
    v_accvgpr_write_b32 a121, v22
    v_accvgpr_read_b32 v22, a122
    v_mul_f32 v22, v22, v21
    v_accvgpr_write_b32 a122, v22
    v_accvgpr_read_b32 v22, a123
    v_mul_f32 v22, v22, v21
    v_accvgpr_write_b32 a123, v22
    v_accvgpr_read_b32 v22, a124
    v_mul_f32 v22, v22, v21
    v_accvgpr_write_b32 a124, v22
    v_accvgpr_read_b32 v22, a125
    v_mul_f32 v22, v22, v21
    v_accvgpr_write_b32 a125, v22
    v_accvgpr_read_b32 v22, a126
    v_mul_f32 v22, v22, v21
    v_accvgpr_write_b32 a126, v22
    v_accvgpr_read_b32 v22, a127
    v_mul_f32 v22, v22, v21
    v_accvgpr_write_b32 a127, v22
    v_accvgpr_read_b32 v22, a128
    v_mul_f32 v22, v22, v21
    v_accvgpr_write_b32 a128, v22
    v_accvgpr_read_b32 v22, a129
    v_mul_f32 v22, v22, v21
    v_accvgpr_write_b32 a129, v22
    v_accvgpr_read_b32 v22, a130
    v_mul_f32 v22, v22, v21
    v_accvgpr_write_b32 a130, v22
    v_accvgpr_read_b32 v22, a131
    v_mul_f32 v22, v22, v21
    v_accvgpr_write_b32 a131, v22
    v_accvgpr_read_b32 v22, a132
    v_mul_f32 v22, v22, v21
    v_accvgpr_write_b32 a132, v22
    v_accvgpr_read_b32 v22, a133
    v_mul_f32 v22, v22, v21
    v_accvgpr_write_b32 a133, v22
    v_accvgpr_read_b32 v22, a134
    v_mul_f32 v22, v22, v21
    v_accvgpr_write_b32 a134, v22
    v_accvgpr_read_b32 v22, a135
    v_mul_f32 v22, v22, v21
    v_accvgpr_write_b32 a135, v22
    v_accvgpr_read_b32 v22, a136
    v_mul_f32 v22, v22, v21
    v_accvgpr_write_b32 a136, v22
    v_accvgpr_read_b32 v22, a137
    v_mul_f32 v22, v22, v21
    v_accvgpr_write_b32 a137, v22
    v_accvgpr_read_b32 v22, a138
    v_mul_f32 v22, v22, v21
    v_accvgpr_write_b32 a138, v22
    v_accvgpr_read_b32 v22, a139
    v_mul_f32 v22, v22, v21
    v_accvgpr_write_b32 a139, v22
    v_accvgpr_read_b32 v22, a140
    v_mul_f32 v22, v22, v21
    v_accvgpr_write_b32 a140, v22
    v_accvgpr_read_b32 v22, a141
    v_mul_f32 v22, v22, v21
    v_accvgpr_write_b32 a141, v22
    v_accvgpr_read_b32 v22, a142
    v_mul_f32 v22, v22, v21
    v_accvgpr_write_b32 a142, v22
    v_accvgpr_read_b32 v22, a143
    v_mul_f32 v22, v22, v21
    v_accvgpr_write_b32 a143, v22
    v_accvgpr_read_b32 v22, a144
    v_mul_f32 v22, v22, v21
    v_accvgpr_write_b32 a144, v22
    v_accvgpr_read_b32 v22, a145
    v_mul_f32 v22, v22, v21
    v_accvgpr_write_b32 a145, v22
    v_accvgpr_read_b32 v22, a146
    v_mul_f32 v22, v22, v21
    v_accvgpr_write_b32 a146, v22
    v_accvgpr_read_b32 v22, a147
    v_mul_f32 v22, v22, v21
    v_accvgpr_write_b32 a147, v22
    v_accvgpr_read_b32 v22, a148
    v_mul_f32 v22, v22, v21
    v_accvgpr_write_b32 a148, v22
    v_accvgpr_read_b32 v22, a149
    v_mul_f32 v22, v22, v21
    v_accvgpr_write_b32 a149, v22
    v_accvgpr_read_b32 v22, a150
    v_mul_f32 v22, v22, v21
    v_accvgpr_write_b32 a150, v22
    v_accvgpr_read_b32 v22, a151
    v_mul_f32 v22, v22, v21
    v_accvgpr_write_b32 a151, v22
    v_accvgpr_read_b32 v22, a152
    v_mul_f32 v22, v22, v21
    v_accvgpr_write_b32 a152, v22
    v_accvgpr_read_b32 v22, a153
    v_mul_f32 v22, v22, v21
    v_accvgpr_write_b32 a153, v22
    v_accvgpr_read_b32 v22, a154
    v_mul_f32 v22, v22, v21
    v_accvgpr_write_b32 a154, v22
    v_accvgpr_read_b32 v22, a155
    v_mul_f32 v22, v22, v21
    v_accvgpr_write_b32 a155, v22
    v_accvgpr_read_b32 v22, a156
    v_mul_f32 v22, v22, v21
    v_accvgpr_write_b32 a156, v22
    v_accvgpr_read_b32 v22, a157
    v_mul_f32 v22, v22, v21
    v_accvgpr_write_b32 a157, v22
    v_accvgpr_read_b32 v22, a158
    v_mul_f32 v22, v22, v21
    v_accvgpr_write_b32 a158, v22
    v_accvgpr_read_b32 v22, a159
    v_mul_f32 v22, v22, v21
    v_accvgpr_write_b32 a159, v22
    v_max3_f32 v20, v48, v49, v50
    v_max3_f32 v20, v51, v56, v20
    v_max3_f32 v20, v57, v58, v20
    v_max_f32 v20, v59, v20
    v_mov_b32 v21, v20
    s_nop 1
    v_permlane32_swap_b32 v20, v21
    v_max_f32 v20, v20, v21
    v_mov_b32 v21, v20
    s_nop 1
    v_permlane16_swap_b32 v20, v21
    v_max_f32 v20, v20, v21
    v_ceil_f32 v20, v20
    v_max_f32 v20, 0, v20
    v_sub_f32 v21, 0, v20
    v_exp_f32 v21, v21
    v_add_f32 v12, v12, v20
    v_sub_f32 v48, v48, v20
    v_sub_f32 v49, v49, v20
    v_sub_f32 v50, v50, v20
    v_sub_f32 v51, v51, v20
    v_sub_f32 v56, v56, v20
    v_sub_f32 v57, v57, v20
    v_sub_f32 v58, v58, v20
    v_sub_f32 v59, v59, v20
    v_mul_f32 v18, v18, v21
    v_accvgpr_read_b32 v22, a160
    v_mul_f32 v22, v22, v21
    v_accvgpr_write_b32 a160, v22
    v_accvgpr_read_b32 v22, a161
    v_mul_f32 v22, v22, v21
    v_accvgpr_write_b32 a161, v22
    v_accvgpr_read_b32 v22, a162
    v_mul_f32 v22, v22, v21
    v_accvgpr_write_b32 a162, v22
    v_accvgpr_read_b32 v22, a163
    v_mul_f32 v22, v22, v21
    v_accvgpr_write_b32 a163, v22
    v_accvgpr_read_b32 v22, a164
    v_mul_f32 v22, v22, v21
    v_accvgpr_write_b32 a164, v22
    v_accvgpr_read_b32 v22, a165
    v_mul_f32 v22, v22, v21
    v_accvgpr_write_b32 a165, v22
    v_accvgpr_read_b32 v22, a166
    v_mul_f32 v22, v22, v21
    v_accvgpr_write_b32 a166, v22
    v_accvgpr_read_b32 v22, a167
    v_mul_f32 v22, v22, v21
    v_accvgpr_write_b32 a167, v22
    v_accvgpr_read_b32 v22, a168
    v_mul_f32 v22, v22, v21
    v_accvgpr_write_b32 a168, v22
    v_accvgpr_read_b32 v22, a169
    v_mul_f32 v22, v22, v21
    v_accvgpr_write_b32 a169, v22
    v_accvgpr_read_b32 v22, a170
    v_mul_f32 v22, v22, v21
    v_accvgpr_write_b32 a170, v22
    v_accvgpr_read_b32 v22, a171
    v_mul_f32 v22, v22, v21
    v_accvgpr_write_b32 a171, v22
    v_accvgpr_read_b32 v22, a172
    v_mul_f32 v22, v22, v21
    v_accvgpr_write_b32 a172, v22
    v_accvgpr_read_b32 v22, a173
    v_mul_f32 v22, v22, v21
    v_accvgpr_write_b32 a173, v22
    v_accvgpr_read_b32 v22, a174
    v_mul_f32 v22, v22, v21
    v_accvgpr_write_b32 a174, v22
    v_accvgpr_read_b32 v22, a175
    v_mul_f32 v22, v22, v21
    v_accvgpr_write_b32 a175, v22
    v_accvgpr_read_b32 v22, a176
    v_mul_f32 v22, v22, v21
    v_accvgpr_write_b32 a176, v22
    v_accvgpr_read_b32 v22, a177
    v_mul_f32 v22, v22, v21
    v_accvgpr_write_b32 a177, v22
    v_accvgpr_read_b32 v22, a178
    v_mul_f32 v22, v22, v21
    v_accvgpr_write_b32 a178, v22
    v_accvgpr_read_b32 v22, a179
    v_mul_f32 v22, v22, v21
    v_accvgpr_write_b32 a179, v22
    v_accvgpr_read_b32 v22, a180
    v_mul_f32 v22, v22, v21
    v_accvgpr_write_b32 a180, v22
    v_accvgpr_read_b32 v22, a181
    v_mul_f32 v22, v22, v21
    v_accvgpr_write_b32 a181, v22
    v_accvgpr_read_b32 v22, a182
    v_mul_f32 v22, v22, v21
    v_accvgpr_write_b32 a182, v22
    v_accvgpr_read_b32 v22, a183
    v_mul_f32 v22, v22, v21
    v_accvgpr_write_b32 a183, v22
    v_accvgpr_read_b32 v22, a184
    v_mul_f32 v22, v22, v21
    v_accvgpr_write_b32 a184, v22
    v_accvgpr_read_b32 v22, a185
    v_mul_f32 v22, v22, v21
    v_accvgpr_write_b32 a185, v22
    v_accvgpr_read_b32 v22, a186
    v_mul_f32 v22, v22, v21
    v_accvgpr_write_b32 a186, v22
    v_accvgpr_read_b32 v22, a187
    v_mul_f32 v22, v22, v21
    v_accvgpr_write_b32 a187, v22
    v_accvgpr_read_b32 v22, a188
    v_mul_f32 v22, v22, v21
    v_accvgpr_write_b32 a188, v22
    v_accvgpr_read_b32 v22, a189
    v_mul_f32 v22, v22, v21
    v_accvgpr_write_b32 a189, v22
    v_accvgpr_read_b32 v22, a190
    v_mul_f32 v22, v22, v21
    v_accvgpr_write_b32 a190, v22
    v_accvgpr_read_b32 v22, a191
    v_mul_f32 v22, v22, v21
    v_accvgpr_write_b32 a191, v22
    v_accvgpr_read_b32 v22, a192
    v_mul_f32 v22, v22, v21
    v_accvgpr_write_b32 a192, v22
    v_accvgpr_read_b32 v22, a193
    v_mul_f32 v22, v22, v21
    v_accvgpr_write_b32 a193, v22
    v_accvgpr_read_b32 v22, a194
    v_mul_f32 v22, v22, v21
    v_accvgpr_write_b32 a194, v22
    v_accvgpr_read_b32 v22, a195
    v_mul_f32 v22, v22, v21
    v_accvgpr_write_b32 a195, v22
    v_accvgpr_read_b32 v22, a196
    v_mul_f32 v22, v22, v21
    v_accvgpr_write_b32 a196, v22
    v_accvgpr_read_b32 v22, a197
    v_mul_f32 v22, v22, v21
    v_accvgpr_write_b32 a197, v22
    v_accvgpr_read_b32 v22, a198
    v_mul_f32 v22, v22, v21
    v_accvgpr_write_b32 a198, v22
    v_accvgpr_read_b32 v22, a199
    v_mul_f32 v22, v22, v21
    v_accvgpr_write_b32 a199, v22
    v_accvgpr_read_b32 v22, a200
    v_mul_f32 v22, v22, v21
    v_accvgpr_write_b32 a200, v22
    v_accvgpr_read_b32 v22, a201
    v_mul_f32 v22, v22, v21
    v_accvgpr_write_b32 a201, v22
    v_accvgpr_read_b32 v22, a202
    v_mul_f32 v22, v22, v21
    v_accvgpr_write_b32 a202, v22
    v_accvgpr_read_b32 v22, a203
    v_mul_f32 v22, v22, v21
    v_accvgpr_write_b32 a203, v22
    v_accvgpr_read_b32 v22, a204
    v_mul_f32 v22, v22, v21
    v_accvgpr_write_b32 a204, v22
    v_accvgpr_read_b32 v22, a205
    v_mul_f32 v22, v22, v21
    v_accvgpr_write_b32 a205, v22
    v_accvgpr_read_b32 v22, a206
    v_mul_f32 v22, v22, v21
    v_accvgpr_write_b32 a206, v22
    v_accvgpr_read_b32 v22, a207
    v_mul_f32 v22, v22, v21
    v_accvgpr_write_b32 a207, v22
    v_max3_f32 v20, v64, v65, v66
    v_max3_f32 v20, v67, v72, v20
    v_max3_f32 v20, v73, v74, v20
    v_max_f32 v20, v75, v20
    v_mov_b32 v21, v20
    s_nop 1
    v_permlane32_swap_b32 v20, v21
    v_max_f32 v20, v20, v21
    v_mov_b32 v21, v20
    s_nop 1
    v_permlane16_swap_b32 v20, v21
    v_max_f32 v20, v20, v21
    v_ceil_f32 v20, v20
    v_max_f32 v20, 0, v20
    v_sub_f32 v21, 0, v20
    v_exp_f32 v21, v21
    v_add_f32 v13, v13, v20
    v_sub_f32 v64, v64, v20
    v_sub_f32 v65, v65, v20
    v_sub_f32 v66, v66, v20
    v_sub_f32 v67, v67, v20
    v_sub_f32 v72, v72, v20
    v_sub_f32 v73, v73, v20
    v_sub_f32 v74, v74, v20
    v_sub_f32 v75, v75, v20
    v_mul_f32 v19, v19, v21
    v_accvgpr_read_b32 v22, a208
    v_mul_f32 v22, v22, v21
    v_accvgpr_write_b32 a208, v22
    v_accvgpr_read_b32 v22, a209
    v_mul_f32 v22, v22, v21
    v_accvgpr_write_b32 a209, v22
    v_accvgpr_read_b32 v22, a210
    v_mul_f32 v22, v22, v21
    v_accvgpr_write_b32 a210, v22
    v_accvgpr_read_b32 v22, a211
    v_mul_f32 v22, v22, v21
    v_accvgpr_write_b32 a211, v22
    v_accvgpr_read_b32 v22, a212
    v_mul_f32 v22, v22, v21
    v_accvgpr_write_b32 a212, v22
    v_accvgpr_read_b32 v22, a213
    v_mul_f32 v22, v22, v21
    v_accvgpr_write_b32 a213, v22
    v_accvgpr_read_b32 v22, a214
    v_mul_f32 v22, v22, v21
    v_accvgpr_write_b32 a214, v22
    v_accvgpr_read_b32 v22, a215
    v_mul_f32 v22, v22, v21
    v_accvgpr_write_b32 a215, v22
    v_accvgpr_read_b32 v22, a216
    v_mul_f32 v22, v22, v21
    v_accvgpr_write_b32 a216, v22
    v_accvgpr_read_b32 v22, a217
    v_mul_f32 v22, v22, v21
    v_accvgpr_write_b32 a217, v22
    v_accvgpr_read_b32 v22, a218
    v_mul_f32 v22, v22, v21
    v_accvgpr_write_b32 a218, v22
    v_accvgpr_read_b32 v22, a219
    v_mul_f32 v22, v22, v21
    v_accvgpr_write_b32 a219, v22
    v_accvgpr_read_b32 v22, a220
    v_mul_f32 v22, v22, v21
    v_accvgpr_write_b32 a220, v22
    v_accvgpr_read_b32 v22, a221
    v_mul_f32 v22, v22, v21
    v_accvgpr_write_b32 a221, v22
    v_accvgpr_read_b32 v22, a222
    v_mul_f32 v22, v22, v21
    v_accvgpr_write_b32 a222, v22
    v_accvgpr_read_b32 v22, a223
    v_mul_f32 v22, v22, v21
    v_accvgpr_write_b32 a223, v22
    v_accvgpr_read_b32 v22, a224
    v_mul_f32 v22, v22, v21
    v_accvgpr_write_b32 a224, v22
    v_accvgpr_read_b32 v22, a225
    v_mul_f32 v22, v22, v21
    v_accvgpr_write_b32 a225, v22
    v_accvgpr_read_b32 v22, a226
    v_mul_f32 v22, v22, v21
    v_accvgpr_write_b32 a226, v22
    v_accvgpr_read_b32 v22, a227
    v_mul_f32 v22, v22, v21
    v_accvgpr_write_b32 a227, v22
    v_accvgpr_read_b32 v22, a228
    v_mul_f32 v22, v22, v21
    v_accvgpr_write_b32 a228, v22
    v_accvgpr_read_b32 v22, a229
    v_mul_f32 v22, v22, v21
    v_accvgpr_write_b32 a229, v22
    v_accvgpr_read_b32 v22, a230
    v_mul_f32 v22, v22, v21
    v_accvgpr_write_b32 a230, v22
    v_accvgpr_read_b32 v22, a231
    v_mul_f32 v22, v22, v21
    v_accvgpr_write_b32 a231, v22
    v_accvgpr_read_b32 v22, a232
    v_mul_f32 v22, v22, v21
    v_accvgpr_write_b32 a232, v22
    v_accvgpr_read_b32 v22, a233
    v_mul_f32 v22, v22, v21
    v_accvgpr_write_b32 a233, v22
    v_accvgpr_read_b32 v22, a234
    v_mul_f32 v22, v22, v21
    v_accvgpr_write_b32 a234, v22
    v_accvgpr_read_b32 v22, a235
    v_mul_f32 v22, v22, v21
    v_accvgpr_write_b32 a235, v22
    v_accvgpr_read_b32 v22, a236
    v_mul_f32 v22, v22, v21
    v_accvgpr_write_b32 a236, v22
    v_accvgpr_read_b32 v22, a237
    v_mul_f32 v22, v22, v21
    v_accvgpr_write_b32 a237, v22
    v_accvgpr_read_b32 v22, a238
    v_mul_f32 v22, v22, v21
    v_accvgpr_write_b32 a238, v22
    v_accvgpr_read_b32 v22, a239
    v_mul_f32 v22, v22, v21
    v_accvgpr_write_b32 a239, v22
    v_accvgpr_read_b32 v22, a240
    v_mul_f32 v22, v22, v21
    v_accvgpr_write_b32 a240, v22
    v_accvgpr_read_b32 v22, a241
    v_mul_f32 v22, v22, v21
    v_accvgpr_write_b32 a241, v22
    v_accvgpr_read_b32 v22, a242
    v_mul_f32 v22, v22, v21
    v_accvgpr_write_b32 a242, v22
    v_accvgpr_read_b32 v22, a243
    v_mul_f32 v22, v22, v21
    v_accvgpr_write_b32 a243, v22
    v_accvgpr_read_b32 v22, a244
    v_mul_f32 v22, v22, v21
    v_accvgpr_write_b32 a244, v22
    v_accvgpr_read_b32 v22, a245
    v_mul_f32 v22, v22, v21
    v_accvgpr_write_b32 a245, v22
    v_accvgpr_read_b32 v22, a246
    v_mul_f32 v22, v22, v21
    v_accvgpr_write_b32 a246, v22
    v_accvgpr_read_b32 v22, a247
    v_mul_f32 v22, v22, v21
    v_accvgpr_write_b32 a247, v22
    v_accvgpr_read_b32 v22, a248
    v_mul_f32 v22, v22, v21
    v_accvgpr_write_b32 a248, v22
    v_accvgpr_read_b32 v22, a249
    v_mul_f32 v22, v22, v21
    v_accvgpr_write_b32 a249, v22
    v_accvgpr_read_b32 v22, a250
    v_mul_f32 v22, v22, v21
    v_accvgpr_write_b32 a250, v22
    v_accvgpr_read_b32 v22, a251
    v_mul_f32 v22, v22, v21
    v_accvgpr_write_b32 a251, v22
    v_accvgpr_read_b32 v22, a252
    v_mul_f32 v22, v22, v21
    v_accvgpr_write_b32 a252, v22
    v_accvgpr_read_b32 v22, a253
    v_mul_f32 v22, v22, v21
    v_accvgpr_write_b32 a253, v22
    v_accvgpr_read_b32 v22, a254
    v_mul_f32 v22, v22, v21
    v_accvgpr_write_b32 a254, v22
    v_accvgpr_read_b32 v22, a255
    v_mul_f32 v22, v22, v21
    v_accvgpr_write_b32 a255, v22
    s_nop 1
    s_branch S_back_tail
.section .rodata,"a"
.p2align 6
.amdhsa_kernel standalone__gqa_softmax__near_ridge_kernel
  .amdhsa_next_free_vgpr 512
  .amdhsa_next_free_sgpr 96
  .amdhsa_accum_offset 256
  .amdhsa_group_segment_fixed_size 0
  .amdhsa_kernarg_size 48
  .amdhsa_user_sgpr_count 2
  .amdhsa_user_sgpr_kernarg_segment_ptr 1
  .amdhsa_system_sgpr_workgroup_id_x 1
.end_amdhsa_kernel
```
